```python
import torch

def _softmax(x, axis=-1):
    return torch.softmax(x, dim=axis)

def _gelu(x):
    return torch.nn.functional.gelu(x, approximate='tanh')

def _silu(x):
    return torch.nn.functional.silu(x)

def _sigmoid(x):
    return torch.sigmoid(x)

def _layernorm(x, axis=-1, eps=1e-05):
    m = x.mean(dim=axis, keepdim=True)
    v = x.var(dim=axis, keepdim=True, unbiased=False)
    return (x - m) / torch.sqrt(v + eps)

def _scatter_add(tgt, idx, src, axis=0):
    return tgt.clone().index_add_(axis, idx, src)

def _segment_sum(src, seg, n):
    out = torch.zeros((n,) + src.shape[1:], dtype=src.dtype)
    return out.index_add_(0, seg, src)

def _pad(x, pw):
    flat = tuple((v for pair in reversed(pw) for v in pair))
    return torch.nn.functional.pad(x, flat)
kernel_name = 'adaLN_cond__mha_block__glu_gated_glu__prompt'

def setup_inputs():

    _w = lambda a: (lambda t: t.to(torch.bfloat16) if t.is_floating_point() else t)(torch.as_tensor(a))

    def _A_setup():
        B, S, D, H = (1, 2048, 640, 32)
        return {'x': _w((lambda *s: torch.randn(*s, dtype=torch.bfloat16) * 0.05)(B, S, D)), 'wqkv': _w((lambda *s: torch.randn(*s, dtype=torch.bfloat16) * 0.05)(D, 3 * D)), 'wo': _w((lambda *s: torch.randn(*s, dtype=torch.bfloat16) * 0.05)(D, D))}
    _A_in = _A_setup()

    def _B_setup():
        B, S, D, F = (1, 2048, 640, 1728)
        return {'x': _w((lambda *s: torch.randn(*s, dtype=torch.bfloat16) * 0.05)(B, S, D)), 'w_gate': _w((lambda *s: torch.randn(*s, dtype=torch.bfloat16) * 0.05)(D, F)), 'w_up': _w((lambda *s: torch.randn(*s, dtype=torch.bfloat16) * 0.05)(D, F)), 'w_down': _w((lambda *s: torch.randn(*s, dtype=torch.bfloat16) * 0.05)(F, D))}
    _B_in = _B_setup()
    return {'A_x': _A_in['x'], 'A_wqkv': _A_in['wqkv'], 'A_wo': _A_in['wo'], 'B_x': _B_in['x'], 'B_w_gate': _B_in['w_gate'], 'B_w_up': _B_in['w_up'], 'B_w_down': _B_in['w_down'], 'c': _w((lambda *s: torch.randn(*s, dtype=torch.bfloat16) * 0.2)(1, 640) * 8.0), 'w_mod': _w((lambda *s: torch.randn(*s, dtype=torch.bfloat16) * 0.2)(640, 6 * 640) * 640 ** (-0.5) * 8.0)}

def reference(A_x, A_wqkv, A_wo, B_x, B_w_gate, B_w_up, B_w_down, c, w_mod):

    def _A_ref(x, wqkv, wo):
        B, S, D = x.shape
        H = 32
        Dh = D // H
        qkv = (lambda x, *d: x.permute(*d))((x @ wqkv).reshape(B, S, 3, H, Dh), 2, 0, 3, 1, 4)
        q, k, v = (qkv[0], qkv[1], qkv[2])
        scores = torch.einsum('bhqd,bhkd->bhqk', q, k) * Dh ** (-0.5)
        p = _softmax(scores, axis=-1)
        o = torch.einsum('bhqk,bhkd->bhqd', p, v)
        return (lambda x, *d: x.permute(*d))(o, 0, 2, 1, 3).reshape(B, S, D) @ wo

    def _B_ref(x, w_gate, w_up, w_down):
        g = torch.einsum('bsd,df->bsf', x, w_gate)
        u = torch.einsum('bsd,df->bsf', x, w_up)
        h = _sigmoid(g) * u
        return torch.einsum('bsf,fd->bsd', h, w_down)
    x = A_x
    mod = (_silu(c) @ w_mod).reshape(c.shape[0], 6, 1, -1)
    sa, ca, ga, sb, cb, gb = (mod[:, 0].clone(), mod[:, 1].clone(), mod[:, 2].clone(), mod[:, 3].clone(), mod[:, 4].clone(), mod[:, 5].clone())
    h = _layernorm(x, axis=-1) * (1 + ca) + sa
    x = x + ga * _A_ref(h, A_wqkv, A_wo)
    h = _layernorm(x, axis=-1) * (1 + cb) + sb
    x = x + gb * _B_ref(h, B_w_gate, B_w_up, B_w_down)
    return x
```

```asm
; @launch grid=(256,1,1) block=(512,1,1) lds=163840
.amdgcn_target "amdgcn-amd-amdhsa--gfx950"
.text
.globl adaLN_cond__mha_block__glu_gated_glu__prompt_kernel
.p2align 8
.type adaLN_cond__mha_block__glu_gated_glu__prompt_kernel,@function
adaLN_cond__mha_block__glu_gated_glu__prompt_kernel:
    s_cmpk_ge_u32 s2, 256
    s_cbranch_scc1 adaLN_cond__mha_block__glu_gated_glu__prompt_kernel_end2
    s_load_dwordx16 s[64:79], s[0:1], 0
    s_load_dwordx8 s[80:87], s[0:1], 64
    v_lshrrev_b32 v1, 6, v0
    v_and_b32 v0, 63, v0
    v_readfirstlane_b32 s3, v1
    s_and_b32 s4, s2, 7
    s_lshr_b32 s5, s2, 3
    s_cmp_lg_u32 s3, 0
    s_cbranch_scc1 pf_1
    s_getpc_b64 s[62:63]
pf_1pc:
    s_lshl_b32 s29, s5, 11
    v_lshl_add_u32 v1, v0, 7, s29
    v_cmp_gt_u32 vcc, adaLN_cond__mha_block__glu_gated_glu__prompt_kernel_end2-pf_1pc, v1
    s_and_b32 exec_lo, vcc_lo, 0xffff
    s_mov_b32 exec_hi, 0
    s_cbranch_execz pf_1x
    global_load_dword v253, v1, s[62:63]
pf_1x:
    s_mov_b64 exec, -1
pf_1:
    s_cmpk_ge_u32 s2, 240
    s_cbranch_scc1 helper_entry
    s_waitcnt lgkmcnt(0)
    s_mov_b32 s8, s86
    s_mov_b32 s9, s87
    s_mov_b32 s10, 0x2400000
    s_mov_b32 s11, 0x20000
    s_lshr_b32 s24, s4, 1
    s_lshl_b32 s24, s24, 2
    s_and_b32 s30, s4, 1
    s_and_b32 s29, s5, 3
    s_lshr_b32 s25, s5, 2
    s_lshl3_add_u32 s25, s30, s25
    s_cmp_lt_u32 s5, 28
    s_cbranch_scc1 B_id_3
    s_mov_b32 s25, 7
    s_lshl1_add_u32 s29, s30, s29
B_id_3:
    s_add_u32 s24, s24, s29
    s_cmp_lt_u32 s3, 4
    s_cselect_b32 s101, 1, 0
    s_and_b32 s26, s3, 3
    s_lshr_b32 s27, s3, 2
    s_mul_i32 s28, s25, 52
    s_lshr_b32 s28, s28, 8
    s_add_u32 s29, s24, s25
    s_mul_i32 s30, s29, 52
    s_lshr_b32 s30, s30, 8
    s_mul_i32 s30, s30, 5
    s_sub_u32 s57, s29, s30
    s_mov_b32 s20, s64
    s_mov_b32 s21, s65
    s_mov_b32 s22, 0x280000
    s_mov_b32 s23, 0x20000
    s_mul_i32 s31, s3, 20480
    s_lshl2_add_u32 s42, s24, s26
    s_mul_i32 s42, s42, 40960
    s_mul_i32 s29, s27, 640
    s_add_u32 s42, s42, s29
    s_mov_b32 s16, s66
    s_mov_b32 s17, s67
    s_mov_b32 s18, 0x0
    s_mov_b32 s19, 0x20000
    s_cmp_lg_u32 s3, 0
    s_cbranch_scc1 B_t_4
    s_cmp_ge_u32 s5, 27
    s_cbranch_scc1 B_t_4
    s_mov_b32 s16, s80
    s_mov_b32 s17, s81
    s_mov_b32 s18, 0x4b0000
    s_mov_b32 s19, 0x20000
    s_and_b32 s29, s4, 1
    s_mul_i32 s29, s29, 320
    s_mul_i32 s30, s5, 12
    s_add_u32 s29, s29, s30
    s_mul_i32 s29, s29, 7680
    s_lshr_b32 s30, s4, 1
    s_mul_i32 s30, s30, 640
    s_add_u32 s29, s29, s30
    v_mul_u32_u24 v1, 13108, v0
    v_lshrrev_b32 v1, 16, v1
    v_mul_u32_u24 v1, 7040, v1
    v_lshl_add_u32 v1, v0, 7, v1
    s_mov_b32 exec_hi, 0x0fffffff
    buffer_load_dword v252, v1, s[16:19], s29 offen
    s_mov_b64 exec, -1
B_t_4:
    s_lshl_b32 s59, s57, 7
    v_lshrrev_b32 v1, 3, v0
    v_mul_u32_u24 v231, 1280, v1
    v_lshrrev_b32 v1, 4, v0
    v_and_b32 v15, 7, v0
    v_xor_b32 v1, v1, v15
    v_lshl_add_u32 v231, v1, 4, v231
    v_xor_b32 v232, 64, v231
    s_mov_b32 s12, s66
    s_mov_b32 s13, s67
    s_mov_b32 s14, 0x258000
    s_mov_b32 s15, 0x20000
    s_cmp_eq_u32 s101, 1
    s_cbranch_scc1 B_is_5
B_su_6:
    v_lshrrev_b32 v1, 3, v0
    v_mul_u32_u24 v7, 3840, v1
    v_bfe_u32 v1, v0, 4, 1
    v_lshlrev_b32 v1, 2, v1
    v_and_b32 v14, 7, v0
    v_xor_b32 v1, v1, v14
    v_lshl_add_u32 v7, v1, 4, v7
    s_mul_i32 s30, s27, 1228800
    s_lshl_b32 s29, s25, 8
    s_add_u32 s30, s30, s29
    s_lshl_b32 s29, s27, 7
    s_add_u32 s33, s30, s29
    s_xor_b32 s29, s29, 128
    s_add_u32 s32, s30, s29
    s_mul_i32 s31, s3, 20480
    s_mov_b32 s19, 0x20000
    s_cmpk_ge_u32 s2, 108
    s_cbranch_scc1 P_w_9
    s_mov_b32 s44, 0
    s_mul_i32 s45, s2, 2428
    s_lshr_b32 s45, s45, 16
    s_mul_i32 s46, s45, 27
    s_sub_u32 s46, s2, s46
    s_cmp_ge_u32 s3, 4
    s_cselect_b32 s16, s74, s72
    s_cselect_b32 s17, s75, s73
    s_mov_b32 s18, 2211840
    v_lshrrev_b32 v12, 3, v0
    v_mul_u32_u24 v10, 3456, v12
    v_bfe_u32 v12, v0, 4, 1
    s_and_b32 s49, s3, 1
    v_lshl_or_b32 v12, s49, 1, v12
    v_lshlrev_b32 v12, 1, v12
    v_and_b32 v11, 7, v0
    v_xor_b32 v12, v12, v11
    v_lshl_add_u32 v224, v12, 4, v10
    v_add_u32 v225, 110592, v224
    v_add_u32 v226, 221184, v224
    v_add_u32 v227, 331776, v224
    v_add_u32 v228, 442368, v224
    v_lshrrev_b32 v12, 3, v0
    v_lshl_add_u32 v12, v12, 5, v11
    v_mul_u32_u24 v229, 3456, v12
    s_and_b32 s48, s3, 3
    s_lshl_b32 s48, s48, 3
    s_mul_i32 s49, s45, 160
    s_add_u32 s48, s48, s49
    s_mul_i32 s48, s48, 3456
    s_lshl_b32 s49, s46, 7
    s_add_u32 s48, s48, s49
    s_branch P_ie_10
P_w_9:
    s_mov_b32 s44, 1
    s_cmpk_ge_u32 s2, 162
    s_cselect_b32 s16, s68, s76
    s_cselect_b32 s17, s69, s77
    s_cbranch_scc1 P_wo_12
    s_mov_b32 s18, 2211840
    s_sub_u32 s45, s2, 108
    s_mov_b32 s46, 27
    s_mov_b32 s47, 27262976
    s_lshl_b32 s48, s45, 5
    s_mov_b32 s50, 16
    s_mov_b32 s51, 8
    s_mov_b32 s52, 4
    s_branch P_j_14
P_wo_12:
    s_mov_b32 s18, 819200
    s_sub_u32 s45, s2, 162
    s_mov_b32 s46, 10
    s_mov_b32 s47, 26214400
    s_cmp_ge_u32 s45, 20
    s_cbranch_scc1 P_n_11
    s_cmp_ge_u32 s45, 16
    s_cbranch_scc1 P_wo2_13
    s_mul_i32 s48, s45, 40
    s_mov_b32 s50, 20
    s_mov_b32 s51, 4
    s_mov_b32 s52, 8
    s_branch P_j_14
P_wo2_13:
    s_mul_i32 s48, s45, 160
    s_sub_u32 s48, s48, 2544
    s_mov_b32 s50, 80
    s_mov_b32 s51, 40
    s_mov_b32 s52, 20
P_j_14:
    s_lshr_b32 s49, s3, 2
    s_mul_i32 s49, s49, s50
    s_add_u32 s48, s48, s49
    s_bfe_u32 s49, s3, 0x10001
    s_mul_i32 s49, s49, s51
    s_add_u32 s48, s48, s49
    s_and_b32 s49, s3, 1
    s_mul_i32 s49, s49, s52
    s_add_u32 s48, s48, s49
    s_mul_i32 s48, s48, 1280
    v_add_u32 v10, 0, v0
    v_mul_u32_u24 v11, 52429, v10
    v_lshrrev_b32 v11, 22, v11
    v_lshlrev_b32 v12, 2, v11
    v_mul_u32_u24 v13, 80, v11
    v_sub_u32 v10, v10, v13
    v_xor_b32 v10, v10, v12
    v_add_u32 v10, v10, v13
    v_lshlrev_b32 v224, 4, v10
    v_add_u32 v10, 64, v0
    v_mul_u32_u24 v11, 52429, v10
    v_lshrrev_b32 v11, 22, v11
    v_lshlrev_b32 v12, 2, v11
    v_mul_u32_u24 v13, 80, v11
    v_sub_u32 v10, v10, v13
    v_xor_b32 v10, v10, v12
    v_add_u32 v10, v10, v13
    v_lshlrev_b32 v225, 4, v10
    v_add_u32 v10, 128, v0
    v_mul_u32_u24 v11, 52429, v10
    v_lshrrev_b32 v11, 22, v11
    v_lshlrev_b32 v12, 2, v11
    v_mul_u32_u24 v13, 80, v11
    v_sub_u32 v10, v10, v13
    v_xor_b32 v10, v10, v12
    v_add_u32 v10, v10, v13
    v_lshlrev_b32 v226, 4, v10
    v_add_u32 v10, 192, v0
    v_mul_u32_u24 v11, 52429, v10
    v_lshrrev_b32 v11, 22, v11
    v_lshlrev_b32 v12, 2, v11
    v_mul_u32_u24 v13, 80, v11
    v_sub_u32 v10, v10, v13
    v_xor_b32 v10, v10, v12
    v_add_u32 v10, v10, v13
    v_lshlrev_b32 v227, 4, v10
    v_add_u32 v10, 256, v0
    v_mul_u32_u24 v11, 52429, v10
    v_lshrrev_b32 v11, 22, v11
    v_lshlrev_b32 v12, 2, v11
    v_mul_u32_u24 v13, 80, v11
    v_sub_u32 v10, v10, v13
    v_xor_b32 v10, v10, v12
    v_add_u32 v10, v10, v13
    v_lshlrev_b32 v228, 4, v10
    v_lshlrev_b32 v229, 7, v0
    s_branch P_ie_10
P_n_11:
    s_cmp_ge_u32 s45, 60
    s_cbranch_scc1 P_n2_15
    s_mov_b32 s44, 3
    s_mov_b32 s16, s80
    s_mov_b32 s17, s81
    s_mov_b32 s18, 4915200
    s_sub_u32 s45, s45, 20
    s_and_b32 s46, s45, 1
    s_lshr_b32 s45, s45, 1
    s_cmp_ge_u32 s45, 10
    s_cselect_b32 s48, 2560, 0
    s_lshl_b32 s49, s45, 7
    s_add_u32 s48, s48, s49
    s_mul_i32 s49, s46, 40
    s_add_u32 s49, s49, s3
    s_mul_i32 s49, s49, 61440
    s_add_u32 s48, s48, s49
    s_add_u32 s48, s48, 2560
    v_lshrrev_b32 v12, 3, v0
    v_mul_u32_u24 v10, 7680, v12
    v_and_b32 v11, 7, v0
    v_lshl_add_u32 v12, v12, 6, v11
    v_mul_u32_u24 v229, 7680, v12
    v_bfe_u32 v12, v0, 4, 1
    s_and_b32 s49, s3, 1
    v_lshl_or_b32 v12, s49, 1, v12
    v_lshlrev_b32 v12, 1, v12
    v_xor_b32 v12, v12, v11
    v_lshl_add_u32 v224, v12, 4, v10
    v_add_u32 v225, 491520, v224
    v_add_u32 v226, 983040, v224
    v_add_u32 v227, 1474560, v224
    v_add_u32 v228, 1966080, v224
    s_branch P_ie_10
P_n2_15:
    s_mov_b32 s44, 2
    s_mov_b32 s48, 0
    v_mov_b32 v224, 0x7f000000
    v_mov_b32 v225, 0x7f000000
    v_mov_b32 v226, 0x7f000000
    v_mov_b32 v227, 0x7f000000
    v_mov_b32 v228, 0x7f000000
    v_mov_b32 v229, 0x7f000000
P_ie_10:
    s_lshr_b32 s36, s24, 1
    s_and_b32 s37, s24, 1
    s_lshl_b32 s37, s37, 2
    s_add_u32 s37, s37, s26
    v_lshrrev_b32 v10, 5, v0
    v_and_b32 v11, 31, v0
    s_cmp_eq_u32 s28, 2
    s_cbranch_scc1 B_av_16
    s_lshl_b32 s38, 10240, s28
    s_mul_i32 s39, s28, 3145728
    s_add_u32 s39, s39, 4194304
    s_mul_i32 s36, s36, s38
    s_add_u32 s39, s39, s36
    s_lshl_b32 s38, s38, 3
    v_and_b32 v12, 0x13, v11
    v_bfe_u32 v13, v11, 2, 1
    v_lshl_or_b32 v12, v13, 3, v12
    v_bfe_u32 v13, v11, 3, 1
    v_lshl_or_b32 v12, v13, 2, v12
    s_cmp_eq_u32 s28, 0
    s_cselect_b64 vcc, -1, 0
    v_cndmask_b32 v11, v12, v11, vcc
    s_lshr_b32 s40, s37, 1
    s_mul_i32 s40, s40, 2560
    s_and_b32 s41, s37, 1
    s_lshl_b32 s41, s41, 8
    s_add_u32 s40, s40, s41
    s_add_u32 s39, s39, s40
    v_lshlrev_b32 v11, 3, v11
    s_mul_i32 s40, s28, 5
    s_sub_u32 s40, s25, s40
    s_lshl_b32 s40, s40, 5
    s_lshl_b32 s41, s27, 4
    s_add_u32 s40, s40, s41
    v_add_u32 v10, s40, v10
    s_sub_u32 s38, s38, 2560
    v_lshl_add_u32 v11, v10, 9, v11
    v_add_u32 v14, 0, v10
    v_mul_u32_u24 v15, 52429, v14
    v_lshrrev_b32 v15, 18, v15
    v_mul_lo_u32 v15, v15, s38
    v_add_u32 v216, v15, v11
    s_mov_b32 s29, 1024
    v_add_u32 v14, 2, v10
    v_mul_u32_u24 v15, 52429, v14
    v_lshrrev_b32 v15, 18, v15
    v_mul_lo_u32 v15, v15, s38
    v_add3_u32 v217, v15, v11, s29
    s_mov_b32 s29, 2048
    v_add_u32 v14, 4, v10
    v_mul_u32_u24 v15, 52429, v14
    v_lshrrev_b32 v15, 18, v15
    v_mul_lo_u32 v15, v15, s38
    v_add3_u32 v218, v15, v11, s29
    s_mov_b32 s29, 3072
    v_add_u32 v14, 6, v10
    v_mul_u32_u24 v15, 52429, v14
    v_lshrrev_b32 v15, 18, v15
    v_mul_lo_u32 v15, v15, s38
    v_add3_u32 v219, v15, v11, s29
    s_mov_b32 s29, 4096
    v_add_u32 v14, 8, v10
    v_mul_u32_u24 v15, 52429, v14
    v_lshrrev_b32 v15, 18, v15
    v_mul_lo_u32 v15, v15, s38
    v_add3_u32 v220, v15, v11, s29
    s_mov_b32 s29, 5120
    v_add_u32 v14, 10, v10
    v_mul_u32_u24 v15, 52429, v14
    v_lshrrev_b32 v15, 18, v15
    v_mul_lo_u32 v15, v15, s38
    v_add3_u32 v221, v15, v11, s29
    s_mov_b32 s29, 6144
    v_add_u32 v14, 12, v10
    v_mul_u32_u24 v15, 52429, v14
    v_lshrrev_b32 v15, 18, v15
    v_mul_lo_u32 v15, v15, s38
    v_add3_u32 v222, v15, v11, s29
    s_mov_b32 s29, 7168
    v_add_u32 v14, 14, v10
    v_mul_u32_u24 v15, 52429, v14
    v_lshrrev_b32 v15, 18, v15
    v_mul_lo_u32 v15, v15, s38
    v_add3_u32 v223, v15, v11, s29
    s_mov_b32 s29, 8192
    s_branch B_ae_17
B_av_16:
    s_mul_i32 s36, s36, 20480
    s_mul_i32 s40, s37, 1280
    s_add_u32 s39, s36, s40
    s_add_u32 s39, s39, 7350272
    s_sub_u32 s40, s25, 10
    s_lshl_b32 s40, s40, 7
    s_lshl_b32 s41, s27, 6
    s_add_u32 s40, s40, s41
    s_mov_b32 s38, 163840
    v_mov_b32 v218, 0x7f000000
    v_mov_b32 v219, 0x7f000000
    v_mov_b32 v220, 0x7f000000
    v_mov_b32 v221, 0x7f000000
    v_mov_b32 v222, 0x7f000000
    v_mov_b32 v223, 0x7f000000
    v_add_u32 v14, s40, v11
    v_mul_u32_u24 v15, 52429, v14
    v_lshrrev_b32 v15, 20, v15
    v_mul_u32_u24 v1, 20, v15
    v_sub_u32 v14, v14, v1
    v_lshrrev_b32 v1, 4, v14
    v_xor_b32 v1, v1, v10
    v_lshl_add_u32 v14, v14, 1, v1
    v_lshlrev_b32 v216, 4, v14
    v_mul_lo_u32 v15, v15, s38
    v_add_u32 v216, v216, v15
    v_add_u32 v14, s40, v11
    v_add_u32 v14, 32, v14
    v_mul_u32_u24 v15, 52429, v14
    v_lshrrev_b32 v15, 20, v15
    v_mul_u32_u24 v1, 20, v15
    v_sub_u32 v14, v14, v1
    v_lshrrev_b32 v1, 4, v14
    v_xor_b32 v1, v1, v10
    v_lshl_add_u32 v14, v14, 1, v1
    v_lshlrev_b32 v217, 4, v14
    v_mul_lo_u32 v15, v15, s38
    v_add_u32 v217, v217, v15
B_ae_17:
    v_bfe_u32 v1, v0, 2, 2
    v_lshrrev_b32 v10, 5, v0
    v_lshl_add_u32 v11, v10, 3, v1
    v_lshlrev_b32 v11, 7, v11
    v_lshrrev_b32 v1, 1, v1
    v_lshlrev_b32 v1, 6, v1
    v_add_u32 v11, v11, v1
    v_bfe_u32 v1, v0, 4, 1
    v_lshl_add_u32 v11, v1, 5, v11
    v_and_b32 v1, 3, v0
    v_lshl_add_u32 v11, v1, 3, v11
    s_mul_i32 s29, s27, 81920
    v_add_u32 v2, s29, v11
    v_xor_b32 v3, 64, v2
    v_add_u32 v4, 61440, v2
    v_add_u32 v5, 61440, v3
    s_mul_i32 s29, s27, 81920
    s_add_u32 s29, s29, 77824
    v_lshlrev_b32 v10, 5, v10
    v_add_u32 v6, s29, v10
    v_lshlrev_b32 v9, 4, v0
    s_lshl_b32 s29, s26, 6
    v_add_u32 v14, s29, v0
    v_cmp_gt_u32 vcc, 160, v14
    v_lshrrev_b32 v15, 4, v14
    s_mov_b64 s[54:55], vcc
    v_cmp_le_u32 vcc, 5, v15
    v_add_u32 v15, s57, v15
    v_and_b32 v212, 15, v14
    v_cndmask_b32 v1, 5, 10, vcc
    v_cmp_le_u32 vcc, v1, v15
    v_subrev_u32 v1, 5, v15
    v_mov_b32 v213, 0x7f000000
    v_cndmask_b32 v15, v15, v1, vcc
    v_lshl_add_u32 v15, v15, 4, v212
    v_lshlrev_b32 v15, 4, v15
    v_cndmask_b32 v15, v213, v15, s[54:55]
    v_cmp_le_u32 vcc, 80, v14
    v_lshlrev_b32 v14, 4, v14
    v_add_u32 v14, 77824, v14
    v_add_u32 v1, 80640, v14
    v_cndmask_b32 v14, v14, v1, vcc
    v_and_b32 v1, 31, v0
    v_lshlrev_b32 v10, 7, v1
    v_bfe_u32 v1, v0, 1, 3
    v_lshrrev_b32 v11, 5, v0
    v_xor_b32 v1, v1, v11
    v_lshl_add_u32 v10, v1, 4, v10
    v_add_u32 v10, s31, v10
    v_xor_b32 v11, 32, v10
    v_xor_b32 v12, 64, v10
    v_xor_b32 v13, 96, v10
    v_mov_b32 v208, 0
    v_mov_b32 v209, 0
    v_mov_b32 v210, 0
    v_mov_b32 v211, 0
    v_mov_b32 v212, 0
    v_mov_b32 v213, 0
    s_mov_b32 s7, 0xffff0000
    s_mov_b32 s6, 0x3f803f80
    s_cmp_eq_u32 s101, 1
    s_cbranch_scc1 B_pr_7
B_is_5:
    s_add_u32 s62, s42, s59
    s_add_u32 s59, s59, 128
    s_cmp_eq_u32 s59, 640
    s_cselect_b32 s59, 0, s59
    s_add_u32 m0, s31, 0
    s_add_u32 s43, s62, 0
    buffer_load_dwordx4 v231, s[20:23], s43 offen lds
    s_add_u32 m0, s31, 1024
    s_add_u32 s43, s62, 10240
    buffer_load_dwordx4 v232, s[20:23], s43 offen lds
    s_add_u32 m0, s31, 2048
    s_add_u32 s43, s62, 20480
    buffer_load_dwordx4 v231, s[20:23], s43 offen lds
    s_add_u32 m0, s31, 3072
    s_add_u32 s43, s62, 30720
    buffer_load_dwordx4 v232, s[20:23], s43 offen lds
    s_add_u32 s62, s42, s59
    s_add_u32 s59, s59, 128
    s_cmp_eq_u32 s59, 640
    s_cselect_b32 s59, 0, s59
    s_add_u32 m0, s31, 4096
    s_add_u32 s43, s62, 0
    buffer_load_dwordx4 v231, s[20:23], s43 offen lds
    s_add_u32 m0, s31, 5120
    s_add_u32 s43, s62, 10240
    buffer_load_dwordx4 v232, s[20:23], s43 offen lds
    s_add_u32 m0, s31, 6144
    s_add_u32 s43, s62, 20480
    buffer_load_dwordx4 v231, s[20:23], s43 offen lds
    s_add_u32 m0, s31, 7168
    s_add_u32 s43, s62, 30720
    buffer_load_dwordx4 v232, s[20:23], s43 offen lds
    s_add_u32 s62, s42, s59
    s_add_u32 s59, s59, 128
    s_cmp_eq_u32 s59, 640
    s_cselect_b32 s59, 0, s59
    s_add_u32 m0, s31, 8192
    s_add_u32 s43, s62, 0
    buffer_load_dwordx4 v231, s[20:23], s43 offen lds
    s_add_u32 m0, s31, 9216
    s_add_u32 s43, s62, 10240
    buffer_load_dwordx4 v232, s[20:23], s43 offen lds
    s_add_u32 m0, s31, 10240
    s_add_u32 s43, s62, 20480
    buffer_load_dwordx4 v231, s[20:23], s43 offen lds
    s_add_u32 m0, s31, 11264
    s_add_u32 s43, s62, 30720
    buffer_load_dwordx4 v232, s[20:23], s43 offen lds
    s_add_u32 s62, s42, s59
    s_add_u32 s59, s59, 128
    s_cmp_eq_u32 s59, 640
    s_cselect_b32 s59, 0, s59
    s_add_u32 m0, s31, 12288
    s_add_u32 s43, s62, 0
    buffer_load_dwordx4 v231, s[20:23], s43 offen lds
    s_add_u32 m0, s31, 13312
    s_add_u32 s43, s62, 10240
    buffer_load_dwordx4 v232, s[20:23], s43 offen lds
    s_add_u32 m0, s31, 14336
    s_add_u32 s43, s62, 20480
    buffer_load_dwordx4 v231, s[20:23], s43 offen lds
    s_add_u32 m0, s31, 15360
    s_add_u32 s43, s62, 30720
    buffer_load_dwordx4 v232, s[20:23], s43 offen lds
    s_add_u32 s62, s42, s59
    s_add_u32 s59, s59, 128
    s_cmp_eq_u32 s59, 640
    s_cselect_b32 s59, 0, s59
    s_add_u32 m0, s31, 16384
    s_add_u32 s43, s62, 0
    buffer_load_dwordx4 v231, s[20:23], s43 offen lds
    s_add_u32 m0, s31, 17408
    s_add_u32 s43, s62, 10240
    buffer_load_dwordx4 v232, s[20:23], s43 offen lds
    s_add_u32 m0, s31, 18432
    s_add_u32 s43, s62, 20480
    buffer_load_dwordx4 v231, s[20:23], s43 offen lds
    s_add_u32 m0, s31, 19456
    s_add_u32 s43, s62, 30720
    buffer_load_dwordx4 v232, s[20:23], s43 offen lds
    s_cmp_eq_u32 s101, 1
    s_cbranch_scc1 B_su_6
    s_barrier
B_pr_7:
    s_waitcnt vmcnt(16)
    ds_read_b128 v[176:179], v10 offset:0
    ds_read_b128 v[180:183], v11 offset:0
    ds_read_b128 v[184:187], v12 offset:0
    ds_read_b128 v[188:191], v13 offset:0
    s_waitcnt vmcnt(12)
    ds_read_b128 v[192:195], v10 offset:4096
    ds_read_b128 v[196:199], v11 offset:4096
    ds_read_b128 v[200:203], v12 offset:4096
    ds_read_b128 v[204:207], v13 offset:4096
    s_waitcnt lgkmcnt(4)
    v_dot2c_f32_bf16 v208, s6, v176
    v_lshlrev_b32 v16, 16, v176
    v_dot2c_f32_bf16 v209, v176, v176
    v_and_b32 v17, s7, v176
    v_dot2c_f32_bf16 v210, s6, v177
    v_lshlrev_b32 v18, 16, v177
    v_dot2c_f32_bf16 v211, v177, v177
    v_and_b32 v19, s7, v177
    v_dot2c_f32_bf16 v208, s6, v178
    v_lshlrev_b32 v20, 16, v178
    v_dot2c_f32_bf16 v209, v178, v178
    v_and_b32 v21, s7, v178
    v_dot2c_f32_bf16 v210, s6, v179
    v_lshlrev_b32 v22, 16, v179
    v_dot2c_f32_bf16 v211, v179, v179
    v_and_b32 v23, s7, v179
    v_dot2c_f32_bf16 v208, s6, v180
    v_lshlrev_b32 v24, 16, v180
    v_dot2c_f32_bf16 v209, v180, v180
    v_and_b32 v25, s7, v180
    v_dot2c_f32_bf16 v210, s6, v181
    v_lshlrev_b32 v26, 16, v181
    v_dot2c_f32_bf16 v211, v181, v181
    v_and_b32 v27, s7, v181
    v_dot2c_f32_bf16 v208, s6, v182
    v_lshlrev_b32 v28, 16, v182
    v_dot2c_f32_bf16 v209, v182, v182
    v_and_b32 v29, s7, v182
    v_dot2c_f32_bf16 v210, s6, v183
    v_lshlrev_b32 v30, 16, v183
    v_dot2c_f32_bf16 v211, v183, v183
    v_and_b32 v31, s7, v183
    v_dot2c_f32_bf16 v208, s6, v184
    v_lshlrev_b32 v32, 16, v184
    v_dot2c_f32_bf16 v209, v184, v184
    v_and_b32 v33, s7, v184
    v_dot2c_f32_bf16 v210, s6, v185
    v_lshlrev_b32 v34, 16, v185
    v_dot2c_f32_bf16 v211, v185, v185
    v_and_b32 v35, s7, v185
    v_dot2c_f32_bf16 v208, s6, v186
    v_lshlrev_b32 v36, 16, v186
    v_dot2c_f32_bf16 v209, v186, v186
    v_and_b32 v37, s7, v186
    v_dot2c_f32_bf16 v210, s6, v187
    v_lshlrev_b32 v38, 16, v187
    v_dot2c_f32_bf16 v211, v187, v187
    v_and_b32 v39, s7, v187
    v_dot2c_f32_bf16 v208, s6, v188
    v_lshlrev_b32 v40, 16, v188
    v_dot2c_f32_bf16 v209, v188, v188
    v_and_b32 v41, s7, v188
    v_dot2c_f32_bf16 v210, s6, v189
    v_lshlrev_b32 v42, 16, v189
    v_dot2c_f32_bf16 v211, v189, v189
    v_and_b32 v43, s7, v189
    v_dot2c_f32_bf16 v208, s6, v190
    v_lshlrev_b32 v44, 16, v190
    v_dot2c_f32_bf16 v209, v190, v190
    v_and_b32 v45, s7, v190
    v_dot2c_f32_bf16 v210, s6, v191
    v_lshlrev_b32 v46, 16, v191
    v_dot2c_f32_bf16 v211, v191, v191
    v_and_b32 v47, s7, v191
    s_waitcnt vmcnt(8)
    ds_read_b128 v[176:179], v10 offset:8192
    ds_read_b128 v[180:183], v11 offset:8192
    ds_read_b128 v[184:187], v12 offset:8192
    ds_read_b128 v[188:191], v13 offset:8192
    s_waitcnt lgkmcnt(4)
    v_dot2c_f32_bf16 v208, s6, v192
    v_lshlrev_b32 v48, 16, v192
    v_dot2c_f32_bf16 v209, v192, v192
    v_and_b32 v49, s7, v192
    v_dot2c_f32_bf16 v210, s6, v193
    v_lshlrev_b32 v50, 16, v193
    v_dot2c_f32_bf16 v211, v193, v193
    v_and_b32 v51, s7, v193
    v_dot2c_f32_bf16 v208, s6, v194
    v_lshlrev_b32 v52, 16, v194
    v_dot2c_f32_bf16 v209, v194, v194
    v_and_b32 v53, s7, v194
    v_dot2c_f32_bf16 v210, s6, v195
    v_lshlrev_b32 v54, 16, v195
    v_dot2c_f32_bf16 v211, v195, v195
    v_and_b32 v55, s7, v195
    v_dot2c_f32_bf16 v208, s6, v196
    v_lshlrev_b32 v56, 16, v196
    v_dot2c_f32_bf16 v209, v196, v196
    v_and_b32 v57, s7, v196
    v_dot2c_f32_bf16 v210, s6, v197
    v_lshlrev_b32 v58, 16, v197
    v_dot2c_f32_bf16 v211, v197, v197
    v_and_b32 v59, s7, v197
    v_dot2c_f32_bf16 v208, s6, v198
    v_lshlrev_b32 v60, 16, v198
    v_dot2c_f32_bf16 v209, v198, v198
    v_and_b32 v61, s7, v198
    v_dot2c_f32_bf16 v210, s6, v199
    v_lshlrev_b32 v62, 16, v199
    v_dot2c_f32_bf16 v211, v199, v199
    v_and_b32 v63, s7, v199
    v_dot2c_f32_bf16 v208, s6, v200
    v_lshlrev_b32 v64, 16, v200
    v_dot2c_f32_bf16 v209, v200, v200
    v_and_b32 v65, s7, v200
    v_dot2c_f32_bf16 v210, s6, v201
    v_lshlrev_b32 v66, 16, v201
    v_dot2c_f32_bf16 v211, v201, v201
    v_and_b32 v67, s7, v201
    v_dot2c_f32_bf16 v208, s6, v202
    v_lshlrev_b32 v68, 16, v202
    v_dot2c_f32_bf16 v209, v202, v202
    v_and_b32 v69, s7, v202
    v_dot2c_f32_bf16 v210, s6, v203
    v_lshlrev_b32 v70, 16, v203
    v_dot2c_f32_bf16 v211, v203, v203
    v_and_b32 v71, s7, v203
    v_dot2c_f32_bf16 v208, s6, v204
    v_lshlrev_b32 v72, 16, v204
    v_dot2c_f32_bf16 v209, v204, v204
    v_and_b32 v73, s7, v204
    v_dot2c_f32_bf16 v210, s6, v205
    v_lshlrev_b32 v74, 16, v205
    v_dot2c_f32_bf16 v211, v205, v205
    v_and_b32 v75, s7, v205
    v_dot2c_f32_bf16 v208, s6, v206
    v_lshlrev_b32 v76, 16, v206
    v_dot2c_f32_bf16 v209, v206, v206
    v_and_b32 v77, s7, v206
    v_dot2c_f32_bf16 v210, s6, v207
    v_lshlrev_b32 v78, 16, v207
    v_dot2c_f32_bf16 v211, v207, v207
    v_and_b32 v79, s7, v207
    s_waitcnt vmcnt(4)
    ds_read_b128 v[192:195], v10 offset:12288
    ds_read_b128 v[196:199], v11 offset:12288
    ds_read_b128 v[200:203], v12 offset:12288
    ds_read_b128 v[204:207], v13 offset:12288
    s_waitcnt lgkmcnt(4)
    v_dot2c_f32_bf16 v208, s6, v176
    v_lshlrev_b32 v80, 16, v176
    v_dot2c_f32_bf16 v209, v176, v176
    v_and_b32 v81, s7, v176
    v_dot2c_f32_bf16 v210, s6, v177
    v_lshlrev_b32 v82, 16, v177
    v_dot2c_f32_bf16 v211, v177, v177
    v_and_b32 v83, s7, v177
    v_dot2c_f32_bf16 v208, s6, v178
    v_lshlrev_b32 v84, 16, v178
    v_dot2c_f32_bf16 v209, v178, v178
    v_and_b32 v85, s7, v178
    v_dot2c_f32_bf16 v210, s6, v179
    v_lshlrev_b32 v86, 16, v179
    v_dot2c_f32_bf16 v211, v179, v179
    v_and_b32 v87, s7, v179
    v_dot2c_f32_bf16 v208, s6, v180
    v_lshlrev_b32 v88, 16, v180
    v_dot2c_f32_bf16 v209, v180, v180
    v_and_b32 v89, s7, v180
    v_dot2c_f32_bf16 v210, s6, v181
    v_lshlrev_b32 v90, 16, v181
    v_dot2c_f32_bf16 v211, v181, v181
    v_and_b32 v91, s7, v181
    v_dot2c_f32_bf16 v208, s6, v182
    v_lshlrev_b32 v92, 16, v182
    v_dot2c_f32_bf16 v209, v182, v182
    v_and_b32 v93, s7, v182
    v_dot2c_f32_bf16 v210, s6, v183
    v_lshlrev_b32 v94, 16, v183
    v_dot2c_f32_bf16 v211, v183, v183
    v_and_b32 v95, s7, v183
    v_dot2c_f32_bf16 v208, s6, v184
    v_lshlrev_b32 v96, 16, v184
    v_dot2c_f32_bf16 v209, v184, v184
    v_and_b32 v97, s7, v184
    v_dot2c_f32_bf16 v210, s6, v185
    v_lshlrev_b32 v98, 16, v185
    v_dot2c_f32_bf16 v211, v185, v185
    v_and_b32 v99, s7, v185
    v_dot2c_f32_bf16 v208, s6, v186
    v_lshlrev_b32 v100, 16, v186
    v_dot2c_f32_bf16 v209, v186, v186
    v_and_b32 v101, s7, v186
    v_dot2c_f32_bf16 v210, s6, v187
    v_lshlrev_b32 v102, 16, v187
    v_dot2c_f32_bf16 v211, v187, v187
    v_and_b32 v103, s7, v187
    v_dot2c_f32_bf16 v208, s6, v188
    v_lshlrev_b32 v104, 16, v188
    v_dot2c_f32_bf16 v209, v188, v188
    v_and_b32 v105, s7, v188
    v_dot2c_f32_bf16 v210, s6, v189
    v_lshlrev_b32 v106, 16, v189
    v_dot2c_f32_bf16 v211, v189, v189
    v_and_b32 v107, s7, v189
    v_dot2c_f32_bf16 v208, s6, v190
    v_lshlrev_b32 v108, 16, v190
    v_dot2c_f32_bf16 v209, v190, v190
    v_and_b32 v109, s7, v190
    v_dot2c_f32_bf16 v210, s6, v191
    v_lshlrev_b32 v110, 16, v191
    v_dot2c_f32_bf16 v211, v191, v191
    v_and_b32 v111, s7, v191
    s_waitcnt vmcnt(0)
    ds_read_b128 v[176:179], v10 offset:16384
    ds_read_b128 v[180:183], v11 offset:16384
    ds_read_b128 v[184:187], v12 offset:16384
    ds_read_b128 v[188:191], v13 offset:16384
    s_waitcnt lgkmcnt(4)
    v_dot2c_f32_bf16 v208, s6, v192
    v_lshlrev_b32 v112, 16, v192
    v_dot2c_f32_bf16 v209, v192, v192
    v_and_b32 v113, s7, v192
    v_dot2c_f32_bf16 v210, s6, v193
    v_lshlrev_b32 v114, 16, v193
    v_dot2c_f32_bf16 v211, v193, v193
    v_and_b32 v115, s7, v193
    v_dot2c_f32_bf16 v208, s6, v194
    v_lshlrev_b32 v116, 16, v194
    v_dot2c_f32_bf16 v209, v194, v194
    v_and_b32 v117, s7, v194
    v_dot2c_f32_bf16 v210, s6, v195
    v_lshlrev_b32 v118, 16, v195
    v_dot2c_f32_bf16 v211, v195, v195
    v_and_b32 v119, s7, v195
    v_dot2c_f32_bf16 v208, s6, v196
    v_lshlrev_b32 v120, 16, v196
    v_dot2c_f32_bf16 v209, v196, v196
    v_and_b32 v121, s7, v196
    v_dot2c_f32_bf16 v210, s6, v197
    v_lshlrev_b32 v122, 16, v197
    v_dot2c_f32_bf16 v211, v197, v197
    v_and_b32 v123, s7, v197
    v_dot2c_f32_bf16 v208, s6, v198
    v_lshlrev_b32 v124, 16, v198
    v_dot2c_f32_bf16 v209, v198, v198
    v_and_b32 v125, s7, v198
    v_dot2c_f32_bf16 v210, s6, v199
    v_lshlrev_b32 v126, 16, v199
    v_dot2c_f32_bf16 v211, v199, v199
    v_and_b32 v127, s7, v199
    v_dot2c_f32_bf16 v208, s6, v200
    v_lshlrev_b32 v128, 16, v200
    v_dot2c_f32_bf16 v209, v200, v200
    v_and_b32 v129, s7, v200
    v_dot2c_f32_bf16 v210, s6, v201
    v_lshlrev_b32 v130, 16, v201
    v_dot2c_f32_bf16 v211, v201, v201
    v_and_b32 v131, s7, v201
    v_dot2c_f32_bf16 v208, s6, v202
    v_lshlrev_b32 v132, 16, v202
    v_dot2c_f32_bf16 v209, v202, v202
    v_and_b32 v133, s7, v202
    v_dot2c_f32_bf16 v210, s6, v203
    v_lshlrev_b32 v134, 16, v203
    v_dot2c_f32_bf16 v211, v203, v203
    v_and_b32 v135, s7, v203
    v_dot2c_f32_bf16 v208, s6, v204
    v_lshlrev_b32 v136, 16, v204
    v_dot2c_f32_bf16 v209, v204, v204
    v_and_b32 v137, s7, v204
    v_dot2c_f32_bf16 v210, s6, v205
    v_lshlrev_b32 v138, 16, v205
    v_dot2c_f32_bf16 v211, v205, v205
    v_and_b32 v139, s7, v205
    v_dot2c_f32_bf16 v208, s6, v206
    v_lshlrev_b32 v140, 16, v206
    v_dot2c_f32_bf16 v209, v206, v206
    v_and_b32 v141, s7, v206
    v_dot2c_f32_bf16 v210, s6, v207
    v_lshlrev_b32 v142, 16, v207
    v_dot2c_f32_bf16 v211, v207, v207
    v_and_b32 v143, s7, v207
    s_waitcnt lgkmcnt(0)
    v_dot2c_f32_bf16 v208, s6, v176
    v_lshlrev_b32 v144, 16, v176
    v_dot2c_f32_bf16 v209, v176, v176
    v_and_b32 v145, s7, v176
    v_dot2c_f32_bf16 v210, s6, v177
    v_lshlrev_b32 v146, 16, v177
    v_dot2c_f32_bf16 v211, v177, v177
    v_and_b32 v147, s7, v177
    v_dot2c_f32_bf16 v208, s6, v178
    v_lshlrev_b32 v148, 16, v178
    v_dot2c_f32_bf16 v209, v178, v178
    v_and_b32 v149, s7, v178
    v_dot2c_f32_bf16 v210, s6, v179
    v_lshlrev_b32 v150, 16, v179
    v_dot2c_f32_bf16 v211, v179, v179
    v_and_b32 v151, s7, v179
    v_dot2c_f32_bf16 v208, s6, v180
    v_lshlrev_b32 v152, 16, v180
    v_dot2c_f32_bf16 v209, v180, v180
    v_and_b32 v153, s7, v180
    v_dot2c_f32_bf16 v210, s6, v181
    v_lshlrev_b32 v154, 16, v181
    v_dot2c_f32_bf16 v211, v181, v181
    v_and_b32 v155, s7, v181
    v_dot2c_f32_bf16 v208, s6, v182
    v_lshlrev_b32 v156, 16, v182
    v_dot2c_f32_bf16 v209, v182, v182
    v_and_b32 v157, s7, v182
    v_dot2c_f32_bf16 v210, s6, v183
    v_lshlrev_b32 v158, 16, v183
    v_dot2c_f32_bf16 v211, v183, v183
    v_and_b32 v159, s7, v183
    v_dot2c_f32_bf16 v208, s6, v184
    v_lshlrev_b32 v160, 16, v184
    v_dot2c_f32_bf16 v209, v184, v184
    v_and_b32 v161, s7, v184
    v_dot2c_f32_bf16 v210, s6, v185
    v_lshlrev_b32 v162, 16, v185
    v_dot2c_f32_bf16 v211, v185, v185
    v_and_b32 v163, s7, v185
    v_dot2c_f32_bf16 v208, s6, v186
    v_lshlrev_b32 v164, 16, v186
    v_dot2c_f32_bf16 v209, v186, v186
    v_and_b32 v165, s7, v186
    v_dot2c_f32_bf16 v210, s6, v187
    v_lshlrev_b32 v166, 16, v187
    v_dot2c_f32_bf16 v211, v187, v187
    v_and_b32 v167, s7, v187
    v_dot2c_f32_bf16 v208, s6, v188
    v_lshlrev_b32 v168, 16, v188
    v_dot2c_f32_bf16 v209, v188, v188
    v_and_b32 v169, s7, v188
    v_dot2c_f32_bf16 v210, s6, v189
    v_lshlrev_b32 v170, 16, v189
    v_dot2c_f32_bf16 v211, v189, v189
    v_and_b32 v171, s7, v189
    v_dot2c_f32_bf16 v208, s6, v190
    v_lshlrev_b32 v172, 16, v190
    v_dot2c_f32_bf16 v209, v190, v190
    v_and_b32 v173, s7, v190
    v_dot2c_f32_bf16 v210, s6, v191
    v_lshlrev_b32 v174, 16, v191
    v_dot2c_f32_bf16 v211, v191, v191
    v_and_b32 v175, s7, v191
    s_cmp_eq_u32 s101, 1
    s_cbranch_scc0 B_y_18
    s_barrier
B_y_18:
    s_lshl_b32 s34, s26, 3
    s_lshr_b32 s34, 0x30201000, s34
    s_bitcmp1_b32 s34, 4
    s_cselect_b32 s35, s33, s32
    s_bitcmp1_b32 s34, 5
    s_cselect_b32 s43, 122880, 0
    s_add_u32 s35, s35, s43
    s_and_b32 s34, s34, 15
    s_add_u32 s34, s34, s57
    s_cmp_ge_u32 s34, 5
    s_cselect_b32 s43, 5, 0
    s_sub_u32 s34, s34, s43
    s_mul_i32 s34, s34, 245760
    s_add_u32 s34, s34, s35
    s_add_u32 m0, s31, 0
    s_nop 0
    buffer_load_dwordx4 v7, s[12:15], s34 offen lds
    s_add_u32 m0, s31, 1024
    s_add_u32 s34, s34, 30720
    buffer_load_dwordx4 v7, s[12:15], s34 offen lds
    s_add_u32 m0, s31, 2048
    s_add_u32 s34, s34, 30720
    buffer_load_dwordx4 v7, s[12:15], s34 offen lds
    s_add_u32 m0, s31, 3072
    s_add_u32 s34, s34, 30720
    buffer_load_dwordx4 v7, s[12:15], s34 offen lds
    v_add_f32 v208, v208, v210
    v_add_f32 v210, v209, v211
    v_lshlrev_b32 v12, 2, v0
    v_add_u32 v13, s31, v12
    v_permlane32_swap_b32 v208, v210
    v_add_f32 v208, v208, v210
    ds_write_b32 v13, v208 offset:19456
    s_xor_b32 s29, s3, 4
    s_mul_i32 s29, s29, 20480
    v_add_u32 v10, s29, v12
    v_and_b32 v11, 3, v0
    v_mul_u32_u24 v11, 20480, v11
    v_bfe_u32 v12, v0, 2, 2
    v_lshl_add_u32 v11, v12, 6, v11
    s_waitcnt lgkmcnt(0)
    s_barrier
    v_mov_b32 v214, 128
    global_load_dword v215, v214, s[84:85] sc1
    ds_read_b32 v209, v10 offset:19456
    s_waitcnt lgkmcnt(0)
    v_add_f32 v208, v208, v209
    v_mov_b32 v210, v208
    s_nop 1
    v_permlane32_swap_b32 v208, v210
    v_mul_f32 v208, 0xbacccccd, v208
    v_mul_f32 v210, 0x3acccccd, v210
    v_fma_f32 v210, -v208, v208, v210
    v_max_f32 v210, 0, v210
    v_add_f32 v210, 0x3727c5ac, v210
    v_rsq_f32 v210, v210
    s_nop 0
    v_mul_f32 v208, v208, v210
    v_pk_fma_f32 v[16:17], v[16:17], v[210:211], v[208:209] op_sel_hi:[1,0,0]
    v_cvt_pk_f16_f32 v16, v16, v17
    v_pk_fma_f32 v[18:19], v[18:19], v[210:211], v[208:209] op_sel_hi:[1,0,0]
    v_cvt_pk_f16_f32 v17, v18, v19
    v_pk_fma_f32 v[20:21], v[20:21], v[210:211], v[208:209] op_sel_hi:[1,0,0]
    v_cvt_pk_f16_f32 v18, v20, v21
    v_pk_fma_f32 v[22:23], v[22:23], v[210:211], v[208:209] op_sel_hi:[1,0,0]
    v_cvt_pk_f16_f32 v19, v22, v23
    v_pk_fma_f32 v[24:25], v[24:25], v[210:211], v[208:209] op_sel_hi:[1,0,0]
    v_cvt_pk_f16_f32 v20, v24, v25
    v_pk_fma_f32 v[26:27], v[26:27], v[210:211], v[208:209] op_sel_hi:[1,0,0]
    v_cvt_pk_f16_f32 v21, v26, v27
    v_pk_fma_f32 v[28:29], v[28:29], v[210:211], v[208:209] op_sel_hi:[1,0,0]
    v_cvt_pk_f16_f32 v22, v28, v29
    v_pk_fma_f32 v[30:31], v[30:31], v[210:211], v[208:209] op_sel_hi:[1,0,0]
    v_cvt_pk_f16_f32 v23, v30, v31
    v_pk_fma_f32 v[32:33], v[32:33], v[210:211], v[208:209] op_sel_hi:[1,0,0]
    v_cvt_pk_f16_f32 v24, v32, v33
    v_pk_fma_f32 v[34:35], v[34:35], v[210:211], v[208:209] op_sel_hi:[1,0,0]
    v_cvt_pk_f16_f32 v25, v34, v35
    v_pk_fma_f32 v[36:37], v[36:37], v[210:211], v[208:209] op_sel_hi:[1,0,0]
    v_cvt_pk_f16_f32 v26, v36, v37
    v_pk_fma_f32 v[38:39], v[38:39], v[210:211], v[208:209] op_sel_hi:[1,0,0]
    v_cvt_pk_f16_f32 v27, v38, v39
    v_pk_fma_f32 v[40:41], v[40:41], v[210:211], v[208:209] op_sel_hi:[1,0,0]
    v_cvt_pk_f16_f32 v28, v40, v41
    v_pk_fma_f32 v[42:43], v[42:43], v[210:211], v[208:209] op_sel_hi:[1,0,0]
    v_cvt_pk_f16_f32 v29, v42, v43
    v_pk_fma_f32 v[44:45], v[44:45], v[210:211], v[208:209] op_sel_hi:[1,0,0]
    v_cvt_pk_f16_f32 v30, v44, v45
    v_pk_fma_f32 v[46:47], v[46:47], v[210:211], v[208:209] op_sel_hi:[1,0,0]
    v_cvt_pk_f16_f32 v31, v46, v47
    v_pk_fma_f32 v[48:49], v[48:49], v[210:211], v[208:209] op_sel_hi:[1,0,0]
    v_cvt_pk_f16_f32 v32, v48, v49
    v_pk_fma_f32 v[50:51], v[50:51], v[210:211], v[208:209] op_sel_hi:[1,0,0]
    v_cvt_pk_f16_f32 v33, v50, v51
    v_pk_fma_f32 v[52:53], v[52:53], v[210:211], v[208:209] op_sel_hi:[1,0,0]
    v_cvt_pk_f16_f32 v34, v52, v53
    v_pk_fma_f32 v[54:55], v[54:55], v[210:211], v[208:209] op_sel_hi:[1,0,0]
    v_cvt_pk_f16_f32 v35, v54, v55
    s_cmp_eq_u32 s101, 1
    s_cbranch_scc0 B_y_19
    s_waitcnt vmcnt(0)
    s_mov_b32 s61, 0
    s_branch goc_21
go_20:
    s_sleep 2
    global_load_dword v215, v214, s[84:85] sc1
    s_add_u32 s61, s61, 1
    s_cmp_gt_u32 s61, 262144
    s_waitcnt vmcnt(0)
    s_cbranch_scc1 goe_22
goc_21:
    v_cmp_ne_u32 vcc, 1, v215
    s_cbranch_vccnz go_20
goe_22:
    s_mov_b32 s29, 262144
    buffer_load_dwordx4 v[192:195], v15, s[8:11], s29 offen sc1
    buffer_load_dwordx4 v[176:179], v15, s[8:11], s29 offen offset:2560 sc1
    s_mov_b32 s29, 267264
    buffer_load_dwordx4 v[196:199], v15, s[8:11], s29 offen sc1
    buffer_load_dwordx4 v[180:183], v15, s[8:11], s29 offen offset:2560 sc1
    s_mov_b32 s29, 272384
    buffer_load_dwordx4 v[200:203], v15, s[8:11], s29 offen sc1
    buffer_load_dwordx4 v[184:187], v15, s[8:11], s29 offen offset:2560 sc1
    s_mov_b32 s29, 277504
    buffer_load_dwordx4 v[204:207], v15, s[8:11], s29 offen sc1
    buffer_load_dwordx4 v[188:191], v15, s[8:11], s29 offen offset:2560 sc1
B_y_19:
    v_pk_fma_f32 v[56:57], v[56:57], v[210:211], v[208:209] op_sel_hi:[1,0,0]
    v_cvt_pk_f16_f32 v36, v56, v57
    v_pk_fma_f32 v[58:59], v[58:59], v[210:211], v[208:209] op_sel_hi:[1,0,0]
    v_cvt_pk_f16_f32 v37, v58, v59
    v_pk_fma_f32 v[60:61], v[60:61], v[210:211], v[208:209] op_sel_hi:[1,0,0]
    v_cvt_pk_f16_f32 v38, v60, v61
    v_pk_fma_f32 v[62:63], v[62:63], v[210:211], v[208:209] op_sel_hi:[1,0,0]
    v_cvt_pk_f16_f32 v39, v62, v63
    v_pk_fma_f32 v[64:65], v[64:65], v[210:211], v[208:209] op_sel_hi:[1,0,0]
    v_cvt_pk_f16_f32 v40, v64, v65
    v_pk_fma_f32 v[66:67], v[66:67], v[210:211], v[208:209] op_sel_hi:[1,0,0]
    v_cvt_pk_f16_f32 v41, v66, v67
    v_pk_fma_f32 v[68:69], v[68:69], v[210:211], v[208:209] op_sel_hi:[1,0,0]
    v_cvt_pk_f16_f32 v42, v68, v69
    v_pk_fma_f32 v[70:71], v[70:71], v[210:211], v[208:209] op_sel_hi:[1,0,0]
    v_cvt_pk_f16_f32 v43, v70, v71
    v_pk_fma_f32 v[72:73], v[72:73], v[210:211], v[208:209] op_sel_hi:[1,0,0]
    v_cvt_pk_f16_f32 v44, v72, v73
    v_pk_fma_f32 v[74:75], v[74:75], v[210:211], v[208:209] op_sel_hi:[1,0,0]
    v_cvt_pk_f16_f32 v45, v74, v75
    v_pk_fma_f32 v[76:77], v[76:77], v[210:211], v[208:209] op_sel_hi:[1,0,0]
    v_cvt_pk_f16_f32 v46, v76, v77
    v_pk_fma_f32 v[78:79], v[78:79], v[210:211], v[208:209] op_sel_hi:[1,0,0]
    v_cvt_pk_f16_f32 v47, v78, v79
    v_pk_fma_f32 v[80:81], v[80:81], v[210:211], v[208:209] op_sel_hi:[1,0,0]
    v_cvt_pk_f16_f32 v48, v80, v81
    v_pk_fma_f32 v[82:83], v[82:83], v[210:211], v[208:209] op_sel_hi:[1,0,0]
    v_cvt_pk_f16_f32 v49, v82, v83
    v_pk_fma_f32 v[84:85], v[84:85], v[210:211], v[208:209] op_sel_hi:[1,0,0]
    v_cvt_pk_f16_f32 v50, v84, v85
    v_pk_fma_f32 v[86:87], v[86:87], v[210:211], v[208:209] op_sel_hi:[1,0,0]
    v_cvt_pk_f16_f32 v51, v86, v87
    v_pk_fma_f32 v[88:89], v[88:89], v[210:211], v[208:209] op_sel_hi:[1,0,0]
    v_cvt_pk_f16_f32 v52, v88, v89
    v_pk_fma_f32 v[90:91], v[90:91], v[210:211], v[208:209] op_sel_hi:[1,0,0]
    v_cvt_pk_f16_f32 v53, v90, v91
    v_pk_fma_f32 v[92:93], v[92:93], v[210:211], v[208:209] op_sel_hi:[1,0,0]
    v_cvt_pk_f16_f32 v54, v92, v93
    v_pk_fma_f32 v[94:95], v[94:95], v[210:211], v[208:209] op_sel_hi:[1,0,0]
    v_cvt_pk_f16_f32 v55, v94, v95
    v_pk_fma_f32 v[96:97], v[96:97], v[210:211], v[208:209] op_sel_hi:[1,0,0]
    v_cvt_pk_f16_f32 v56, v96, v97
    v_pk_fma_f32 v[98:99], v[98:99], v[210:211], v[208:209] op_sel_hi:[1,0,0]
    v_cvt_pk_f16_f32 v57, v98, v99
    v_pk_fma_f32 v[100:101], v[100:101], v[210:211], v[208:209] op_sel_hi:[1,0,0]
    v_cvt_pk_f16_f32 v58, v100, v101
    v_pk_fma_f32 v[102:103], v[102:103], v[210:211], v[208:209] op_sel_hi:[1,0,0]
    v_cvt_pk_f16_f32 v59, v102, v103
    v_pk_fma_f32 v[104:105], v[104:105], v[210:211], v[208:209] op_sel_hi:[1,0,0]
    v_cvt_pk_f16_f32 v60, v104, v105
    v_pk_fma_f32 v[106:107], v[106:107], v[210:211], v[208:209] op_sel_hi:[1,0,0]
    v_cvt_pk_f16_f32 v61, v106, v107
    v_pk_fma_f32 v[108:109], v[108:109], v[210:211], v[208:209] op_sel_hi:[1,0,0]
    v_cvt_pk_f16_f32 v62, v108, v109
    v_pk_fma_f32 v[110:111], v[110:111], v[210:211], v[208:209] op_sel_hi:[1,0,0]
    v_cvt_pk_f16_f32 v63, v110, v111
    v_pk_fma_f32 v[112:113], v[112:113], v[210:211], v[208:209] op_sel_hi:[1,0,0]
    v_cvt_pk_f16_f32 v64, v112, v113
    v_pk_fma_f32 v[114:115], v[114:115], v[210:211], v[208:209] op_sel_hi:[1,0,0]
    v_cvt_pk_f16_f32 v65, v114, v115
    v_pk_fma_f32 v[116:117], v[116:117], v[210:211], v[208:209] op_sel_hi:[1,0,0]
    v_cvt_pk_f16_f32 v66, v116, v117
    v_pk_fma_f32 v[118:119], v[118:119], v[210:211], v[208:209] op_sel_hi:[1,0,0]
    v_cvt_pk_f16_f32 v67, v118, v119
    v_pk_fma_f32 v[120:121], v[120:121], v[210:211], v[208:209] op_sel_hi:[1,0,0]
    v_cvt_pk_f16_f32 v68, v120, v121
    v_pk_fma_f32 v[122:123], v[122:123], v[210:211], v[208:209] op_sel_hi:[1,0,0]
    v_cvt_pk_f16_f32 v69, v122, v123
    v_pk_fma_f32 v[124:125], v[124:125], v[210:211], v[208:209] op_sel_hi:[1,0,0]
    v_cvt_pk_f16_f32 v70, v124, v125
    v_pk_fma_f32 v[126:127], v[126:127], v[210:211], v[208:209] op_sel_hi:[1,0,0]
    v_cvt_pk_f16_f32 v71, v126, v127
    v_pk_fma_f32 v[128:129], v[128:129], v[210:211], v[208:209] op_sel_hi:[1,0,0]
    v_cvt_pk_f16_f32 v72, v128, v129
    v_pk_fma_f32 v[130:131], v[130:131], v[210:211], v[208:209] op_sel_hi:[1,0,0]
    v_cvt_pk_f16_f32 v73, v130, v131
    v_pk_fma_f32 v[132:133], v[132:133], v[210:211], v[208:209] op_sel_hi:[1,0,0]
    v_cvt_pk_f16_f32 v74, v132, v133
    v_pk_fma_f32 v[134:135], v[134:135], v[210:211], v[208:209] op_sel_hi:[1,0,0]
    v_cvt_pk_f16_f32 v75, v134, v135
    v_pk_fma_f32 v[136:137], v[136:137], v[210:211], v[208:209] op_sel_hi:[1,0,0]
    v_cvt_pk_f16_f32 v76, v136, v137
    v_pk_fma_f32 v[138:139], v[138:139], v[210:211], v[208:209] op_sel_hi:[1,0,0]
    v_cvt_pk_f16_f32 v77, v138, v139
    v_pk_fma_f32 v[140:141], v[140:141], v[210:211], v[208:209] op_sel_hi:[1,0,0]
    v_cvt_pk_f16_f32 v78, v140, v141
    v_pk_fma_f32 v[142:143], v[142:143], v[210:211], v[208:209] op_sel_hi:[1,0,0]
    v_cvt_pk_f16_f32 v79, v142, v143
    v_pk_fma_f32 v[144:145], v[144:145], v[210:211], v[208:209] op_sel_hi:[1,0,0]
    v_cvt_pk_f16_f32 v80, v144, v145
    v_pk_fma_f32 v[146:147], v[146:147], v[210:211], v[208:209] op_sel_hi:[1,0,0]
    v_cvt_pk_f16_f32 v81, v146, v147
    v_pk_fma_f32 v[148:149], v[148:149], v[210:211], v[208:209] op_sel_hi:[1,0,0]
    v_cvt_pk_f16_f32 v82, v148, v149
    v_pk_fma_f32 v[150:151], v[150:151], v[210:211], v[208:209] op_sel_hi:[1,0,0]
    v_cvt_pk_f16_f32 v83, v150, v151
    v_pk_fma_f32 v[152:153], v[152:153], v[210:211], v[208:209] op_sel_hi:[1,0,0]
    v_cvt_pk_f16_f32 v84, v152, v153
    v_pk_fma_f32 v[154:155], v[154:155], v[210:211], v[208:209] op_sel_hi:[1,0,0]
    v_cvt_pk_f16_f32 v85, v154, v155
    v_pk_fma_f32 v[156:157], v[156:157], v[210:211], v[208:209] op_sel_hi:[1,0,0]
    v_cvt_pk_f16_f32 v86, v156, v157
    v_pk_fma_f32 v[158:159], v[158:159], v[210:211], v[208:209] op_sel_hi:[1,0,0]
    v_cvt_pk_f16_f32 v87, v158, v159
    v_pk_fma_f32 v[160:161], v[160:161], v[210:211], v[208:209] op_sel_hi:[1,0,0]
    v_cvt_pk_f16_f32 v88, v160, v161
    v_pk_fma_f32 v[162:163], v[162:163], v[210:211], v[208:209] op_sel_hi:[1,0,0]
    v_cvt_pk_f16_f32 v89, v162, v163
    v_pk_fma_f32 v[164:165], v[164:165], v[210:211], v[208:209] op_sel_hi:[1,0,0]
    v_cvt_pk_f16_f32 v90, v164, v165
    v_pk_fma_f32 v[166:167], v[166:167], v[210:211], v[208:209] op_sel_hi:[1,0,0]
    v_cvt_pk_f16_f32 v91, v166, v167
    v_pk_fma_f32 v[168:169], v[168:169], v[210:211], v[208:209] op_sel_hi:[1,0,0]
    v_cvt_pk_f16_f32 v92, v168, v169
    v_pk_fma_f32 v[170:171], v[170:171], v[210:211], v[208:209] op_sel_hi:[1,0,0]
    v_cvt_pk_f16_f32 v93, v170, v171
    v_pk_fma_f32 v[172:173], v[172:173], v[210:211], v[208:209] op_sel_hi:[1,0,0]
    v_cvt_pk_f16_f32 v94, v172, v173
    v_pk_fma_f32 v[174:175], v[174:175], v[210:211], v[208:209] op_sel_hi:[1,0,0]
    v_cvt_pk_f16_f32 v95, v174, v175
    s_cmp_eq_u32 s101, 1
    s_cbranch_scc0 B_y_23
    s_mov_b32 s61, 0
    s_branch B_swc_25
B_sw_24:
    s_sleep 2
    s_mov_b32 s29, 262144
    buffer_load_dwordx4 v[192:195], v15, s[8:11], s29 offen sc1
    buffer_load_dwordx4 v[176:179], v15, s[8:11], s29 offen offset:2560 sc1
    s_mov_b32 s29, 267264
    buffer_load_dwordx4 v[196:199], v15, s[8:11], s29 offen sc1
    buffer_load_dwordx4 v[180:183], v15, s[8:11], s29 offen offset:2560 sc1
    s_mov_b32 s29, 272384
    buffer_load_dwordx4 v[200:203], v15, s[8:11], s29 offen sc1
    buffer_load_dwordx4 v[184:187], v15, s[8:11], s29 offen offset:2560 sc1
    s_mov_b32 s29, 277504
    buffer_load_dwordx4 v[204:207], v15, s[8:11], s29 offen sc1
    buffer_load_dwordx4 v[188:191], v15, s[8:11], s29 offen offset:2560 sc1
    s_add_u32 s61, s61, 1
    s_cmp_gt_u32 s61, 262144
    s_cbranch_scc1 B_swe_26
B_swc_25:
    s_waitcnt vmcnt(0)
    v_and_b32 v1, v176, v177
    v_bitop3_b32 v1, v1, v178, v179 bitop3:0x80
    v_bitop3_b32 v1, v1, v180, v181 bitop3:0x80
    v_bitop3_b32 v1, v1, v182, v183 bitop3:0x80
    v_bitop3_b32 v1, v1, v184, v185 bitop3:0x80
    v_bitop3_b32 v1, v1, v186, v187 bitop3:0x80
    v_bitop3_b32 v1, v1, v188, v189 bitop3:0x80
    v_bitop3_b32 v1, v1, v190, v191 bitop3:0x80
    v_bitop3_b32 v1, v1, v192, v193 bitop3:0x80
    v_bitop3_b32 v1, v1, v194, v195 bitop3:0x80
    v_bitop3_b32 v1, v1, v196, v197 bitop3:0x80
    v_bitop3_b32 v1, v1, v198, v199 bitop3:0x80
    v_bitop3_b32 v1, v1, v200, v201 bitop3:0x80
    v_bitop3_b32 v1, v1, v202, v203 bitop3:0x80
    v_bitop3_b32 v1, v1, v204, v205 bitop3:0x80
    v_bitop3_b32 v1, v1, v206, v207 bitop3:0x80
    v_and_b32 v1, 1, v1
    v_cmp_eq_u32 vcc, 0, v1
    s_and_b64 vcc, vcc, s[54:55]
    s_cbranch_vccnz B_sw_24
B_swe_26:
    s_waitcnt vmcnt(0)
    v_pk_add_f32 v[176:177], v[176:177], v[180:181]
    v_pk_add_f32 v[184:185], v[184:185], v[188:189]
    v_pk_add_f32 v[178:179], v[178:179], v[182:183]
    v_pk_add_f32 v[186:187], v[186:187], v[190:191]
    v_pk_add_f32 v[192:193], v[192:193], v[196:197]
    v_pk_add_f32 v[200:201], v[200:201], v[204:205]
    v_pk_add_f32 v[194:195], v[194:195], v[198:199]
    v_pk_add_f32 v[202:203], v[202:203], v[206:207]
    v_pk_add_f32 v[176:177], v[176:177], v[184:185]
    v_pk_add_f32 v[180:181], v[192:193], v[200:201]
    v_pk_add_f32 v[178:179], v[178:179], v[186:187]
    v_pk_add_f32 v[182:183], v[194:195], v[202:203]
    v_cvt_pk_bf16_f32 v1, v176, v177
    v_lshlrev_b32 v176, 16, v1
    v_and_b32 v177, s7, v1
    v_cvt_pk_bf16_f32 v1, v178, v179
    v_lshlrev_b32 v178, 16, v1
    v_and_b32 v179, s7, v1
    v_cvt_pk_bf16_f32 v1, v180, v181
    v_lshlrev_b32 v180, 16, v1
    v_and_b32 v181, s7, v1
    v_cvt_pk_bf16_f32 v1, v182, v183
    v_lshlrev_b32 v182, 16, v1
    v_and_b32 v183, s7, v1
    v_add_f32 v176, 1.0, v176
    v_add_f32 v177, 1.0, v177
    v_add_f32 v178, 1.0, v178
    v_add_f32 v179, 1.0, v179
    v_cvt_pk_bf16_f32 v1, v176, v177
    v_lshlrev_b32 v176, 16, v1
    v_and_b32 v177, s7, v1
    v_cvt_pk_bf16_f32 v1, v178, v179
    v_lshlrev_b32 v178, 16, v1
    v_and_b32 v179, s7, v1
    v_max3_f32 v213, |v176|, |v177|, |v178|
    v_max3_f32 v213, |v179|, |v180|, v213
    v_max3_f32 v213, |v181|, |v182|, v213
    v_max_f32 v213, |v183|, v213
    v_cndmask_b32 v213, 0, v213, s[54:55]
    s_nop 1
    v_max_u32_dpp v213, v213, v213 row_ror:1 row_mask:0xf bank_mask:0xf
    s_nop 1
    v_max_u32_dpp v213, v213, v213 row_ror:2 row_mask:0xf bank_mask:0xf
    s_nop 1
    v_max_u32_dpp v213, v213, v213 row_ror:4 row_mask:0xf bank_mask:0xf
    s_nop 1
    v_max_u32_dpp v213, v213, v213 row_ror:8 row_mask:0xf bank_mask:0xf
    s_nop 1
    ds_write_b32 v13, v213 offset:18432
    s_waitcnt lgkmcnt(0)
B_y_23:
    s_lshl_b32 s34, s26, 3
    s_lshr_b32 s34, 0x31211101, s34
    s_bitcmp1_b32 s34, 4
    s_cselect_b32 s35, s33, s32
    s_bitcmp1_b32 s34, 5
    s_cselect_b32 s43, 122880, 0
    s_add_u32 s35, s35, s43
    s_and_b32 s34, s34, 15
    s_add_u32 s34, s34, s57
    s_cmp_ge_u32 s34, 5
    s_cselect_b32 s43, 5, 0
    s_sub_u32 s34, s34, s43
    s_mul_i32 s34, s34, 245760
    s_add_u32 s34, s34, s35
    s_add_u32 m0, s31, 4096
    s_nop 0
    buffer_load_dwordx4 v7, s[12:15], s34 offen lds
    s_add_u32 m0, s31, 5120
    s_add_u32 s34, s34, 30720
    buffer_load_dwordx4 v7, s[12:15], s34 offen lds
    s_add_u32 m0, s31, 6144
    s_add_u32 s34, s34, 30720
    buffer_load_dwordx4 v7, s[12:15], s34 offen lds
    s_add_u32 m0, s31, 7168
    s_add_u32 s34, s34, 30720
    buffer_load_dwordx4 v7, s[12:15], s34 offen lds
    s_barrier
    ds_read_b32 v213, v11 offset:18432
    s_cmp_eq_u32 s28, 0
    s_cselect_b32 s29, 0x3ea52b5c, 1.0
    s_waitcnt lgkmcnt(0)
    v_max_u32_dpp v213, v213, v213 row_ror:1 row_mask:0xf bank_mask:0xf
    s_nop 1
    v_max_u32_dpp v213, v213, v213 row_ror:2 row_mask:0xf bank_mask:0xf
    s_nop 1
    v_max_u32_dpp v213, v213, v213 row_ror:4 row_mask:0xf bank_mask:0xf
    s_nop 1
    v_max_u32_dpp v213, v213, v213 row_ror:8 row_mask:0xf bank_mask:0xf
    s_nop 1
    v_lshrrev_b32 v13, 23, v213
    v_max_u32 v13, 15, v13
    v_sub_u32 v1, 268, v13
    v_subrev_u32 v13, 14, v13
    v_lshlrev_b32 v13, 23, v13
    v_mul_f32 v230, s29, v13
    s_cmp_eq_u32 s101, 1
    s_cbranch_scc0 B_y_27
    v_lshlrev_b32 v1, 23, v1
    v_mul_f32 v176, v176, v1
    v_mul_f32 v177, v177, v1
    v_mul_f32 v178, v178, v1
    v_mul_f32 v179, v179, v1
    v_mul_f32 v180, v180, v1
    v_mul_f32 v181, v181, v1
    v_mul_f32 v182, v182, v1
    v_mul_f32 v183, v183, v1
    v_cvt_pk_f16_f32 v176, v176, v180
    v_cvt_pk_f16_f32 v177, v177, v181
    v_cvt_pk_f16_f32 v178, v178, v182
    v_cvt_pk_f16_f32 v179, v179, v183
    s_mov_b64 exec, s[54:55]
    ds_write_b128 v14, v[176:179]
    s_mov_b64 exec, -1
B_y_27:
    s_cmp_eq_u32 s28, 2
    s_cbranch_scc1 B_v_28
    s_waitcnt vmcnt(5)
    s_waitcnt lgkmcnt(0)
    s_barrier
    ds_read_b128 v[192:195], v6 offset:0
    ds_read_b128 v[196:199], v6 offset:16
    ds_read_b64_tr_b16 v[160:161], v2 offset:0
    ds_read_b64_tr_b16 v[162:163], v2 offset:512
    ds_read_b64_tr_b16 v[164:165], v3 offset:0
    ds_read_b64_tr_b16 v[166:167], v3 offset:512
    ds_read_b128 v[200:203], v6 offset:64
    ds_read_b128 v[204:207], v6 offset:80
    ds_read_b64_tr_b16 v[168:169], v2 offset:20480
    ds_read_b64_tr_b16 v[170:171], v2 offset:20992
    ds_read_b64_tr_b16 v[172:173], v3 offset:20480
    ds_read_b64_tr_b16 v[174:175], v3 offset:20992
    ds_read_b64_tr_b16 v[176:177], v2 offset:2048
    ds_read_b64_tr_b16 v[178:179], v2 offset:2560
    s_waitcnt lgkmcnt(12)
    v_fma_mix_f32 v208, v16, v192, v192 op_sel:[0,0,1] op_sel_hi:[1,1,1]
    v_fma_mix_f32 v209, v16, v193, v193 op_sel:[1,0,1] op_sel_hi:[1,1,1]
    v_fma_mix_f32 v210, v17, v194, v194 op_sel:[0,0,1] op_sel_hi:[1,1,1]
    v_fma_mix_f32 v211, v17, v195, v195 op_sel:[1,0,1] op_sel_hi:[1,1,1]
    v_fma_mix_f32 v212, v18, v196, v196 op_sel:[0,0,1] op_sel_hi:[1,1,1]
    v_fma_mix_f32 v213, v18, v197, v197 op_sel:[1,0,1] op_sel_hi:[1,1,1]
    v_fma_mix_f32 v214, v19, v198, v198 op_sel:[0,0,1] op_sel_hi:[1,1,1]
    v_fma_mix_f32 v215, v19, v199, v199 op_sel:[1,0,1] op_sel_hi:[1,1,1]
    v_cvt_pk_bf16_f32 v16, v208, v209
    v_cvt_pk_bf16_f32 v17, v210, v211
    v_cvt_pk_bf16_f32 v18, v212, v213
    v_cvt_pk_bf16_f32 v19, v214, v215
    v_add_u32 v1, s31, v9
    s_xor_b32 s29, s3, 4
    s_mul_i32 s29, s29, 20480
    v_add_u32 v9, s29, v9
    s_waitcnt lgkmcnt(10)
    v_mfma_f32_32x32x16_bf16 v[96:111], v[160:163], v[16:19], 0
    ds_read_b64_tr_b16 v[180:181], v3 offset:2048
    ds_read_b64_tr_b16 v[182:183], v3 offset:2560
    s_waitcnt lgkmcnt(8)
    v_fma_mix_f32 v208, v20, v200, v200 op_sel:[0,0,1] op_sel_hi:[1,1,1]
    v_fma_mix_f32 v209, v20, v201, v201 op_sel:[1,0,1] op_sel_hi:[1,1,1]
    v_fma_mix_f32 v210, v21, v202, v202 op_sel:[0,0,1] op_sel_hi:[1,1,1]
    v_fma_mix_f32 v211, v21, v203, v203 op_sel:[1,0,1] op_sel_hi:[1,1,1]
    s_lshl_b32 s34, s26, 3
    s_lshr_b32 s34, 0x3221202, s34
    s_bitcmp1_b32 s34, 4
    s_cselect_b32 s35, s33, s32
    s_bitcmp1_b32 s34, 5
    s_cselect_b32 s43, 122880, 0
    s_add_u32 s35, s35, s43
    s_and_b32 s34, s34, 15
    s_add_u32 s34, s34, s57
    s_cmp_ge_u32 s34, 5
    s_cselect_b32 s43, 5, 0
    s_sub_u32 s34, s34, s43
    s_mul_i32 s34, s34, 245760
    s_add_u32 s34, s34, s35
    s_add_u32 m0, s31, 8192
    s_nop 0
    buffer_load_dwordx4 v7, s[12:15], s34 offen lds
    s_add_u32 m0, s31, 9216
    s_add_u32 s34, s34, 30720
    buffer_load_dwordx4 v7, s[12:15], s34 offen lds
    s_add_u32 m0, s31, 10240
    s_add_u32 s34, s34, 30720
    buffer_load_dwordx4 v7, s[12:15], s34 offen lds
    s_add_u32 m0, s31, 11264
    s_add_u32 s34, s34, 30720
    buffer_load_dwordx4 v7, s[12:15], s34 offen lds
    v_mfma_f32_32x32x16_bf16 v[112:127], v[164:167], v[16:19], 0
    ds_read_b64_tr_b16 v[184:185], v2 offset:22528
    ds_read_b64_tr_b16 v[186:187], v2 offset:23040
    v_fma_mix_f32 v212, v22, v204, v204 op_sel:[0,0,1] op_sel_hi:[1,1,1]
    v_fma_mix_f32 v213, v22, v205, v205 op_sel:[1,0,1] op_sel_hi:[1,1,1]
    v_fma_mix_f32 v214, v23, v206, v206 op_sel:[0,0,1] op_sel_hi:[1,1,1]
    v_fma_mix_f32 v215, v23, v207, v207 op_sel:[1,0,1] op_sel_hi:[1,1,1]
    s_waitcnt lgkmcnt(8)
    v_mfma_f32_32x32x16_bf16 v[128:143], v[168:171], v[16:19], 0
    ds_read_b64_tr_b16 v[188:189], v3 offset:22528
    ds_read_b64_tr_b16 v[190:191], v3 offset:23040
    v_cvt_pk_bf16_f32 v20, v208, v209
    v_cvt_pk_bf16_f32 v21, v210, v211
    v_cvt_pk_bf16_f32 v22, v212, v213
    v_cvt_pk_bf16_f32 v23, v214, v215
    ds_read_b128 v[192:195], v6 offset:128
    ds_read_b128 v[196:199], v6 offset:144
    ds_read_b128 v[200:203], v6 offset:192
    ds_read_b128 v[204:207], v6 offset:208
    s_waitcnt lgkmcnt(12)
    v_mfma_f32_32x32x16_bf16 v[144:159], v[172:175], v[16:19], 0
    ds_read_b64_tr_b16 v[160:161], v2 offset:40960
    ds_read_b64_tr_b16 v[162:163], v2 offset:41472
    s_waitcnt lgkmcnt(4)
    v_fma_mix_f32 v208, v24, v192, v192 op_sel:[0,0,1] op_sel_hi:[1,1,1]
    v_fma_mix_f32 v209, v24, v193, v193 op_sel:[1,0,1] op_sel_hi:[1,1,1]
    v_fma_mix_f32 v210, v25, v194, v194 op_sel:[0,0,1] op_sel_hi:[1,1,1]
    v_fma_mix_f32 v211, v25, v195, v195 op_sel:[1,0,1] op_sel_hi:[1,1,1]
    v_fma_mix_f32 v212, v26, v196, v196 op_sel:[0,0,1] op_sel_hi:[1,1,1]
    s_lshl_b32 s34, s26, 3
    s_lshr_b32 s34, 0x32240423, s34
    s_bitcmp1_b32 s34, 4
    s_cselect_b32 s35, s33, s32
    s_bitcmp1_b32 s34, 5
    s_cselect_b32 s43, 122880, 0
    s_add_u32 s35, s35, s43
    s_and_b32 s34, s34, 15
    s_add_u32 s34, s34, s57
    s_cmp_ge_u32 s34, 5
    s_cselect_b32 s43, 5, 0
    s_sub_u32 s34, s34, s43
    s_mul_i32 s34, s34, 245760
    s_add_u32 s34, s34, s35
    s_add_u32 m0, s31, 12288
    s_nop 0
    buffer_load_dwordx4 v7, s[12:15], s34 offen lds
    s_add_u32 m0, s31, 13312
    s_add_u32 s34, s34, 30720
    buffer_load_dwordx4 v7, s[12:15], s34 offen lds
    s_add_u32 m0, s31, 14336
    s_add_u32 s34, s34, 30720
    buffer_load_dwordx4 v7, s[12:15], s34 offen lds
    s_add_u32 m0, s31, 15360
    s_add_u32 s34, s34, 30720
    buffer_load_dwordx4 v7, s[12:15], s34 offen lds
    v_mfma_f32_32x32x16_bf16 v[96:111], v[176:179], v[20:23], v[96:111]
    ds_read_b64_tr_b16 v[164:165], v3 offset:40960
    ds_read_b64_tr_b16 v[166:167], v3 offset:41472
    v_fma_mix_f32 v213, v26, v197, v197 op_sel:[1,0,1] op_sel_hi:[1,1,1]
    v_fma_mix_f32 v214, v27, v198, v198 op_sel:[0,0,1] op_sel_hi:[1,1,1]
    v_fma_mix_f32 v215, v27, v199, v199 op_sel:[1,0,1] op_sel_hi:[1,1,1]
    v_cvt_pk_bf16_f32 v24, v208, v209
    v_mfma_f32_32x32x16_bf16 v[112:127], v[180:183], v[20:23], v[112:127]
    ds_read_b64_tr_b16 v[168:169], v4 offset:0
    ds_read_b64_tr_b16 v[170:171], v4 offset:512
    v_cvt_pk_bf16_f32 v25, v210, v211
    v_cvt_pk_bf16_f32 v26, v212, v213
    v_cvt_pk_bf16_f32 v27, v214, v215
    ds_read_b128 v[192:195], v6 offset:256
    ds_read_b128 v[196:199], v6 offset:272
    s_waitcnt lgkmcnt(8)
    v_fma_mix_f32 v208, v28, v200, v200 op_sel:[0,0,1] op_sel_hi:[1,1,1]
    s_mov_b32 exec_lo, 0xff
    s_mov_b32 exec_hi, 0x0
    buffer_load_dword v252, v229, s[16:19], s48 offen
    s_mov_b64 exec, -1
    v_mfma_f32_32x32x16_bf16 v[128:143], v[184:187], v[20:23], v[128:143]
    ds_read_b64_tr_b16 v[172:173], v5 offset:0
    ds_read_b64_tr_b16 v[174:175], v5 offset:512
    v_fma_mix_f32 v209, v28, v201, v201 op_sel:[1,0,1] op_sel_hi:[1,1,1]
    v_fma_mix_f32 v210, v29, v202, v202 op_sel:[0,0,1] op_sel_hi:[1,1,1]
    v_fma_mix_f32 v211, v29, v203, v203 op_sel:[1,0,1] op_sel_hi:[1,1,1]
    v_fma_mix_f32 v212, v30, v204, v204 op_sel:[0,0,1] op_sel_hi:[1,1,1]
    v_mfma_f32_32x32x16_bf16 v[144:159], v[188:191], v[20:23], v[144:159]
    ds_read_b64_tr_b16 v[176:177], v2 offset:43008
    ds_read_b64_tr_b16 v[178:179], v2 offset:43520
    v_fma_mix_f32 v213, v30, v205, v205 op_sel:[1,0,1] op_sel_hi:[1,1,1]
    v_fma_mix_f32 v214, v31, v206, v206 op_sel:[0,0,1] op_sel_hi:[1,1,1]
    v_fma_mix_f32 v215, v31, v207, v207 op_sel:[1,0,1] op_sel_hi:[1,1,1]
    v_cvt_pk_bf16_f32 v28, v208, v209
    v_cvt_pk_bf16_f32 v29, v210, v211
    s_waitcnt lgkmcnt(10)
    v_mfma_f32_32x32x16_bf16 v[96:111], v[160:163], v[24:27], v[96:111]
    ds_read_b64_tr_b16 v[180:181], v3 offset:43008
    ds_read_b64_tr_b16 v[182:183], v3 offset:43520
    v_cvt_pk_bf16_f32 v30, v212, v213
    v_cvt_pk_bf16_f32 v31, v214, v215
    ds_read_b128 v[200:203], v6 offset:320
    ds_read_b128 v[204:207], v6 offset:336
    s_waitcnt lgkmcnt(8)
    v_fma_mix_f32 v208, v32, v192, v192 op_sel:[0,0,1] op_sel_hi:[1,1,1]
    v_fma_mix_f32 v209, v32, v193, v193 op_sel:[1,0,1] op_sel_hi:[1,1,1]
    v_mfma_f32_32x32x16_bf16 v[112:127], v[164:167], v[24:27], v[112:127]
    ds_read_b64_tr_b16 v[184:185], v4 offset:2048
    ds_read_b64_tr_b16 v[186:187], v4 offset:2560
    v_fma_mix_f32 v210, v33, v194, v194 op_sel:[0,0,1] op_sel_hi:[1,1,1]
    v_fma_mix_f32 v211, v33, v195, v195 op_sel:[1,0,1] op_sel_hi:[1,1,1]
    v_fma_mix_f32 v212, v34, v196, v196 op_sel:[0,0,1] op_sel_hi:[1,1,1]
    v_fma_mix_f32 v213, v34, v197, v197 op_sel:[1,0,1] op_sel_hi:[1,1,1]
    v_mfma_f32_32x32x16_bf16 v[128:143], v[168:171], v[24:27], v[128:143]
    ds_read_b64_tr_b16 v[188:189], v5 offset:2048
    ds_read_b64_tr_b16 v[190:191], v5 offset:2560
    v_fma_mix_f32 v214, v35, v198, v198 op_sel:[0,0,1] op_sel_hi:[1,1,1]
    v_fma_mix_f32 v215, v35, v199, v199 op_sel:[1,0,1] op_sel_hi:[1,1,1]
    v_cvt_pk_bf16_f32 v32, v208, v209
    v_cvt_pk_bf16_f32 v33, v210, v211
    s_waitcnt lgkmcnt(10)
    v_mfma_f32_32x32x16_bf16 v[144:159], v[172:175], v[24:27], v[144:159]
    s_waitcnt vmcnt(9)
    s_barrier
    ds_read_b64_tr_b16 v[160:161], v2 offset:4096
    ds_read_b64_tr_b16 v[162:163], v2 offset:4608
    v_cvt_pk_bf16_f32 v34, v212, v213
    v_cvt_pk_bf16_f32 v35, v214, v215
    ds_read_b128 v[192:195], v6 offset:384
    ds_read_b128 v[196:199], v6 offset:400
    s_waitcnt lgkmcnt(8)
    v_fma_mix_f32 v208, v36, v200, v200 op_sel:[0,0,1] op_sel_hi:[1,1,1]
    v_fma_mix_f32 v209, v36, v201, v201 op_sel:[1,0,1] op_sel_hi:[1,1,1]
    v_fma_mix_f32 v210, v37, v202, v202 op_sel:[0,0,1] op_sel_hi:[1,1,1]
    v_mfma_f32_32x32x16_bf16 v[96:111], v[176:179], v[28:31], v[96:111]
    ds_read_b64_tr_b16 v[164:165], v3 offset:4096
    ds_read_b64_tr_b16 v[166:167], v3 offset:4608
    v_fma_mix_f32 v211, v37, v203, v203 op_sel:[1,0,1] op_sel_hi:[1,1,1]
    v_fma_mix_f32 v212, v38, v204, v204 op_sel:[0,0,1] op_sel_hi:[1,1,1]
    v_fma_mix_f32 v213, v38, v205, v205 op_sel:[1,0,1] op_sel_hi:[1,1,1]
    v_fma_mix_f32 v214, v39, v206, v206 op_sel:[0,0,1] op_sel_hi:[1,1,1]
    v_mfma_f32_32x32x16_bf16 v[112:127], v[180:183], v[28:31], v[112:127]
    ds_read_b64_tr_b16 v[168:169], v2 offset:24576
    ds_read_b64_tr_b16 v[170:171], v2 offset:25088
    v_fma_mix_f32 v215, v39, v207, v207 op_sel:[1,0,1] op_sel_hi:[1,1,1]
    v_cvt_pk_bf16_f32 v36, v208, v209
    v_cvt_pk_bf16_f32 v37, v210, v211
    v_cvt_pk_bf16_f32 v38, v212, v213
    s_waitcnt lgkmcnt(10)
    v_mfma_f32_32x32x16_bf16 v[128:143], v[184:187], v[28:31], v[128:143]
    ds_read_b64_tr_b16 v[172:173], v3 offset:24576
    ds_read_b64_tr_b16 v[174:175], v3 offset:25088
    v_cvt_pk_bf16_f32 v39, v214, v215
    ds_read_b128 v[200:203], v6 offset:448
    ds_read_b128 v[204:207], v6 offset:464
    s_waitcnt lgkmcnt(8)
    v_fma_mix_f32 v208, v40, v192, v192 op_sel:[0,0,1] op_sel_hi:[1,1,1]
    v_fma_mix_f32 v209, v40, v193, v193 op_sel:[1,0,1] op_sel_hi:[1,1,1]
    v_fma_mix_f32 v210, v41, v194, v194 op_sel:[0,0,1] op_sel_hi:[1,1,1]
    v_mfma_f32_32x32x16_bf16 v[144:159], v[188:191], v[28:31], v[144:159]
    ds_read_b64_tr_b16 v[176:177], v2 offset:6144
    ds_read_b64_tr_b16 v[178:179], v2 offset:6656
    v_fma_mix_f32 v211, v41, v195, v195 op_sel:[1,0,1] op_sel_hi:[1,1,1]
    v_fma_mix_f32 v212, v42, v196, v196 op_sel:[0,0,1] op_sel_hi:[1,1,1]
    v_fma_mix_f32 v213, v42, v197, v197 op_sel:[1,0,1] op_sel_hi:[1,1,1]
    v_fma_mix_f32 v214, v43, v198, v198 op_sel:[0,0,1] op_sel_hi:[1,1,1]
    v_fma_mix_f32 v215, v43, v199, v199 op_sel:[1,0,1] op_sel_hi:[1,1,1]
    v_mfma_f32_32x32x16_bf16 v[96:111], v[160:163], v[32:35], v[96:111]
    ds_read_b64_tr_b16 v[180:181], v3 offset:6144
    ds_read_b64_tr_b16 v[182:183], v3 offset:6656
    v_cvt_pk_bf16_f32 v40, v208, v209
    v_cvt_pk_bf16_f32 v41, v210, v211
    v_cvt_pk_bf16_f32 v42, v212, v213
    v_cvt_pk_bf16_f32 v43, v214, v215
    ds_read_b128 v[192:195], v6 offset:512
    ds_read_b128 v[196:199], v6 offset:528
    s_waitcnt lgkmcnt(12)
    v_mfma_f32_32x32x16_bf16 v[112:127], v[164:167], v[32:35], v[112:127]
    ds_read_b64_tr_b16 v[184:185], v2 offset:26624
    ds_read_b64_tr_b16 v[186:187], v2 offset:27136
    s_waitcnt lgkmcnt(8)
    v_fma_mix_f32 v208, v44, v200, v200 op_sel:[0,0,1] op_sel_hi:[1,1,1]
    v_fma_mix_f32 v209, v44, v201, v201 op_sel:[1,0,1] op_sel_hi:[1,1,1]
    v_fma_mix_f32 v210, v45, v202, v202 op_sel:[0,0,1] op_sel_hi:[1,1,1]
    v_fma_mix_f32 v211, v45, v203, v203 op_sel:[1,0,1] op_sel_hi:[1,1,1]
    v_mfma_f32_32x32x16_bf16 v[128:143], v[168:171], v[32:35], v[128:143]
    ds_read_b64_tr_b16 v[188:189], v3 offset:26624
    ds_read_b64_tr_b16 v[190:191], v3 offset:27136
    v_fma_mix_f32 v212, v46, v204, v204 op_sel:[0,0,1] op_sel_hi:[1,1,1]
    v_fma_mix_f32 v213, v46, v205, v205 op_sel:[1,0,1] op_sel_hi:[1,1,1]
    v_fma_mix_f32 v214, v47, v206, v206 op_sel:[0,0,1] op_sel_hi:[1,1,1]
    v_fma_mix_f32 v215, v47, v207, v207 op_sel:[1,0,1] op_sel_hi:[1,1,1]
    v_mfma_f32_32x32x16_bf16 v[144:159], v[172:175], v[32:35], v[144:159]
    ds_read_b64_tr_b16 v[160:161], v2 offset:45056
    ds_read_b64_tr_b16 v[162:163], v2 offset:45568
    v_cvt_pk_bf16_f32 v44, v208, v209
    v_cvt_pk_bf16_f32 v45, v210, v211
    v_cvt_pk_bf16_f32 v46, v212, v213
    v_cvt_pk_bf16_f32 v47, v214, v215
    ds_read_b128 v[200:203], v6 offset:576
    ds_read_b128 v[204:207], v6 offset:592
    s_waitcnt lgkmcnt(8)
    v_fma_mix_f32 v208, v48, v192, v192 op_sel:[0,0,1] op_sel_hi:[1,1,1]
    s_mov_b32 exec_lo, 0xff00
    s_mov_b32 exec_hi, 0x0
    buffer_load_dword v252, v229, s[16:19], s48 offen
    s_mov_b64 exec, -1
    v_mfma_f32_32x32x16_bf16 v[96:111], v[176:179], v[36:39], v[96:111]
    ds_read_b64_tr_b16 v[164:165], v3 offset:45056
    ds_read_b64_tr_b16 v[166:167], v3 offset:45568
    v_fma_mix_f32 v209, v48, v193, v193 op_sel:[1,0,1] op_sel_hi:[1,1,1]
    v_fma_mix_f32 v210, v49, v194, v194 op_sel:[0,0,1] op_sel_hi:[1,1,1]
    v_fma_mix_f32 v211, v49, v195, v195 op_sel:[1,0,1] op_sel_hi:[1,1,1]
    v_fma_mix_f32 v212, v50, v196, v196 op_sel:[0,0,1] op_sel_hi:[1,1,1]
    v_mfma_f32_32x32x16_bf16 v[112:127], v[180:183], v[36:39], v[112:127]
    ds_read_b64_tr_b16 v[168:169], v4 offset:4096
    ds_read_b64_tr_b16 v[170:171], v4 offset:4608
    v_fma_mix_f32 v213, v50, v197, v197 op_sel:[1,0,1] op_sel_hi:[1,1,1]
    v_fma_mix_f32 v214, v51, v198, v198 op_sel:[0,0,1] op_sel_hi:[1,1,1]
    v_fma_mix_f32 v215, v51, v199, v199 op_sel:[1,0,1] op_sel_hi:[1,1,1]
    v_cvt_pk_bf16_f32 v48, v208, v209
    s_waitcnt lgkmcnt(10)
    v_mfma_f32_32x32x16_bf16 v[128:143], v[184:187], v[36:39], v[128:143]
    ds_read_b64_tr_b16 v[172:173], v5 offset:4096
    ds_read_b64_tr_b16 v[174:175], v5 offset:4608
    v_cvt_pk_bf16_f32 v49, v210, v211
    v_cvt_pk_bf16_f32 v50, v212, v213
    v_cvt_pk_bf16_f32 v51, v214, v215
    ds_read_b128 v[192:195], v6 offset:640
    ds_read_b128 v[196:199], v6 offset:656
    s_waitcnt lgkmcnt(8)
    v_fma_mix_f32 v208, v52, v200, v200 op_sel:[0,0,1] op_sel_hi:[1,1,1]
    v_mfma_f32_32x32x16_bf16 v[144:159], v[188:191], v[36:39], v[144:159]
    ds_read_b64_tr_b16 v[176:177], v2 offset:47104
    ds_read_b64_tr_b16 v[178:179], v2 offset:47616
    v_fma_mix_f32 v209, v52, v201, v201 op_sel:[1,0,1] op_sel_hi:[1,1,1]
    v_fma_mix_f32 v210, v53, v202, v202 op_sel:[0,0,1] op_sel_hi:[1,1,1]
    v_fma_mix_f32 v211, v53, v203, v203 op_sel:[1,0,1] op_sel_hi:[1,1,1]
    v_fma_mix_f32 v212, v54, v204, v204 op_sel:[0,0,1] op_sel_hi:[1,1,1]
    v_fma_mix_f32 v213, v54, v205, v205 op_sel:[1,0,1] op_sel_hi:[1,1,1]
    v_mfma_f32_32x32x16_bf16 v[96:111], v[160:163], v[40:43], v[96:111]
    ds_read_b64_tr_b16 v[180:181], v3 offset:47104
    ds_read_b64_tr_b16 v[182:183], v3 offset:47616
    v_fma_mix_f32 v214, v55, v206, v206 op_sel:[0,0,1] op_sel_hi:[1,1,1]
    v_fma_mix_f32 v215, v55, v207, v207 op_sel:[1,0,1] op_sel_hi:[1,1,1]
    v_cvt_pk_bf16_f32 v52, v208, v209
    v_cvt_pk_bf16_f32 v53, v210, v211
    s_waitcnt lgkmcnt(10)
    v_mfma_f32_32x32x16_bf16 v[112:127], v[164:167], v[40:43], v[112:127]
    ds_read_b64_tr_b16 v[184:185], v4 offset:6144
    ds_read_b64_tr_b16 v[186:187], v4 offset:6656
    v_cvt_pk_bf16_f32 v54, v212, v213
    v_cvt_pk_bf16_f32 v55, v214, v215
    ds_read_b128 v[200:203], v6 offset:704
    ds_read_b128 v[204:207], v6 offset:720
    s_waitcnt lgkmcnt(8)
    v_fma_mix_f32 v208, v56, v192, v192 op_sel:[0,0,1] op_sel_hi:[1,1,1]
    v_fma_mix_f32 v209, v56, v193, v193 op_sel:[1,0,1] op_sel_hi:[1,1,1]
    v_mfma_f32_32x32x16_bf16 v[128:143], v[168:171], v[40:43], v[128:143]
    ds_read_b64_tr_b16 v[188:189], v5 offset:6144
    ds_read_b64_tr_b16 v[190:191], v5 offset:6656
    v_fma_mix_f32 v210, v57, v194, v194 op_sel:[0,0,1] op_sel_hi:[1,1,1]
    v_fma_mix_f32 v211, v57, v195, v195 op_sel:[1,0,1] op_sel_hi:[1,1,1]
    v_fma_mix_f32 v212, v58, v196, v196 op_sel:[0,0,1] op_sel_hi:[1,1,1]
    v_fma_mix_f32 v213, v58, v197, v197 op_sel:[1,0,1] op_sel_hi:[1,1,1]
    v_mfma_f32_32x32x16_bf16 v[144:159], v[172:175], v[40:43], v[144:159]
    s_waitcnt vmcnt(6)
    s_barrier
    ds_read_b64_tr_b16 v[160:161], v2 offset:8192
    ds_read_b64_tr_b16 v[162:163], v2 offset:8704
    v_fma_mix_f32 v214, v59, v198, v198 op_sel:[0,0,1] op_sel_hi:[1,1,1]
    v_fma_mix_f32 v215, v59, v199, v199 op_sel:[1,0,1] op_sel_hi:[1,1,1]
    v_cvt_pk_bf16_f32 v56, v208, v209
    v_cvt_pk_bf16_f32 v57, v210, v211
    v_cvt_pk_bf16_f32 v58, v212, v213
    s_waitcnt lgkmcnt(10)
    v_mfma_f32_32x32x16_bf16 v[96:111], v[176:179], v[44:47], v[96:111]
    ds_read_b64_tr_b16 v[164:165], v3 offset:8192
    ds_read_b64_tr_b16 v[166:167], v3 offset:8704
    v_cvt_pk_bf16_f32 v59, v214, v215
    ds_read_b128 v[192:195], v6 offset:768
    ds_read_b128 v[196:199], v6 offset:784
    s_waitcnt lgkmcnt(8)
    v_fma_mix_f32 v208, v60, v200, v200 op_sel:[0,0,1] op_sel_hi:[1,1,1]
    v_fma_mix_f32 v209, v60, v201, v201 op_sel:[1,0,1] op_sel_hi:[1,1,1]
    v_fma_mix_f32 v210, v61, v202, v202 op_sel:[0,0,1] op_sel_hi:[1,1,1]
    v_mfma_f32_32x32x16_bf16 v[112:127], v[180:183], v[44:47], v[112:127]
    ds_read_b64_tr_b16 v[168:169], v2 offset:28672
    ds_read_b64_tr_b16 v[170:171], v2 offset:29184
    v_fma_mix_f32 v211, v61, v203, v203 op_sel:[1,0,1] op_sel_hi:[1,1,1]
    v_fma_mix_f32 v212, v62, v204, v204 op_sel:[0,0,1] op_sel_hi:[1,1,1]
    v_fma_mix_f32 v213, v62, v205, v205 op_sel:[1,0,1] op_sel_hi:[1,1,1]
    v_fma_mix_f32 v214, v63, v206, v206 op_sel:[0,0,1] op_sel_hi:[1,1,1]
    v_mfma_f32_32x32x16_bf16 v[128:143], v[184:187], v[44:47], v[128:143]
    ds_read_b64_tr_b16 v[172:173], v3 offset:28672
    ds_read_b64_tr_b16 v[174:175], v3 offset:29184
    v_fma_mix_f32 v215, v63, v207, v207 op_sel:[1,0,1] op_sel_hi:[1,1,1]
    v_cvt_pk_bf16_f32 v60, v208, v209
    v_cvt_pk_bf16_f32 v61, v210, v211
    v_cvt_pk_bf16_f32 v62, v212, v213
    s_waitcnt lgkmcnt(10)
    v_mfma_f32_32x32x16_bf16 v[144:159], v[188:191], v[44:47], v[144:159]
    ds_read_b64_tr_b16 v[176:177], v2 offset:10240
    ds_read_b64_tr_b16 v[178:179], v2 offset:10752
    v_cvt_pk_bf16_f32 v63, v214, v215
    ds_read_b128 v[200:203], v6 offset:832
    ds_read_b128 v[204:207], v6 offset:848
    s_waitcnt lgkmcnt(8)
    v_fma_mix_f32 v208, v64, v192, v192 op_sel:[0,0,1] op_sel_hi:[1,1,1]
    v_fma_mix_f32 v209, v64, v193, v193 op_sel:[1,0,1] op_sel_hi:[1,1,1]
    v_fma_mix_f32 v210, v65, v194, v194 op_sel:[0,0,1] op_sel_hi:[1,1,1]
    v_fma_mix_f32 v211, v65, v195, v195 op_sel:[1,0,1] op_sel_hi:[1,1,1]
    v_mfma_f32_32x32x16_bf16 v[96:111], v[160:163], v[48:51], v[96:111]
    ds_read_b64_tr_b16 v[180:181], v3 offset:10240
    ds_read_b64_tr_b16 v[182:183], v3 offset:10752
    v_fma_mix_f32 v212, v66, v196, v196 op_sel:[0,0,1] op_sel_hi:[1,1,1]
    v_fma_mix_f32 v213, v66, v197, v197 op_sel:[1,0,1] op_sel_hi:[1,1,1]
    v_fma_mix_f32 v214, v67, v198, v198 op_sel:[0,0,1] op_sel_hi:[1,1,1]
    v_fma_mix_f32 v215, v67, v199, v199 op_sel:[1,0,1] op_sel_hi:[1,1,1]
    v_mfma_f32_32x32x16_bf16 v[112:127], v[164:167], v[48:51], v[112:127]
    ds_read_b64_tr_b16 v[184:185], v2 offset:30720
    ds_read_b64_tr_b16 v[186:187], v2 offset:31232
    v_cvt_pk_bf16_f32 v64, v208, v209
    v_cvt_pk_bf16_f32 v65, v210, v211
    v_cvt_pk_bf16_f32 v66, v212, v213
    v_cvt_pk_bf16_f32 v67, v214, v215
    ds_read_b128 v[192:195], v6 offset:896
    ds_read_b128 v[196:199], v6 offset:912
    s_mov_b32 exec_lo, 0xff0000
    s_mov_b32 exec_hi, 0x0
    buffer_load_dword v252, v229, s[16:19], s48 offen
    s_mov_b64 exec, -1
    s_waitcnt lgkmcnt(12)
    v_mfma_f32_32x32x16_bf16 v[128:143], v[168:171], v[48:51], v[128:143]
    ds_read_b64_tr_b16 v[188:189], v3 offset:30720
    ds_read_b64_tr_b16 v[190:191], v3 offset:31232
    s_waitcnt lgkmcnt(8)
    v_fma_mix_f32 v208, v68, v200, v200 op_sel:[0,0,1] op_sel_hi:[1,1,1]
    v_fma_mix_f32 v209, v68, v201, v201 op_sel:[1,0,1] op_sel_hi:[1,1,1]
    v_fma_mix_f32 v210, v69, v202, v202 op_sel:[0,0,1] op_sel_hi:[1,1,1]
    v_fma_mix_f32 v211, v69, v203, v203 op_sel:[1,0,1] op_sel_hi:[1,1,1]
    v_mfma_f32_32x32x16_bf16 v[144:159], v[172:175], v[48:51], v[144:159]
    ds_read_b64_tr_b16 v[160:161], v2 offset:49152
    ds_read_b64_tr_b16 v[162:163], v2 offset:49664
    v_fma_mix_f32 v212, v70, v204, v204 op_sel:[0,0,1] op_sel_hi:[1,1,1]
    v_fma_mix_f32 v213, v70, v205, v205 op_sel:[1,0,1] op_sel_hi:[1,1,1]
    v_fma_mix_f32 v214, v71, v206, v206 op_sel:[0,0,1] op_sel_hi:[1,1,1]
    v_fma_mix_f32 v215, v71, v207, v207 op_sel:[1,0,1] op_sel_hi:[1,1,1]
    v_cvt_pk_bf16_f32 v68, v208, v209
    v_mfma_f32_32x32x16_bf16 v[96:111], v[176:179], v[52:55], v[96:111]
    ds_read_b64_tr_b16 v[164:165], v3 offset:49152
    ds_read_b64_tr_b16 v[166:167], v3 offset:49664
    v_cvt_pk_bf16_f32 v69, v210, v211
    v_cvt_pk_bf16_f32 v70, v212, v213
    v_cvt_pk_bf16_f32 v71, v214, v215
    ds_read_b128 v[200:203], v6 offset:960
    ds_read_b128 v[204:207], v6 offset:976
    s_waitcnt lgkmcnt(8)
    v_fma_mix_f32 v208, v72, v192, v192 op_sel:[0,0,1] op_sel_hi:[1,1,1]
    v_mfma_f32_32x32x16_bf16 v[112:127], v[180:183], v[52:55], v[112:127]
    ds_read_b64_tr_b16 v[168:169], v2 offset:51200
    ds_read_b64_tr_b16 v[170:171], v2 offset:51712
    v_fma_mix_f32 v209, v72, v193, v193 op_sel:[1,0,1] op_sel_hi:[1,1,1]
    v_fma_mix_f32 v210, v73, v194, v194 op_sel:[0,0,1] op_sel_hi:[1,1,1]
    v_fma_mix_f32 v211, v73, v195, v195 op_sel:[1,0,1] op_sel_hi:[1,1,1]
    v_fma_mix_f32 v212, v74, v196, v196 op_sel:[0,0,1] op_sel_hi:[1,1,1]
    v_mfma_f32_32x32x16_bf16 v[128:143], v[184:187], v[52:55], v[128:143]
    ds_read_b64_tr_b16 v[172:173], v3 offset:51200
    ds_read_b64_tr_b16 v[174:175], v3 offset:51712
    v_fma_mix_f32 v213, v74, v197, v197 op_sel:[1,0,1] op_sel_hi:[1,1,1]
    v_fma_mix_f32 v214, v75, v198, v198 op_sel:[0,0,1] op_sel_hi:[1,1,1]
    v_fma_mix_f32 v215, v75, v199, v199 op_sel:[1,0,1] op_sel_hi:[1,1,1]
    v_cvt_pk_bf16_f32 v72, v208, v209
    s_waitcnt lgkmcnt(10)
    v_mfma_f32_32x32x16_bf16 v[144:159], v[188:191], v[52:55], v[144:159]
    ds_read_b64_tr_b16 v[176:177], v4 offset:8192
    ds_read_b64_tr_b16 v[178:179], v4 offset:8704
    v_cvt_pk_bf16_f32 v73, v210, v211
    v_cvt_pk_bf16_f32 v74, v212, v213
    v_cvt_pk_bf16_f32 v75, v214, v215
    ds_read_b128 v[192:195], v6 offset:1024
    ds_read_b128 v[196:199], v6 offset:1040
    s_waitcnt lgkmcnt(8)
    v_fma_mix_f32 v208, v76, v200, v200 op_sel:[0,0,1] op_sel_hi:[1,1,1]
    v_fma_mix_f32 v209, v76, v201, v201 op_sel:[1,0,1] op_sel_hi:[1,1,1]
    v_mfma_f32_32x32x16_bf16 v[96:111], v[160:163], v[56:59], v[96:111]
    ds_read_b64_tr_b16 v[180:181], v5 offset:8192
    ds_read_b64_tr_b16 v[182:183], v5 offset:8704
    v_fma_mix_f32 v210, v77, v202, v202 op_sel:[0,0,1] op_sel_hi:[1,1,1]
    v_fma_mix_f32 v211, v77, v203, v203 op_sel:[1,0,1] op_sel_hi:[1,1,1]
    v_fma_mix_f32 v212, v78, v204, v204 op_sel:[0,0,1] op_sel_hi:[1,1,1]
    v_fma_mix_f32 v213, v78, v205, v205 op_sel:[1,0,1] op_sel_hi:[1,1,1]
    v_mfma_f32_32x32x16_bf16 v[112:127], v[164:167], v[56:59], v[112:127]
    ds_read_b64_tr_b16 v[184:185], v4 offset:10240
    ds_read_b64_tr_b16 v[186:187], v4 offset:10752
    v_fma_mix_f32 v214, v79, v206, v206 op_sel:[0,0,1] op_sel_hi:[1,1,1]
    v_fma_mix_f32 v215, v79, v207, v207 op_sel:[1,0,1] op_sel_hi:[1,1,1]
    v_cvt_pk_bf16_f32 v76, v208, v209
    v_cvt_pk_bf16_f32 v77, v210, v211
    s_waitcnt lgkmcnt(10)
    v_mfma_f32_32x32x16_bf16 v[96:111], v[168:171], v[60:63], v[96:111]
    ds_read_b64_tr_b16 v[188:189], v5 offset:10240
    ds_read_b64_tr_b16 v[190:191], v5 offset:10752
    v_cvt_pk_bf16_f32 v78, v212, v213
    v_cvt_pk_bf16_f32 v79, v214, v215
    ds_read_b128 v[200:203], v6 offset:1088
    ds_read_b128 v[204:207], v6 offset:1104
    s_waitcnt lgkmcnt(8)
    v_fma_mix_f32 v208, v80, v192, v192 op_sel:[0,0,1] op_sel_hi:[1,1,1]
    v_fma_mix_f32 v209, v80, v193, v193 op_sel:[1,0,1] op_sel_hi:[1,1,1]
    v_mfma_f32_32x32x16_bf16 v[112:127], v[172:175], v[60:63], v[112:127]
    s_waitcnt vmcnt(3)
    s_barrier
    s_lshl_b32 s34, s26, 3
    s_lshr_b32 s34, 0x13341433, s34
    s_bitcmp1_b32 s34, 4
    s_cselect_b32 s35, s33, s32
    s_bitcmp1_b32 s34, 5
    s_cselect_b32 s43, 122880, 0
    s_add_u32 s35, s35, s43
    s_and_b32 s34, s34, 15
    s_add_u32 s34, s34, s57
    s_cmp_ge_u32 s34, 5
    s_cselect_b32 s43, 5, 0
    s_sub_u32 s34, s34, s43
    s_mul_i32 s34, s34, 245760
    s_add_u32 s34, s34, s35
    s_cmp_eq_u32 s26, 3
    s_cselect_b32 s35, 0xfffef000, 0
    s_add_u32 s35, s35, s31
    s_add_u32 m0, s35, 16384
    s_nop 0
    buffer_load_dwordx4 v7, s[12:15], s34 offen lds
    s_add_u32 m0, s35, 17408
    s_add_u32 s34, s34, 30720
    buffer_load_dwordx4 v7, s[12:15], s34 offen lds
    s_add_u32 m0, s35, 18432
    s_add_u32 s34, s34, 30720
    buffer_load_dwordx4 v7, s[12:15], s34 offen lds
    s_add_u32 m0, s35, 19456
    s_add_u32 s34, s34, 30720
    buffer_load_dwordx4 v7, s[12:15], s34 offen lds
    v_and_b32 v233, 15, v0
    v_lshlrev_b32 v233, 7, v233
    s_mov_b32 s62, 65536
    buffer_load_dword v234, v233, s[8:11], s62 offen sc1
    ds_read_b64_tr_b16 v[160:161], v2 offset:12288
    ds_read_b64_tr_b16 v[162:163], v2 offset:12800
    v_fma_mix_f32 v210, v81, v194, v194 op_sel:[0,0,1] op_sel_hi:[1,1,1]
    v_fma_mix_f32 v211, v81, v195, v195 op_sel:[1,0,1] op_sel_hi:[1,1,1]
    v_fma_mix_f32 v212, v82, v196, v196 op_sel:[0,0,1] op_sel_hi:[1,1,1]
    v_fma_mix_f32 v213, v82, v197, v197 op_sel:[1,0,1] op_sel_hi:[1,1,1]
    v_fma_mix_f32 v214, v83, v198, v198 op_sel:[0,0,1] op_sel_hi:[1,1,1]
    v_mfma_f32_32x32x16_bf16 v[96:111], v[176:179], v[64:67], v[96:111]
    ds_read_b64_tr_b16 v[164:165], v3 offset:12288
    ds_read_b64_tr_b16 v[166:167], v3 offset:12800
    v_fma_mix_f32 v215, v83, v199, v199 op_sel:[1,0,1] op_sel_hi:[1,1,1]
    v_cvt_pk_bf16_f32 v80, v208, v209
    v_cvt_pk_bf16_f32 v81, v210, v211
    v_cvt_pk_bf16_f32 v82, v212, v213
    s_waitcnt lgkmcnt(10)
    v_mfma_f32_32x32x16_bf16 v[112:127], v[180:183], v[64:67], v[112:127]
    ds_read_b64_tr_b16 v[168:169], v2 offset:14336
    ds_read_b64_tr_b16 v[170:171], v2 offset:14848
    v_cvt_pk_bf16_f32 v83, v214, v215
    ds_read_b128 v[192:195], v6 offset:1152
    ds_read_b128 v[196:199], v6 offset:1168
    s_waitcnt lgkmcnt(8)
    v_fma_mix_f32 v208, v84, v200, v200 op_sel:[0,0,1] op_sel_hi:[1,1,1]
    v_fma_mix_f32 v209, v84, v201, v201 op_sel:[1,0,1] op_sel_hi:[1,1,1]
    v_fma_mix_f32 v210, v85, v202, v202 op_sel:[0,0,1] op_sel_hi:[1,1,1]
    v_mfma_f32_32x32x16_bf16 v[96:111], v[184:187], v[68:71], v[96:111]
    ds_read_b64_tr_b16 v[172:173], v3 offset:14336
    ds_read_b64_tr_b16 v[174:175], v3 offset:14848
    v_fma_mix_f32 v211, v85, v203, v203 op_sel:[1,0,1] op_sel_hi:[1,1,1]
    v_fma_mix_f32 v212, v86, v204, v204 op_sel:[0,0,1] op_sel_hi:[1,1,1]
    v_fma_mix_f32 v213, v86, v205, v205 op_sel:[1,0,1] op_sel_hi:[1,1,1]
    v_fma_mix_f32 v214, v87, v206, v206 op_sel:[0,0,1] op_sel_hi:[1,1,1]
    v_mfma_f32_32x32x16_bf16 v[112:127], v[188:191], v[68:71], v[112:127]
    ds_read_b64_tr_b16 v[176:177], v2 offset:32768
    ds_read_b64_tr_b16 v[178:179], v2 offset:33280
    v_fma_mix_f32 v215, v87, v207, v207 op_sel:[1,0,1] op_sel_hi:[1,1,1]
    v_cvt_pk_bf16_f32 v84, v208, v209
    v_cvt_pk_bf16_f32 v85, v210, v211
    v_cvt_pk_bf16_f32 v86, v212, v213
    v_cvt_pk_bf16_f32 v87, v214, v215
    ds_read_b128 v[200:203], v6 offset:1216
    ds_read_b128 v[204:207], v6 offset:1232
    s_mov_b32 exec_lo, 0xff000000
    s_mov_b32 exec_hi, 0x0
    buffer_load_dword v252, v229, s[16:19], s48 offen
    s_mov_b64 exec, -1
    s_waitcnt lgkmcnt(12)
    v_mfma_f32_32x32x16_bf16 v[96:111], v[160:163], v[72:75], v[96:111]
    ds_read_b64_tr_b16 v[180:181], v3 offset:32768
    ds_read_b64_tr_b16 v[182:183], v3 offset:33280
    s_waitcnt lgkmcnt(8)
    v_fma_mix_f32 v208, v88, v192, v192 op_sel:[0,0,1] op_sel_hi:[1,1,1]
    v_fma_mix_f32 v209, v88, v193, v193 op_sel:[1,0,1] op_sel_hi:[1,1,1]
    v_fma_mix_f32 v210, v89, v194, v194 op_sel:[0,0,1] op_sel_hi:[1,1,1]
    v_fma_mix_f32 v211, v89, v195, v195 op_sel:[1,0,1] op_sel_hi:[1,1,1]
    v_mfma_f32_32x32x16_bf16 v[112:127], v[164:167], v[72:75], v[112:127]
    ds_read_b64_tr_b16 v[184:185], v2 offset:34816
    ds_read_b64_tr_b16 v[186:187], v2 offset:35328
    v_fma_mix_f32 v212, v90, v196, v196 op_sel:[0,0,1] op_sel_hi:[1,1,1]
    v_fma_mix_f32 v213, v90, v197, v197 op_sel:[1,0,1] op_sel_hi:[1,1,1]
    v_fma_mix_f32 v214, v91, v198, v198 op_sel:[0,0,1] op_sel_hi:[1,1,1]
    v_fma_mix_f32 v215, v91, v199, v199 op_sel:[1,0,1] op_sel_hi:[1,1,1]
    v_mfma_f32_32x32x16_bf16 v[96:111], v[168:171], v[76:79], v[96:111]
    ds_read_b64_tr_b16 v[188:189], v3 offset:34816
    ds_read_b64_tr_b16 v[190:191], v3 offset:35328
    v_cvt_pk_bf16_f32 v88, v208, v209
    v_cvt_pk_bf16_f32 v89, v210, v211
    v_cvt_pk_bf16_f32 v90, v212, v213
    v_cvt_pk_bf16_f32 v91, v214, v215
    s_nop 1
    s_waitcnt lgkmcnt(10)
    v_mfma_f32_32x32x16_bf16 v[112:127], v[172:175], v[76:79], v[112:127]
    ds_read_b64_tr_b16 v[160:161], v2 offset:53248
    ds_read_b64_tr_b16 v[162:163], v2 offset:53760
    s_waitcnt lgkmcnt(8)
    v_fma_mix_f32 v208, v92, v200, v200 op_sel:[0,0,1] op_sel_hi:[1,1,1]
    v_fma_mix_f32 v209, v92, v201, v201 op_sel:[1,0,1] op_sel_hi:[1,1,1]
    v_fma_mix_f32 v210, v93, v202, v202 op_sel:[0,0,1] op_sel_hi:[1,1,1]
    v_fma_mix_f32 v211, v93, v203, v203 op_sel:[1,0,1] op_sel_hi:[1,1,1]
    v_fma_mix_f32 v212, v94, v204, v204 op_sel:[0,0,1] op_sel_hi:[1,1,1]
    v_mfma_f32_32x32x16_bf16 v[96:111], v[176:179], v[80:83], v[96:111]
    ds_read_b64_tr_b16 v[164:165], v3 offset:53248
    ds_read_b64_tr_b16 v[166:167], v3 offset:53760
    v_fma_mix_f32 v213, v94, v205, v205 op_sel:[1,0,1] op_sel_hi:[1,1,1]
    v_fma_mix_f32 v214, v95, v206, v206 op_sel:[0,0,1] op_sel_hi:[1,1,1]
    v_fma_mix_f32 v215, v95, v207, v207 op_sel:[1,0,1] op_sel_hi:[1,1,1]
    v_cvt_pk_bf16_f32 v92, v208, v209
    s_waitcnt lgkmcnt(8)
    v_mfma_f32_32x32x16_bf16 v[112:127], v[180:183], v[80:83], v[112:127]
    ds_read_b64_tr_b16 v[168:169], v2 offset:55296
    ds_read_b64_tr_b16 v[170:171], v2 offset:55808
    v_cvt_pk_bf16_f32 v93, v210, v211
    v_cvt_pk_bf16_f32 v94, v212, v213
    v_cvt_pk_bf16_f32 v95, v214, v215
    s_nop 1
    s_waitcnt lgkmcnt(8)
    v_mfma_f32_32x32x16_bf16 v[96:111], v[184:187], v[84:87], v[96:111]
    ds_read_b64_tr_b16 v[172:173], v3 offset:55296
    ds_read_b64_tr_b16 v[174:175], v3 offset:55808
    s_waitcnt lgkmcnt(8)
    v_mfma_f32_32x32x16_bf16 v[112:127], v[188:191], v[84:87], v[112:127]
    ds_read_b64_tr_b16 v[176:177], v4 offset:12288
    ds_read_b64_tr_b16 v[178:179], v4 offset:12800
    s_waitcnt lgkmcnt(8)
    v_mfma_f32_32x32x16_bf16 v[96:111], v[160:163], v[88:91], v[96:111]
    ds_read_b64_tr_b16 v[180:181], v5 offset:12288
    ds_read_b64_tr_b16 v[182:183], v5 offset:12800
    s_waitcnt lgkmcnt(8)
    v_mfma_f32_32x32x16_bf16 v[112:127], v[164:167], v[88:91], v[112:127]
    ds_read_b64_tr_b16 v[184:185], v4 offset:14336
    ds_read_b64_tr_b16 v[186:187], v4 offset:14848
    s_mov_b32 exec_lo, 0x0
    s_mov_b32 exec_hi, 0xff
    buffer_load_dword v252, v229, s[16:19], s48 offen
    s_mov_b64 exec, -1
    s_waitcnt lgkmcnt(8)
    v_mfma_f32_32x32x16_bf16 v[96:111], v[168:171], v[92:95], v[96:111]
    ds_read_b64_tr_b16 v[188:189], v5 offset:14336
    ds_read_b64_tr_b16 v[190:191], v5 offset:14848
    s_waitcnt lgkmcnt(8)
    v_mfma_f32_32x32x16_bf16 v[112:127], v[172:175], v[92:95], v[112:127]
    s_waitcnt vmcnt(2)
    s_barrier
    s_mov_b32 s61, 0
P_f_30:
    v_cmp_ne_u32 vcc, 1, v234
    s_add_u32 s61, s61, 1
    s_cbranch_vccz P_fe_31
    s_cmp_gt_u32 s61, 262144
    s_cbranch_scc1 P_fe_31
    s_mov_b32 s62, 65536
    buffer_load_dword v234, v233, s[8:11], s62 offen sc1
    s_waitcnt vmcnt(0)
    s_branch P_f_30
P_fe_31:
    s_cmp_lg_u32 s44, 3
    s_cbranch_scc1 P_3_33
    s_mov_b32 s20, s78
    s_mov_b32 s21, s79
    s_mov_b32 s22, 0x500
    s_mov_b32 s23, 0x20000
    s_lshl_b32 s49, s3, 7
    v_lshl_add_u32 v233, v0, 1, s49
    s_mul_i32 s49, s46, 640
    buffer_load_ushort v236, v233, s[20:23], s49 offen
P_3_33:
    s_lshl1_add_u32 s62, s44, s3
    s_cmp_ge_u32 s62, 2
    s_cbranch_scc1 P_t_32
    s_mul_i32 s49, s45, 640
    s_mul_i32 s50, s3, 2560
    s_sub_u32 s49, s49, s50
    s_add_u32 s49, s49, 289280
    v_lshlrev_b32 v233, 4, v0
    buffer_load_dwordx4 v[236:239], v233, s[8:11], s49 offen sc1
    s_add_u32 s49, s49, 5120
    buffer_load_dwordx4 v[240:243], v233, s[8:11], s49 offen sc1
    s_add_u32 s49, s49, 5120
    buffer_load_dwordx4 v[244:247], v233, s[8:11], s49 offen sc1
    s_add_u32 s49, s49, 5120
    buffer_load_dwordx4 v[248:251], v233, s[8:11], s49 offen sc1
P_t_32:
    ds_read_b64_tr_b16 v[160:161], v2 offset:8192
    ds_read_b64_tr_b16 v[162:163], v2 offset:8704
    s_waitcnt lgkmcnt(8)
    v_mfma_f32_32x32x16_bf16 v[128:143], v[176:179], v[56:59], v[128:143]
    ds_read_b64_tr_b16 v[164:165], v3 offset:8192
    ds_read_b64_tr_b16 v[166:167], v3 offset:8704
    s_waitcnt lgkmcnt(8)
    v_mfma_f32_32x32x16_bf16 v[144:159], v[180:183], v[56:59], v[144:159]
    ds_read_b64_tr_b16 v[168:169], v2 offset:10240
    ds_read_b64_tr_b16 v[170:171], v2 offset:10752
    s_nop 1
    v_mul_f32 v96, v96, v230
    v_mul_f32 v97, v97, v230
    v_mul_f32 v98, v98, v230
    v_mul_f32 v99, v99, v230
    ds_write_b128 v1, v[96:99] offset:0
    v_mul_f32 v100, v100, v230
    v_mul_f32 v101, v101, v230
    s_waitcnt lgkmcnt(9)
    v_mfma_f32_32x32x16_bf16 v[128:143], v[184:187], v[60:63], v[128:143]
    ds_read_b64_tr_b16 v[172:173], v3 offset:10240
    ds_read_b64_tr_b16 v[174:175], v3 offset:10752
    v_mul_f32 v102, v102, v230
    v_mul_f32 v103, v103, v230
    ds_write_b128 v1, v[100:103] offset:1024
    v_mul_f32 v104, v104, v230
    v_mul_f32 v105, v105, v230
    v_mul_f32 v106, v106, v230
    v_mul_f32 v107, v107, v230
    s_waitcnt lgkmcnt(10)
    v_mfma_f32_32x32x16_bf16 v[144:159], v[188:191], v[60:63], v[144:159]
    ds_read_b64_tr_b16 v[176:177], v2 offset:16384
    ds_read_b64_tr_b16 v[178:179], v2 offset:16896
    ds_write_b128 v1, v[104:107] offset:2048
    v_mul_f32 v108, v108, v230
    v_mul_f32 v109, v109, v230
    v_mul_f32 v110, v110, v230
    v_mul_f32 v111, v111, v230
    ds_write_b128 v1, v[108:111] offset:3072
    v_mul_f32 v112, v112, v230
    s_waitcnt lgkmcnt(12)
    v_mfma_f32_32x32x16_bf16 v[128:143], v[160:163], v[64:67], v[128:143]
    ds_read_b64_tr_b16 v[180:181], v3 offset:16384
    ds_read_b64_tr_b16 v[182:183], v3 offset:16896
    v_mul_f32 v113, v113, v230
    v_mul_f32 v114, v114, v230
    v_mul_f32 v115, v115, v230
    ds_write_b128 v1, v[112:115] offset:4096
    v_mul_f32 v116, v116, v230
    v_mul_f32 v117, v117, v230
    v_mul_f32 v118, v118, v230
    s_waitcnt lgkmcnt(13)
    v_mfma_f32_32x32x16_bf16 v[144:159], v[164:167], v[64:67], v[144:159]
    ds_read_b64_tr_b16 v[184:185], v2 offset:18432
    ds_read_b64_tr_b16 v[186:187], v2 offset:18944
    v_mul_f32 v119, v119, v230
    ds_write_b128 v1, v[116:119] offset:5120
    v_mul_f32 v120, v120, v230
    v_mul_f32 v121, v121, v230
    v_mul_f32 v122, v122, v230
    v_mul_f32 v123, v123, v230
    ds_write_b128 v1, v[120:123] offset:6144
    s_waitcnt lgkmcnt(15)
    v_mfma_f32_32x32x16_bf16 v[128:143], v[168:171], v[68:71], v[128:143]
    ds_read_b64_tr_b16 v[188:189], v3 offset:18432
    ds_read_b64_tr_b16 v[190:191], v3 offset:18944
    v_mul_f32 v124, v124, v230
    v_mul_f32 v125, v125, v230
    v_mul_f32 v126, v126, v230
    v_mul_f32 v127, v127, v230
    ds_write_b128 v1, v[124:127] offset:7168
    s_waitcnt lgkmcnt(15)
    v_mfma_f32_32x32x16_bf16 v[144:159], v[172:175], v[68:71], v[144:159]
    s_waitcnt lgkmcnt(0)
    s_barrier
    s_add_u32 m0, s31, 8192
    s_nop 0
    buffer_load_dwordx4 v224, s[16:19], s48 offen lds
    s_add_u32 m0, s31, 9216
    s_nop 0
    buffer_load_dwordx4 v225, s[16:19], s48 offen lds
    s_add_u32 m0, s31, 10240
    s_nop 0
    buffer_load_dwordx4 v226, s[16:19], s48 offen lds
    s_add_u32 m0, s31, 11264
    s_nop 0
    buffer_load_dwordx4 v227, s[16:19], s48 offen lds
    s_add_u32 m0, s31, 12288
    s_nop 0
    buffer_load_dwordx4 v228, s[16:19], s48 offen lds
    ds_read_b64_tr_b16 v[160:161], v2 offset:36864
    ds_read_b64_tr_b16 v[162:163], v2 offset:37376
    ds_read_b128 v[96:99], v9 offset:0
    v_mfma_f32_32x32x16_bf16 v[128:143], v[176:179], v[72:75], v[128:143]
    ds_read_b64_tr_b16 v[164:165], v3 offset:36864
    ds_read_b64_tr_b16 v[166:167], v3 offset:37376
    ds_read_b128 v[100:103], v9 offset:1024
    v_mfma_f32_32x32x16_bf16 v[144:159], v[180:183], v[72:75], v[144:159]
    ds_read_b64_tr_b16 v[168:169], v2 offset:38912
    ds_read_b64_tr_b16 v[170:171], v2 offset:39424
    ds_read_b128 v[104:107], v9 offset:2048
    v_mfma_f32_32x32x16_bf16 v[128:143], v[184:187], v[76:79], v[128:143]
    ds_read_b64_tr_b16 v[172:173], v3 offset:38912
    ds_read_b64_tr_b16 v[174:175], v3 offset:39424
    ds_read_b128 v[108:111], v9 offset:3072
    v_mfma_f32_32x32x16_bf16 v[144:159], v[188:191], v[76:79], v[144:159]
    ds_read_b64_tr_b16 v[176:177], v2 offset:57344
    ds_read_b64_tr_b16 v[178:179], v2 offset:57856
    ds_read_b128 v[112:115], v9 offset:4096
    s_waitcnt lgkmcnt(13)
    v_mfma_f32_32x32x16_bf16 v[128:143], v[160:163], v[80:83], v[128:143]
    ds_read_b64_tr_b16 v[180:181], v3 offset:57344
    ds_read_b64_tr_b16 v[182:183], v3 offset:57856
    ds_read_b128 v[116:119], v9 offset:5120
    s_waitcnt lgkmcnt(13)
    v_mfma_f32_32x32x16_bf16 v[144:159], v[164:167], v[80:83], v[144:159]
    ds_read_b64_tr_b16 v[184:185], v2 offset:59392
    ds_read_b64_tr_b16 v[186:187], v2 offset:59904
    ds_read_b128 v[120:123], v9 offset:6144
    s_waitcnt lgkmcnt(13)
    v_mfma_f32_32x32x16_bf16 v[128:143], v[168:171], v[84:87], v[128:143]
    ds_read_b64_tr_b16 v[188:189], v3 offset:59392
    ds_read_b64_tr_b16 v[190:191], v3 offset:59904
    ds_read_b128 v[124:127], v9 offset:7168
    s_waitcnt lgkmcnt(13)
    v_mfma_f32_32x32x16_bf16 v[144:159], v[172:175], v[84:87], v[144:159]
    s_waitcnt lgkmcnt(10)
    v_mfma_f32_32x32x16_bf16 v[128:143], v[176:179], v[88:91], v[128:143]
    s_waitcnt lgkmcnt(7)
    v_mfma_f32_32x32x16_bf16 v[144:159], v[180:183], v[88:91], v[144:159]
    s_waitcnt lgkmcnt(4)
    v_mfma_f32_32x32x16_bf16 v[128:143], v[184:187], v[92:95], v[128:143]
    s_waitcnt lgkmcnt(1)
    v_mfma_f32_32x32x16_bf16 v[144:159], v[188:191], v[92:95], v[144:159]
    s_cmp_lg_u32 s44, 3
    s_cbranch_scc1 P_3_36
    s_waitcnt vmcnt(5)
    v_lshlrev_b32 v236, 16, v236
    v_mul_f32 v238, 0xbfb8aa3b, v236
    v_exp_f32 v238, v238
    s_nop 0
    v_add_f32 v238, 1.0, v238
    v_rcp_f32 v238, v238
    s_nop 0
    v_mul_f32 v236, v236, v238
    v_cvt_pk_bf16_f32 v236, v236, 0
    v_lshlrev_b32 v237, 16, v236
    ds_write_b16 v233, v236 offset:13312
P_3_36:
    s_lshl1_add_u32 s62, s44, s3
    s_cmp_ge_u32 s62, 2
    s_cbranch_scc1 P_t_34
    v_lshrrev_b32 v11, 1, v0
    v_lshlrev_b32 v11, 6, v11
    v_and_b32 v12, 1, v0
    s_mov_b32 exec_hi, 0xff
    s_cmp_eq_u32 s3, 1
    s_waitcnt vmcnt(5)
    v_add_f32 v236, v236, v240
    v_add_f32 v244, v244, v248
    v_add_f32 v237, v237, v241
    v_add_f32 v245, v245, v249
    v_add_f32 v238, v238, v242
    v_add_f32 v246, v246, v250
    v_add_f32 v239, v239, v243
    v_add_f32 v247, v247, v251
    v_add_f32 v236, v236, v244
    v_add_f32 v237, v237, v245
    v_add_f32 v238, v238, v246
    v_add_f32 v239, v239, v247
    s_cbranch_scc1 P_t2_35
    v_cvt_pk_bf16_f32 v13, v236, v237
    v_lshlrev_b32 v236, 16, v13
    v_and_b32 v237, 0xffff0000, v13
    v_cvt_pk_bf16_f32 v13, v238, v239
    v_lshlrev_b32 v238, 16, v13
    v_and_b32 v239, 0xffff0000, v13
    v_add_f32 v236, 1.0, v236
    v_add_f32 v237, 1.0, v237
    v_add_f32 v238, 1.0, v238
    v_add_f32 v239, 1.0, v239
    v_cvt_pk_bf16_f32 v13, v236, v237
    v_lshlrev_b32 v236, 16, v13
    v_and_b32 v237, 0xffff0000, v13
    v_cvt_pk_bf16_f32 v13, v238, v239
    v_lshlrev_b32 v238, 16, v13
    v_and_b32 v239, 0xffff0000, v13
    v_lshl_add_u32 v11, v12, 4, v11
    ds_write_b128 v11, v[236:239] offset:13312
    s_branch P_t_34
P_t2_35:
    v_cvt_pk_bf16_f32 v236, v236, v237
    v_cvt_pk_bf16_f32 v237, v238, v239
    v_lshl_add_u32 v11, v12, 3, v11
    ds_write_b64 v11, v[236:237] offset:13344
P_t_34:
    s_mov_b64 exec, -1
    s_waitcnt lgkmcnt(0)
    s_nop 9
    v_fma_f32 v128, v128, v230, v96
    v_fma_f32 v129, v129, v230, v97
    v_fma_f32 v130, v130, v230, v98
    v_fma_f32 v131, v131, v230, v99
    v_fma_f32 v132, v132, v230, v100
    v_fma_f32 v133, v133, v230, v101
    v_fma_f32 v134, v134, v230, v102
    v_fma_f32 v135, v135, v230, v103
    v_fma_f32 v136, v136, v230, v104
    v_fma_f32 v137, v137, v230, v105
    v_fma_f32 v138, v138, v230, v106
    v_fma_f32 v139, v139, v230, v107
    v_fma_f32 v140, v140, v230, v108
    v_fma_f32 v141, v141, v230, v109
    v_fma_f32 v142, v142, v230, v110
    v_fma_f32 v143, v143, v230, v111
    v_cvt_pk_bf16_f32 v16, v128, v129
    v_cvt_pk_bf16_f32 v17, v130, v131
    v_cvt_pk_bf16_f32 v18, v132, v133
    v_cvt_pk_bf16_f32 v19, v134, v135
    v_cvt_pk_bf16_f32 v20, v136, v137
    v_cvt_pk_bf16_f32 v21, v138, v139
    v_cvt_pk_bf16_f32 v22, v140, v141
    v_cvt_pk_bf16_f32 v23, v142, v143
    buffer_store_dwordx2 v[16:17], v216, s[8:11], s39 offen sc1
    buffer_store_dwordx2 v[18:19], v217, s[8:11], s39 offen sc1
    buffer_store_dwordx2 v[20:21], v218, s[8:11], s39 offen sc1
    buffer_store_dwordx2 v[22:23], v219, s[8:11], s39 offen sc1
    s_nop 1
    v_fma_f32 v144, v144, v230, v112
    v_fma_f32 v145, v145, v230, v113
    v_fma_f32 v146, v146, v230, v114
    v_fma_f32 v147, v147, v230, v115
    v_fma_f32 v148, v148, v230, v116
    v_fma_f32 v149, v149, v230, v117
    v_fma_f32 v150, v150, v230, v118
    v_fma_f32 v151, v151, v230, v119
    v_fma_f32 v152, v152, v230, v120
    v_fma_f32 v153, v153, v230, v121
    v_fma_f32 v154, v154, v230, v122
    v_fma_f32 v155, v155, v230, v123
    v_fma_f32 v156, v156, v230, v124
    v_fma_f32 v157, v157, v230, v125
    v_fma_f32 v158, v158, v230, v126
    v_fma_f32 v159, v159, v230, v127
    v_cvt_pk_bf16_f32 v24, v144, v145
    v_cvt_pk_bf16_f32 v25, v146, v147
    v_cvt_pk_bf16_f32 v26, v148, v149
    v_cvt_pk_bf16_f32 v27, v150, v151
    v_cvt_pk_bf16_f32 v28, v152, v153
    v_cvt_pk_bf16_f32 v29, v154, v155
    v_cvt_pk_bf16_f32 v30, v156, v157
    v_cvt_pk_bf16_f32 v31, v158, v159
    buffer_store_dwordx2 v[24:25], v220, s[8:11], s39 offen sc1
    buffer_store_dwordx2 v[26:27], v221, s[8:11], s39 offen sc1
    buffer_store_dwordx2 v[28:29], v222, s[8:11], s39 offen sc1
    buffer_store_dwordx2 v[30:31], v223, s[8:11], s39 offen sc1
    s_waitcnt vmcnt(8) lgkmcnt(0)
    s_branch B_e_29
B_v_28:
    s_waitcnt vmcnt(5)
    s_waitcnt lgkmcnt(0)
    s_barrier
    ds_read_b128 v[192:195], v6 offset:0
    ds_read_b128 v[196:199], v6 offset:16
    ds_read_b64_tr_b16 v[160:161], v2 offset:0
    ds_read_b64_tr_b16 v[162:163], v2 offset:512
    ds_read_b64_tr_b16 v[164:165], v3 offset:0
    ds_read_b64_tr_b16 v[166:167], v3 offset:512
    ds_read_b128 v[200:203], v6 offset:64
    ds_read_b128 v[204:207], v6 offset:80
    ds_read_b64_tr_b16 v[168:169], v2 offset:20480
    ds_read_b64_tr_b16 v[170:171], v2 offset:20992
    ds_read_b64_tr_b16 v[172:173], v3 offset:20480
    ds_read_b64_tr_b16 v[174:175], v3 offset:20992
    ds_read_b64_tr_b16 v[176:177], v2 offset:2048
    ds_read_b64_tr_b16 v[178:179], v2 offset:2560
    s_waitcnt lgkmcnt(12)
    v_fma_mix_f32 v208, v16, v192, v192 op_sel:[0,0,1] op_sel_hi:[1,1,1]
    v_fma_mix_f32 v209, v16, v193, v193 op_sel:[1,0,1] op_sel_hi:[1,1,1]
    v_fma_mix_f32 v210, v17, v194, v194 op_sel:[0,0,1] op_sel_hi:[1,1,1]
    v_fma_mix_f32 v211, v17, v195, v195 op_sel:[1,0,1] op_sel_hi:[1,1,1]
    v_fma_mix_f32 v212, v18, v196, v196 op_sel:[0,0,1] op_sel_hi:[1,1,1]
    v_fma_mix_f32 v213, v18, v197, v197 op_sel:[1,0,1] op_sel_hi:[1,1,1]
    v_fma_mix_f32 v214, v19, v198, v198 op_sel:[0,0,1] op_sel_hi:[1,1,1]
    v_fma_mix_f32 v215, v19, v199, v199 op_sel:[1,0,1] op_sel_hi:[1,1,1]
    v_cvt_pk_bf16_f32 v16, v208, v209
    v_cvt_pk_bf16_f32 v17, v210, v211
    v_cvt_pk_bf16_f32 v18, v212, v213
    v_cvt_pk_bf16_f32 v19, v214, v215
    v_add_u32 v1, s31, v9
    s_xor_b32 s29, s3, 4
    s_mul_i32 s29, s29, 20480
    v_add_u32 v9, s29, v9
    s_waitcnt lgkmcnt(10)
    v_mfma_f32_32x32x16_bf16 v[96:111], v[16:19], v[160:163], 0
    ds_read_b64_tr_b16 v[180:181], v3 offset:2048
    ds_read_b64_tr_b16 v[182:183], v3 offset:2560
    s_waitcnt lgkmcnt(8)
    v_fma_mix_f32 v208, v20, v200, v200 op_sel:[0,0,1] op_sel_hi:[1,1,1]
    v_fma_mix_f32 v209, v20, v201, v201 op_sel:[1,0,1] op_sel_hi:[1,1,1]
    v_fma_mix_f32 v210, v21, v202, v202 op_sel:[0,0,1] op_sel_hi:[1,1,1]
    v_fma_mix_f32 v211, v21, v203, v203 op_sel:[1,0,1] op_sel_hi:[1,1,1]
    s_lshl_b32 s34, s26, 3
    s_lshr_b32 s34, 0x3221202, s34
    s_bitcmp1_b32 s34, 4
    s_cselect_b32 s35, s33, s32
    s_bitcmp1_b32 s34, 5
    s_cselect_b32 s43, 122880, 0
    s_add_u32 s35, s35, s43
    s_and_b32 s34, s34, 15
    s_add_u32 s34, s34, s57
    s_cmp_ge_u32 s34, 5
    s_cselect_b32 s43, 5, 0
    s_sub_u32 s34, s34, s43
    s_mul_i32 s34, s34, 245760
    s_add_u32 s34, s34, s35
    s_add_u32 m0, s31, 8192
    s_nop 0
    buffer_load_dwordx4 v7, s[12:15], s34 offen lds
    s_add_u32 m0, s31, 9216
    s_add_u32 s34, s34, 30720
    buffer_load_dwordx4 v7, s[12:15], s34 offen lds
    s_add_u32 m0, s31, 10240
    s_add_u32 s34, s34, 30720
    buffer_load_dwordx4 v7, s[12:15], s34 offen lds
    s_add_u32 m0, s31, 11264
    s_add_u32 s34, s34, 30720
    buffer_load_dwordx4 v7, s[12:15], s34 offen lds
    v_mfma_f32_32x32x16_bf16 v[112:127], v[16:19], v[164:167], 0
    ds_read_b64_tr_b16 v[184:185], v2 offset:22528
    ds_read_b64_tr_b16 v[186:187], v2 offset:23040
    v_fma_mix_f32 v212, v22, v204, v204 op_sel:[0,0,1] op_sel_hi:[1,1,1]
    v_fma_mix_f32 v213, v22, v205, v205 op_sel:[1,0,1] op_sel_hi:[1,1,1]
    v_fma_mix_f32 v214, v23, v206, v206 op_sel:[0,0,1] op_sel_hi:[1,1,1]
    v_fma_mix_f32 v215, v23, v207, v207 op_sel:[1,0,1] op_sel_hi:[1,1,1]
    s_waitcnt lgkmcnt(8)
    v_mfma_f32_32x32x16_bf16 v[128:143], v[16:19], v[168:171], 0
    ds_read_b64_tr_b16 v[188:189], v3 offset:22528
    ds_read_b64_tr_b16 v[190:191], v3 offset:23040
    v_cvt_pk_bf16_f32 v20, v208, v209
    v_cvt_pk_bf16_f32 v21, v210, v211
    v_cvt_pk_bf16_f32 v22, v212, v213
    v_cvt_pk_bf16_f32 v23, v214, v215
    ds_read_b128 v[192:195], v6 offset:128
    ds_read_b128 v[196:199], v6 offset:144
    ds_read_b128 v[200:203], v6 offset:192
    ds_read_b128 v[204:207], v6 offset:208
    s_waitcnt lgkmcnt(12)
    v_mfma_f32_32x32x16_bf16 v[144:159], v[16:19], v[172:175], 0
    ds_read_b64_tr_b16 v[160:161], v2 offset:40960
    ds_read_b64_tr_b16 v[162:163], v2 offset:41472
    s_waitcnt lgkmcnt(4)
    v_fma_mix_f32 v208, v24, v192, v192 op_sel:[0,0,1] op_sel_hi:[1,1,1]
    v_fma_mix_f32 v209, v24, v193, v193 op_sel:[1,0,1] op_sel_hi:[1,1,1]
    v_fma_mix_f32 v210, v25, v194, v194 op_sel:[0,0,1] op_sel_hi:[1,1,1]
    v_fma_mix_f32 v211, v25, v195, v195 op_sel:[1,0,1] op_sel_hi:[1,1,1]
    v_fma_mix_f32 v212, v26, v196, v196 op_sel:[0,0,1] op_sel_hi:[1,1,1]
    s_lshl_b32 s34, s26, 3
    s_lshr_b32 s34, 0x32240423, s34
    s_bitcmp1_b32 s34, 4
    s_cselect_b32 s35, s33, s32
    s_bitcmp1_b32 s34, 5
    s_cselect_b32 s43, 122880, 0
    s_add_u32 s35, s35, s43
    s_and_b32 s34, s34, 15
    s_add_u32 s34, s34, s57
    s_cmp_ge_u32 s34, 5
    s_cselect_b32 s43, 5, 0
    s_sub_u32 s34, s34, s43
    s_mul_i32 s34, s34, 245760
    s_add_u32 s34, s34, s35
    s_add_u32 m0, s31, 12288
    s_nop 0
    buffer_load_dwordx4 v7, s[12:15], s34 offen lds
    s_add_u32 m0, s31, 13312
    s_add_u32 s34, s34, 30720
    buffer_load_dwordx4 v7, s[12:15], s34 offen lds
    s_add_u32 m0, s31, 14336
    s_add_u32 s34, s34, 30720
    buffer_load_dwordx4 v7, s[12:15], s34 offen lds
    s_add_u32 m0, s31, 15360
    s_add_u32 s34, s34, 30720
    buffer_load_dwordx4 v7, s[12:15], s34 offen lds
    v_mfma_f32_32x32x16_bf16 v[96:111], v[20:23], v[176:179], v[96:111]
    ds_read_b64_tr_b16 v[164:165], v3 offset:40960
    ds_read_b64_tr_b16 v[166:167], v3 offset:41472
    v_fma_mix_f32 v213, v26, v197, v197 op_sel:[1,0,1] op_sel_hi:[1,1,1]
    v_fma_mix_f32 v214, v27, v198, v198 op_sel:[0,0,1] op_sel_hi:[1,1,1]
    v_fma_mix_f32 v215, v27, v199, v199 op_sel:[1,0,1] op_sel_hi:[1,1,1]
    v_cvt_pk_bf16_f32 v24, v208, v209
    v_mfma_f32_32x32x16_bf16 v[112:127], v[20:23], v[180:183], v[112:127]
    ds_read_b64_tr_b16 v[168:169], v4 offset:0
    ds_read_b64_tr_b16 v[170:171], v4 offset:512
    v_cvt_pk_bf16_f32 v25, v210, v211
    v_cvt_pk_bf16_f32 v26, v212, v213
    v_cvt_pk_bf16_f32 v27, v214, v215
    ds_read_b128 v[192:195], v6 offset:256
    ds_read_b128 v[196:199], v6 offset:272
    s_waitcnt lgkmcnt(8)
    v_fma_mix_f32 v208, v28, v200, v200 op_sel:[0,0,1] op_sel_hi:[1,1,1]
    s_mov_b32 exec_lo, 0xff
    s_mov_b32 exec_hi, 0x0
    buffer_load_dword v252, v229, s[16:19], s48 offen
    s_mov_b64 exec, -1
    v_mfma_f32_32x32x16_bf16 v[128:143], v[20:23], v[184:187], v[128:143]
    ds_read_b64_tr_b16 v[172:173], v5 offset:0
    ds_read_b64_tr_b16 v[174:175], v5 offset:512
    v_fma_mix_f32 v209, v28, v201, v201 op_sel:[1,0,1] op_sel_hi:[1,1,1]
    v_fma_mix_f32 v210, v29, v202, v202 op_sel:[0,0,1] op_sel_hi:[1,1,1]
    v_fma_mix_f32 v211, v29, v203, v203 op_sel:[1,0,1] op_sel_hi:[1,1,1]
    v_fma_mix_f32 v212, v30, v204, v204 op_sel:[0,0,1] op_sel_hi:[1,1,1]
    v_mfma_f32_32x32x16_bf16 v[144:159], v[20:23], v[188:191], v[144:159]
    ds_read_b64_tr_b16 v[176:177], v2 offset:43008
    ds_read_b64_tr_b16 v[178:179], v2 offset:43520
    v_fma_mix_f32 v213, v30, v205, v205 op_sel:[1,0,1] op_sel_hi:[1,1,1]
    v_fma_mix_f32 v214, v31, v206, v206 op_sel:[0,0,1] op_sel_hi:[1,1,1]
    v_fma_mix_f32 v215, v31, v207, v207 op_sel:[1,0,1] op_sel_hi:[1,1,1]
    v_cvt_pk_bf16_f32 v28, v208, v209
    v_cvt_pk_bf16_f32 v29, v210, v211
    s_waitcnt lgkmcnt(10)
    v_mfma_f32_32x32x16_bf16 v[96:111], v[24:27], v[160:163], v[96:111]
    ds_read_b64_tr_b16 v[180:181], v3 offset:43008
    ds_read_b64_tr_b16 v[182:183], v3 offset:43520
    v_cvt_pk_bf16_f32 v30, v212, v213
    v_cvt_pk_bf16_f32 v31, v214, v215
    ds_read_b128 v[200:203], v6 offset:320
    ds_read_b128 v[204:207], v6 offset:336
    s_waitcnt lgkmcnt(8)
    v_fma_mix_f32 v208, v32, v192, v192 op_sel:[0,0,1] op_sel_hi:[1,1,1]
    v_fma_mix_f32 v209, v32, v193, v193 op_sel:[1,0,1] op_sel_hi:[1,1,1]
    v_mfma_f32_32x32x16_bf16 v[112:127], v[24:27], v[164:167], v[112:127]
    ds_read_b64_tr_b16 v[184:185], v4 offset:2048
    ds_read_b64_tr_b16 v[186:187], v4 offset:2560
    v_fma_mix_f32 v210, v33, v194, v194 op_sel:[0,0,1] op_sel_hi:[1,1,1]
    v_fma_mix_f32 v211, v33, v195, v195 op_sel:[1,0,1] op_sel_hi:[1,1,1]
    v_fma_mix_f32 v212, v34, v196, v196 op_sel:[0,0,1] op_sel_hi:[1,1,1]
    v_fma_mix_f32 v213, v34, v197, v197 op_sel:[1,0,1] op_sel_hi:[1,1,1]
    v_mfma_f32_32x32x16_bf16 v[128:143], v[24:27], v[168:171], v[128:143]
    ds_read_b64_tr_b16 v[188:189], v5 offset:2048
    ds_read_b64_tr_b16 v[190:191], v5 offset:2560
    v_fma_mix_f32 v214, v35, v198, v198 op_sel:[0,0,1] op_sel_hi:[1,1,1]
    v_fma_mix_f32 v215, v35, v199, v199 op_sel:[1,0,1] op_sel_hi:[1,1,1]
    v_cvt_pk_bf16_f32 v32, v208, v209
    v_cvt_pk_bf16_f32 v33, v210, v211
    s_waitcnt lgkmcnt(10)
    v_mfma_f32_32x32x16_bf16 v[144:159], v[24:27], v[172:175], v[144:159]
    s_waitcnt vmcnt(9)
    s_barrier
    ds_read_b64_tr_b16 v[160:161], v2 offset:4096
    ds_read_b64_tr_b16 v[162:163], v2 offset:4608
    v_cvt_pk_bf16_f32 v34, v212, v213
    v_cvt_pk_bf16_f32 v35, v214, v215
    ds_read_b128 v[192:195], v6 offset:384
    ds_read_b128 v[196:199], v6 offset:400
    s_waitcnt lgkmcnt(8)
    v_fma_mix_f32 v208, v36, v200, v200 op_sel:[0,0,1] op_sel_hi:[1,1,1]
    v_fma_mix_f32 v209, v36, v201, v201 op_sel:[1,0,1] op_sel_hi:[1,1,1]
    v_fma_mix_f32 v210, v37, v202, v202 op_sel:[0,0,1] op_sel_hi:[1,1,1]
    v_mfma_f32_32x32x16_bf16 v[96:111], v[28:31], v[176:179], v[96:111]
    ds_read_b64_tr_b16 v[164:165], v3 offset:4096
    ds_read_b64_tr_b16 v[166:167], v3 offset:4608
    v_fma_mix_f32 v211, v37, v203, v203 op_sel:[1,0,1] op_sel_hi:[1,1,1]
    v_fma_mix_f32 v212, v38, v204, v204 op_sel:[0,0,1] op_sel_hi:[1,1,1]
    v_fma_mix_f32 v213, v38, v205, v205 op_sel:[1,0,1] op_sel_hi:[1,1,1]
    v_fma_mix_f32 v214, v39, v206, v206 op_sel:[0,0,1] op_sel_hi:[1,1,1]
    v_mfma_f32_32x32x16_bf16 v[112:127], v[28:31], v[180:183], v[112:127]
    ds_read_b64_tr_b16 v[168:169], v2 offset:24576
    ds_read_b64_tr_b16 v[170:171], v2 offset:25088
    v_fma_mix_f32 v215, v39, v207, v207 op_sel:[1,0,1] op_sel_hi:[1,1,1]
    v_cvt_pk_bf16_f32 v36, v208, v209
    v_cvt_pk_bf16_f32 v37, v210, v211
    v_cvt_pk_bf16_f32 v38, v212, v213
    s_waitcnt lgkmcnt(10)
    v_mfma_f32_32x32x16_bf16 v[128:143], v[28:31], v[184:187], v[128:143]
    ds_read_b64_tr_b16 v[172:173], v3 offset:24576
    ds_read_b64_tr_b16 v[174:175], v3 offset:25088
    v_cvt_pk_bf16_f32 v39, v214, v215
    ds_read_b128 v[200:203], v6 offset:448
    ds_read_b128 v[204:207], v6 offset:464
    s_waitcnt lgkmcnt(8)
    v_fma_mix_f32 v208, v40, v192, v192 op_sel:[0,0,1] op_sel_hi:[1,1,1]
    v_fma_mix_f32 v209, v40, v193, v193 op_sel:[1,0,1] op_sel_hi:[1,1,1]
    v_fma_mix_f32 v210, v41, v194, v194 op_sel:[0,0,1] op_sel_hi:[1,1,1]
    v_mfma_f32_32x32x16_bf16 v[144:159], v[28:31], v[188:191], v[144:159]
    ds_read_b64_tr_b16 v[176:177], v2 offset:6144
    ds_read_b64_tr_b16 v[178:179], v2 offset:6656
    v_fma_mix_f32 v211, v41, v195, v195 op_sel:[1,0,1] op_sel_hi:[1,1,1]
    v_fma_mix_f32 v212, v42, v196, v196 op_sel:[0,0,1] op_sel_hi:[1,1,1]
    v_fma_mix_f32 v213, v42, v197, v197 op_sel:[1,0,1] op_sel_hi:[1,1,1]
    v_fma_mix_f32 v214, v43, v198, v198 op_sel:[0,0,1] op_sel_hi:[1,1,1]
    v_fma_mix_f32 v215, v43, v199, v199 op_sel:[1,0,1] op_sel_hi:[1,1,1]
    v_mfma_f32_32x32x16_bf16 v[96:111], v[32:35], v[160:163], v[96:111]
    ds_read_b64_tr_b16 v[180:181], v3 offset:6144
    ds_read_b64_tr_b16 v[182:183], v3 offset:6656
    v_cvt_pk_bf16_f32 v40, v208, v209
    v_cvt_pk_bf16_f32 v41, v210, v211
    v_cvt_pk_bf16_f32 v42, v212, v213
    v_cvt_pk_bf16_f32 v43, v214, v215
    ds_read_b128 v[192:195], v6 offset:512
    ds_read_b128 v[196:199], v6 offset:528
    s_waitcnt lgkmcnt(12)
    v_mfma_f32_32x32x16_bf16 v[112:127], v[32:35], v[164:167], v[112:127]
    ds_read_b64_tr_b16 v[184:185], v2 offset:26624
    ds_read_b64_tr_b16 v[186:187], v2 offset:27136
    s_waitcnt lgkmcnt(8)
    v_fma_mix_f32 v208, v44, v200, v200 op_sel:[0,0,1] op_sel_hi:[1,1,1]
    v_fma_mix_f32 v209, v44, v201, v201 op_sel:[1,0,1] op_sel_hi:[1,1,1]
    v_fma_mix_f32 v210, v45, v202, v202 op_sel:[0,0,1] op_sel_hi:[1,1,1]
    v_fma_mix_f32 v211, v45, v203, v203 op_sel:[1,0,1] op_sel_hi:[1,1,1]
    v_mfma_f32_32x32x16_bf16 v[128:143], v[32:35], v[168:171], v[128:143]
    ds_read_b64_tr_b16 v[188:189], v3 offset:26624
    ds_read_b64_tr_b16 v[190:191], v3 offset:27136
    v_fma_mix_f32 v212, v46, v204, v204 op_sel:[0,0,1] op_sel_hi:[1,1,1]
    v_fma_mix_f32 v213, v46, v205, v205 op_sel:[1,0,1] op_sel_hi:[1,1,1]
    v_fma_mix_f32 v214, v47, v206, v206 op_sel:[0,0,1] op_sel_hi:[1,1,1]
    v_fma_mix_f32 v215, v47, v207, v207 op_sel:[1,0,1] op_sel_hi:[1,1,1]
    v_mfma_f32_32x32x16_bf16 v[144:159], v[32:35], v[172:175], v[144:159]
    ds_read_b64_tr_b16 v[160:161], v2 offset:45056
    ds_read_b64_tr_b16 v[162:163], v2 offset:45568
    v_cvt_pk_bf16_f32 v44, v208, v209
    v_cvt_pk_bf16_f32 v45, v210, v211
    v_cvt_pk_bf16_f32 v46, v212, v213
    v_cvt_pk_bf16_f32 v47, v214, v215
    ds_read_b128 v[200:203], v6 offset:576
    ds_read_b128 v[204:207], v6 offset:592
    s_waitcnt lgkmcnt(8)
    v_fma_mix_f32 v208, v48, v192, v192 op_sel:[0,0,1] op_sel_hi:[1,1,1]
    s_mov_b32 exec_lo, 0xff00
    s_mov_b32 exec_hi, 0x0
    buffer_load_dword v252, v229, s[16:19], s48 offen
    s_mov_b64 exec, -1
    v_mfma_f32_32x32x16_bf16 v[96:111], v[36:39], v[176:179], v[96:111]
    ds_read_b64_tr_b16 v[164:165], v3 offset:45056
    ds_read_b64_tr_b16 v[166:167], v3 offset:45568
    v_fma_mix_f32 v209, v48, v193, v193 op_sel:[1,0,1] op_sel_hi:[1,1,1]
    v_fma_mix_f32 v210, v49, v194, v194 op_sel:[0,0,1] op_sel_hi:[1,1,1]
    v_fma_mix_f32 v211, v49, v195, v195 op_sel:[1,0,1] op_sel_hi:[1,1,1]
    v_fma_mix_f32 v212, v50, v196, v196 op_sel:[0,0,1] op_sel_hi:[1,1,1]
    v_mfma_f32_32x32x16_bf16 v[112:127], v[36:39], v[180:183], v[112:127]
    ds_read_b64_tr_b16 v[168:169], v4 offset:4096
    ds_read_b64_tr_b16 v[170:171], v4 offset:4608
    v_fma_mix_f32 v213, v50, v197, v197 op_sel:[1,0,1] op_sel_hi:[1,1,1]
    v_fma_mix_f32 v214, v51, v198, v198 op_sel:[0,0,1] op_sel_hi:[1,1,1]
    v_fma_mix_f32 v215, v51, v199, v199 op_sel:[1,0,1] op_sel_hi:[1,1,1]
    v_cvt_pk_bf16_f32 v48, v208, v209
    s_waitcnt lgkmcnt(10)
    v_mfma_f32_32x32x16_bf16 v[128:143], v[36:39], v[184:187], v[128:143]
    ds_read_b64_tr_b16 v[172:173], v5 offset:4096
    ds_read_b64_tr_b16 v[174:175], v5 offset:4608
    v_cvt_pk_bf16_f32 v49, v210, v211
    v_cvt_pk_bf16_f32 v50, v212, v213
    v_cvt_pk_bf16_f32 v51, v214, v215
    ds_read_b128 v[192:195], v6 offset:640
    ds_read_b128 v[196:199], v6 offset:656
    s_waitcnt lgkmcnt(8)
    v_fma_mix_f32 v208, v52, v200, v200 op_sel:[0,0,1] op_sel_hi:[1,1,1]
    v_mfma_f32_32x32x16_bf16 v[144:159], v[36:39], v[188:191], v[144:159]
    ds_read_b64_tr_b16 v[176:177], v2 offset:47104
    ds_read_b64_tr_b16 v[178:179], v2 offset:47616
    v_fma_mix_f32 v209, v52, v201, v201 op_sel:[1,0,1] op_sel_hi:[1,1,1]
    v_fma_mix_f32 v210, v53, v202, v202 op_sel:[0,0,1] op_sel_hi:[1,1,1]
    v_fma_mix_f32 v211, v53, v203, v203 op_sel:[1,0,1] op_sel_hi:[1,1,1]
    v_fma_mix_f32 v212, v54, v204, v204 op_sel:[0,0,1] op_sel_hi:[1,1,1]
    v_fma_mix_f32 v213, v54, v205, v205 op_sel:[1,0,1] op_sel_hi:[1,1,1]
    v_mfma_f32_32x32x16_bf16 v[96:111], v[40:43], v[160:163], v[96:111]
    ds_read_b64_tr_b16 v[180:181], v3 offset:47104
    ds_read_b64_tr_b16 v[182:183], v3 offset:47616
    v_fma_mix_f32 v214, v55, v206, v206 op_sel:[0,0,1] op_sel_hi:[1,1,1]
    v_fma_mix_f32 v215, v55, v207, v207 op_sel:[1,0,1] op_sel_hi:[1,1,1]
    v_cvt_pk_bf16_f32 v52, v208, v209
    v_cvt_pk_bf16_f32 v53, v210, v211
    s_waitcnt lgkmcnt(10)
    v_mfma_f32_32x32x16_bf16 v[112:127], v[40:43], v[164:167], v[112:127]
    ds_read_b64_tr_b16 v[184:185], v4 offset:6144
    ds_read_b64_tr_b16 v[186:187], v4 offset:6656
    v_cvt_pk_bf16_f32 v54, v212, v213
    v_cvt_pk_bf16_f32 v55, v214, v215
    ds_read_b128 v[200:203], v6 offset:704
    ds_read_b128 v[204:207], v6 offset:720
    s_waitcnt lgkmcnt(8)
    v_fma_mix_f32 v208, v56, v192, v192 op_sel:[0,0,1] op_sel_hi:[1,1,1]
    v_fma_mix_f32 v209, v56, v193, v193 op_sel:[1,0,1] op_sel_hi:[1,1,1]
    v_mfma_f32_32x32x16_bf16 v[128:143], v[40:43], v[168:171], v[128:143]
    ds_read_b64_tr_b16 v[188:189], v5 offset:6144
    ds_read_b64_tr_b16 v[190:191], v5 offset:6656
    v_fma_mix_f32 v210, v57, v194, v194 op_sel:[0,0,1] op_sel_hi:[1,1,1]
    v_fma_mix_f32 v211, v57, v195, v195 op_sel:[1,0,1] op_sel_hi:[1,1,1]
    v_fma_mix_f32 v212, v58, v196, v196 op_sel:[0,0,1] op_sel_hi:[1,1,1]
    v_fma_mix_f32 v213, v58, v197, v197 op_sel:[1,0,1] op_sel_hi:[1,1,1]
    v_mfma_f32_32x32x16_bf16 v[144:159], v[40:43], v[172:175], v[144:159]
    s_waitcnt vmcnt(6)
    s_barrier
    ds_read_b64_tr_b16 v[160:161], v2 offset:8192
    ds_read_b64_tr_b16 v[162:163], v2 offset:8704
    v_fma_mix_f32 v214, v59, v198, v198 op_sel:[0,0,1] op_sel_hi:[1,1,1]
    v_fma_mix_f32 v215, v59, v199, v199 op_sel:[1,0,1] op_sel_hi:[1,1,1]
    v_cvt_pk_bf16_f32 v56, v208, v209
    v_cvt_pk_bf16_f32 v57, v210, v211
    v_cvt_pk_bf16_f32 v58, v212, v213
    s_waitcnt lgkmcnt(10)
    v_mfma_f32_32x32x16_bf16 v[96:111], v[44:47], v[176:179], v[96:111]
    ds_read_b64_tr_b16 v[164:165], v3 offset:8192
    ds_read_b64_tr_b16 v[166:167], v3 offset:8704
    v_cvt_pk_bf16_f32 v59, v214, v215
    ds_read_b128 v[192:195], v6 offset:768
    ds_read_b128 v[196:199], v6 offset:784
    s_waitcnt lgkmcnt(8)
    v_fma_mix_f32 v208, v60, v200, v200 op_sel:[0,0,1] op_sel_hi:[1,1,1]
    v_fma_mix_f32 v209, v60, v201, v201 op_sel:[1,0,1] op_sel_hi:[1,1,1]
    v_fma_mix_f32 v210, v61, v202, v202 op_sel:[0,0,1] op_sel_hi:[1,1,1]
    v_mfma_f32_32x32x16_bf16 v[112:127], v[44:47], v[180:183], v[112:127]
    ds_read_b64_tr_b16 v[168:169], v2 offset:28672
    ds_read_b64_tr_b16 v[170:171], v2 offset:29184
    v_fma_mix_f32 v211, v61, v203, v203 op_sel:[1,0,1] op_sel_hi:[1,1,1]
    v_fma_mix_f32 v212, v62, v204, v204 op_sel:[0,0,1] op_sel_hi:[1,1,1]
    v_fma_mix_f32 v213, v62, v205, v205 op_sel:[1,0,1] op_sel_hi:[1,1,1]
    v_fma_mix_f32 v214, v63, v206, v206 op_sel:[0,0,1] op_sel_hi:[1,1,1]
    v_mfma_f32_32x32x16_bf16 v[128:143], v[44:47], v[184:187], v[128:143]
    ds_read_b64_tr_b16 v[172:173], v3 offset:28672
    ds_read_b64_tr_b16 v[174:175], v3 offset:29184
    v_fma_mix_f32 v215, v63, v207, v207 op_sel:[1,0,1] op_sel_hi:[1,1,1]
    v_cvt_pk_bf16_f32 v60, v208, v209
    v_cvt_pk_bf16_f32 v61, v210, v211
    v_cvt_pk_bf16_f32 v62, v212, v213
    s_waitcnt lgkmcnt(10)
    v_mfma_f32_32x32x16_bf16 v[144:159], v[44:47], v[188:191], v[144:159]
    ds_read_b64_tr_b16 v[176:177], v2 offset:10240
    ds_read_b64_tr_b16 v[178:179], v2 offset:10752
    v_cvt_pk_bf16_f32 v63, v214, v215
    ds_read_b128 v[200:203], v6 offset:832
    ds_read_b128 v[204:207], v6 offset:848
    s_waitcnt lgkmcnt(8)
    v_fma_mix_f32 v208, v64, v192, v192 op_sel:[0,0,1] op_sel_hi:[1,1,1]
    v_fma_mix_f32 v209, v64, v193, v193 op_sel:[1,0,1] op_sel_hi:[1,1,1]
    v_fma_mix_f32 v210, v65, v194, v194 op_sel:[0,0,1] op_sel_hi:[1,1,1]
    v_fma_mix_f32 v211, v65, v195, v195 op_sel:[1,0,1] op_sel_hi:[1,1,1]
    v_mfma_f32_32x32x16_bf16 v[96:111], v[48:51], v[160:163], v[96:111]
    ds_read_b64_tr_b16 v[180:181], v3 offset:10240
    ds_read_b64_tr_b16 v[182:183], v3 offset:10752
    v_fma_mix_f32 v212, v66, v196, v196 op_sel:[0,0,1] op_sel_hi:[1,1,1]
    v_fma_mix_f32 v213, v66, v197, v197 op_sel:[1,0,1] op_sel_hi:[1,1,1]
    v_fma_mix_f32 v214, v67, v198, v198 op_sel:[0,0,1] op_sel_hi:[1,1,1]
    v_fma_mix_f32 v215, v67, v199, v199 op_sel:[1,0,1] op_sel_hi:[1,1,1]
    v_mfma_f32_32x32x16_bf16 v[112:127], v[48:51], v[164:167], v[112:127]
    ds_read_b64_tr_b16 v[184:185], v2 offset:30720
    ds_read_b64_tr_b16 v[186:187], v2 offset:31232
    v_cvt_pk_bf16_f32 v64, v208, v209
    v_cvt_pk_bf16_f32 v65, v210, v211
    v_cvt_pk_bf16_f32 v66, v212, v213
    v_cvt_pk_bf16_f32 v67, v214, v215
    ds_read_b128 v[192:195], v6 offset:896
    ds_read_b128 v[196:199], v6 offset:912
    s_mov_b32 exec_lo, 0xff0000
    s_mov_b32 exec_hi, 0x0
    buffer_load_dword v252, v229, s[16:19], s48 offen
    s_mov_b64 exec, -1
    s_waitcnt lgkmcnt(12)
    v_mfma_f32_32x32x16_bf16 v[128:143], v[48:51], v[168:171], v[128:143]
    ds_read_b64_tr_b16 v[188:189], v3 offset:30720
    ds_read_b64_tr_b16 v[190:191], v3 offset:31232
    s_waitcnt lgkmcnt(8)
    v_fma_mix_f32 v208, v68, v200, v200 op_sel:[0,0,1] op_sel_hi:[1,1,1]
    v_fma_mix_f32 v209, v68, v201, v201 op_sel:[1,0,1] op_sel_hi:[1,1,1]
    v_fma_mix_f32 v210, v69, v202, v202 op_sel:[0,0,1] op_sel_hi:[1,1,1]
    v_fma_mix_f32 v211, v69, v203, v203 op_sel:[1,0,1] op_sel_hi:[1,1,1]
    v_mfma_f32_32x32x16_bf16 v[144:159], v[48:51], v[172:175], v[144:159]
    ds_read_b64_tr_b16 v[160:161], v2 offset:49152
    ds_read_b64_tr_b16 v[162:163], v2 offset:49664
    v_fma_mix_f32 v212, v70, v204, v204 op_sel:[0,0,1] op_sel_hi:[1,1,1]
    v_fma_mix_f32 v213, v70, v205, v205 op_sel:[1,0,1] op_sel_hi:[1,1,1]
    v_fma_mix_f32 v214, v71, v206, v206 op_sel:[0,0,1] op_sel_hi:[1,1,1]
    v_fma_mix_f32 v215, v71, v207, v207 op_sel:[1,0,1] op_sel_hi:[1,1,1]
    v_cvt_pk_bf16_f32 v68, v208, v209
    v_mfma_f32_32x32x16_bf16 v[96:111], v[52:55], v[176:179], v[96:111]
    ds_read_b64_tr_b16 v[164:165], v3 offset:49152
    ds_read_b64_tr_b16 v[166:167], v3 offset:49664
    v_cvt_pk_bf16_f32 v69, v210, v211
    v_cvt_pk_bf16_f32 v70, v212, v213
    v_cvt_pk_bf16_f32 v71, v214, v215
    ds_read_b128 v[200:203], v6 offset:960
    ds_read_b128 v[204:207], v6 offset:976
    s_waitcnt lgkmcnt(8)
    v_fma_mix_f32 v208, v72, v192, v192 op_sel:[0,0,1] op_sel_hi:[1,1,1]
    v_mfma_f32_32x32x16_bf16 v[112:127], v[52:55], v[180:183], v[112:127]
    ds_read_b64_tr_b16 v[168:169], v2 offset:51200
    ds_read_b64_tr_b16 v[170:171], v2 offset:51712
    v_fma_mix_f32 v209, v72, v193, v193 op_sel:[1,0,1] op_sel_hi:[1,1,1]
    v_fma_mix_f32 v210, v73, v194, v194 op_sel:[0,0,1] op_sel_hi:[1,1,1]
    v_fma_mix_f32 v211, v73, v195, v195 op_sel:[1,0,1] op_sel_hi:[1,1,1]
    v_fma_mix_f32 v212, v74, v196, v196 op_sel:[0,0,1] op_sel_hi:[1,1,1]
    v_mfma_f32_32x32x16_bf16 v[128:143], v[52:55], v[184:187], v[128:143]
    ds_read_b64_tr_b16 v[172:173], v3 offset:51200
    ds_read_b64_tr_b16 v[174:175], v3 offset:51712
    v_fma_mix_f32 v213, v74, v197, v197 op_sel:[1,0,1] op_sel_hi:[1,1,1]
    v_fma_mix_f32 v214, v75, v198, v198 op_sel:[0,0,1] op_sel_hi:[1,1,1]
    v_fma_mix_f32 v215, v75, v199, v199 op_sel:[1,0,1] op_sel_hi:[1,1,1]
    v_cvt_pk_bf16_f32 v72, v208, v209
    s_waitcnt lgkmcnt(10)
    v_mfma_f32_32x32x16_bf16 v[144:159], v[52:55], v[188:191], v[144:159]
    ds_read_b64_tr_b16 v[176:177], v4 offset:8192
    ds_read_b64_tr_b16 v[178:179], v4 offset:8704
    v_cvt_pk_bf16_f32 v73, v210, v211
    v_cvt_pk_bf16_f32 v74, v212, v213
    v_cvt_pk_bf16_f32 v75, v214, v215
    ds_read_b128 v[192:195], v6 offset:1024
    ds_read_b128 v[196:199], v6 offset:1040
    s_waitcnt lgkmcnt(8)
    v_fma_mix_f32 v208, v76, v200, v200 op_sel:[0,0,1] op_sel_hi:[1,1,1]
    v_fma_mix_f32 v209, v76, v201, v201 op_sel:[1,0,1] op_sel_hi:[1,1,1]
    v_mfma_f32_32x32x16_bf16 v[96:111], v[56:59], v[160:163], v[96:111]
    ds_read_b64_tr_b16 v[180:181], v5 offset:8192
    ds_read_b64_tr_b16 v[182:183], v5 offset:8704
    v_fma_mix_f32 v210, v77, v202, v202 op_sel:[0,0,1] op_sel_hi:[1,1,1]
    v_fma_mix_f32 v211, v77, v203, v203 op_sel:[1,0,1] op_sel_hi:[1,1,1]
    v_fma_mix_f32 v212, v78, v204, v204 op_sel:[0,0,1] op_sel_hi:[1,1,1]
    v_fma_mix_f32 v213, v78, v205, v205 op_sel:[1,0,1] op_sel_hi:[1,1,1]
    v_mfma_f32_32x32x16_bf16 v[112:127], v[56:59], v[164:167], v[112:127]
    ds_read_b64_tr_b16 v[184:185], v4 offset:10240
    ds_read_b64_tr_b16 v[186:187], v4 offset:10752
    v_fma_mix_f32 v214, v79, v206, v206 op_sel:[0,0,1] op_sel_hi:[1,1,1]
    v_fma_mix_f32 v215, v79, v207, v207 op_sel:[1,0,1] op_sel_hi:[1,1,1]
    v_cvt_pk_bf16_f32 v76, v208, v209
    v_cvt_pk_bf16_f32 v77, v210, v211
    s_waitcnt lgkmcnt(10)
    v_mfma_f32_32x32x16_bf16 v[96:111], v[60:63], v[168:171], v[96:111]
    ds_read_b64_tr_b16 v[188:189], v5 offset:10240
    ds_read_b64_tr_b16 v[190:191], v5 offset:10752
    v_cvt_pk_bf16_f32 v78, v212, v213
    v_cvt_pk_bf16_f32 v79, v214, v215
    ds_read_b128 v[200:203], v6 offset:1088
    ds_read_b128 v[204:207], v6 offset:1104
    s_waitcnt lgkmcnt(8)
    v_fma_mix_f32 v208, v80, v192, v192 op_sel:[0,0,1] op_sel_hi:[1,1,1]
    v_fma_mix_f32 v209, v80, v193, v193 op_sel:[1,0,1] op_sel_hi:[1,1,1]
    v_mfma_f32_32x32x16_bf16 v[112:127], v[60:63], v[172:175], v[112:127]
    s_waitcnt vmcnt(3)
    s_barrier
    s_lshl_b32 s34, s26, 3
    s_lshr_b32 s34, 0x13341433, s34
    s_bitcmp1_b32 s34, 4
    s_cselect_b32 s35, s33, s32
    s_bitcmp1_b32 s34, 5
    s_cselect_b32 s43, 122880, 0
    s_add_u32 s35, s35, s43
    s_and_b32 s34, s34, 15
    s_add_u32 s34, s34, s57
    s_cmp_ge_u32 s34, 5
    s_cselect_b32 s43, 5, 0
    s_sub_u32 s34, s34, s43
    s_mul_i32 s34, s34, 245760
    s_add_u32 s34, s34, s35
    s_cmp_eq_u32 s26, 3
    s_cselect_b32 s35, 0xfffef000, 0
    s_add_u32 s35, s35, s31
    s_add_u32 m0, s35, 16384
    s_nop 0
    buffer_load_dwordx4 v7, s[12:15], s34 offen lds
    s_add_u32 m0, s35, 17408
    s_add_u32 s34, s34, 30720
    buffer_load_dwordx4 v7, s[12:15], s34 offen lds
    s_add_u32 m0, s35, 18432
    s_add_u32 s34, s34, 30720
    buffer_load_dwordx4 v7, s[12:15], s34 offen lds
    s_add_u32 m0, s35, 19456
    s_add_u32 s34, s34, 30720
    buffer_load_dwordx4 v7, s[12:15], s34 offen lds
    v_and_b32 v233, 15, v0
    v_lshlrev_b32 v233, 7, v233
    s_mov_b32 s62, 65536
    buffer_load_dword v234, v233, s[8:11], s62 offen sc1
    ds_read_b64_tr_b16 v[160:161], v2 offset:12288
    ds_read_b64_tr_b16 v[162:163], v2 offset:12800
    v_fma_mix_f32 v210, v81, v194, v194 op_sel:[0,0,1] op_sel_hi:[1,1,1]
    v_fma_mix_f32 v211, v81, v195, v195 op_sel:[1,0,1] op_sel_hi:[1,1,1]
    v_fma_mix_f32 v212, v82, v196, v196 op_sel:[0,0,1] op_sel_hi:[1,1,1]
    v_fma_mix_f32 v213, v82, v197, v197 op_sel:[1,0,1] op_sel_hi:[1,1,1]
    v_fma_mix_f32 v214, v83, v198, v198 op_sel:[0,0,1] op_sel_hi:[1,1,1]
    v_mfma_f32_32x32x16_bf16 v[96:111], v[64:67], v[176:179], v[96:111]
    ds_read_b64_tr_b16 v[164:165], v3 offset:12288
    ds_read_b64_tr_b16 v[166:167], v3 offset:12800
    v_fma_mix_f32 v215, v83, v199, v199 op_sel:[1,0,1] op_sel_hi:[1,1,1]
    v_cvt_pk_bf16_f32 v80, v208, v209
    v_cvt_pk_bf16_f32 v81, v210, v211
    v_cvt_pk_bf16_f32 v82, v212, v213
    s_waitcnt lgkmcnt(10)
    v_mfma_f32_32x32x16_bf16 v[112:127], v[64:67], v[180:183], v[112:127]
    ds_read_b64_tr_b16 v[168:169], v2 offset:14336
    ds_read_b64_tr_b16 v[170:171], v2 offset:14848
    v_cvt_pk_bf16_f32 v83, v214, v215
    ds_read_b128 v[192:195], v6 offset:1152
    ds_read_b128 v[196:199], v6 offset:1168
    s_waitcnt lgkmcnt(8)
    v_fma_mix_f32 v208, v84, v200, v200 op_sel:[0,0,1] op_sel_hi:[1,1,1]
    v_fma_mix_f32 v209, v84, v201, v201 op_sel:[1,0,1] op_sel_hi:[1,1,1]
    v_fma_mix_f32 v210, v85, v202, v202 op_sel:[0,0,1] op_sel_hi:[1,1,1]
    v_mfma_f32_32x32x16_bf16 v[96:111], v[68:71], v[184:187], v[96:111]
    ds_read_b64_tr_b16 v[172:173], v3 offset:14336
    ds_read_b64_tr_b16 v[174:175], v3 offset:14848
    v_fma_mix_f32 v211, v85, v203, v203 op_sel:[1,0,1] op_sel_hi:[1,1,1]
    v_fma_mix_f32 v212, v86, v204, v204 op_sel:[0,0,1] op_sel_hi:[1,1,1]
    v_fma_mix_f32 v213, v86, v205, v205 op_sel:[1,0,1] op_sel_hi:[1,1,1]
    v_fma_mix_f32 v214, v87, v206, v206 op_sel:[0,0,1] op_sel_hi:[1,1,1]
    v_mfma_f32_32x32x16_bf16 v[112:127], v[68:71], v[188:191], v[112:127]
    ds_read_b64_tr_b16 v[176:177], v2 offset:32768
    ds_read_b64_tr_b16 v[178:179], v2 offset:33280
    v_fma_mix_f32 v215, v87, v207, v207 op_sel:[1,0,1] op_sel_hi:[1,1,1]
    v_cvt_pk_bf16_f32 v84, v208, v209
    v_cvt_pk_bf16_f32 v85, v210, v211
    v_cvt_pk_bf16_f32 v86, v212, v213
    v_cvt_pk_bf16_f32 v87, v214, v215
    ds_read_b128 v[200:203], v6 offset:1216
    ds_read_b128 v[204:207], v6 offset:1232
    s_mov_b32 exec_lo, 0xff000000
    s_mov_b32 exec_hi, 0x0
    buffer_load_dword v252, v229, s[16:19], s48 offen
    s_mov_b64 exec, -1
    s_waitcnt lgkmcnt(12)
    v_mfma_f32_32x32x16_bf16 v[96:111], v[72:75], v[160:163], v[96:111]
    ds_read_b64_tr_b16 v[180:181], v3 offset:32768
    ds_read_b64_tr_b16 v[182:183], v3 offset:33280
    s_waitcnt lgkmcnt(8)
    v_fma_mix_f32 v208, v88, v192, v192 op_sel:[0,0,1] op_sel_hi:[1,1,1]
    v_fma_mix_f32 v209, v88, v193, v193 op_sel:[1,0,1] op_sel_hi:[1,1,1]
    v_fma_mix_f32 v210, v89, v194, v194 op_sel:[0,0,1] op_sel_hi:[1,1,1]
    v_fma_mix_f32 v211, v89, v195, v195 op_sel:[1,0,1] op_sel_hi:[1,1,1]
    v_mfma_f32_32x32x16_bf16 v[112:127], v[72:75], v[164:167], v[112:127]
    ds_read_b64_tr_b16 v[184:185], v2 offset:34816
    ds_read_b64_tr_b16 v[186:187], v2 offset:35328
    v_fma_mix_f32 v212, v90, v196, v196 op_sel:[0,0,1] op_sel_hi:[1,1,1]
    v_fma_mix_f32 v213, v90, v197, v197 op_sel:[1,0,1] op_sel_hi:[1,1,1]
    v_fma_mix_f32 v214, v91, v198, v198 op_sel:[0,0,1] op_sel_hi:[1,1,1]
    v_fma_mix_f32 v215, v91, v199, v199 op_sel:[1,0,1] op_sel_hi:[1,1,1]
    v_mfma_f32_32x32x16_bf16 v[96:111], v[76:79], v[168:171], v[96:111]
    ds_read_b64_tr_b16 v[188:189], v3 offset:34816
    ds_read_b64_tr_b16 v[190:191], v3 offset:35328
    v_cvt_pk_bf16_f32 v88, v208, v209
    v_cvt_pk_bf16_f32 v89, v210, v211
    v_cvt_pk_bf16_f32 v90, v212, v213
    v_cvt_pk_bf16_f32 v91, v214, v215
    s_nop 1
    s_waitcnt lgkmcnt(10)
    v_mfma_f32_32x32x16_bf16 v[112:127], v[76:79], v[172:175], v[112:127]
    ds_read_b64_tr_b16 v[160:161], v2 offset:53248
    ds_read_b64_tr_b16 v[162:163], v2 offset:53760
    s_waitcnt lgkmcnt(8)
    v_fma_mix_f32 v208, v92, v200, v200 op_sel:[0,0,1] op_sel_hi:[1,1,1]
    v_fma_mix_f32 v209, v92, v201, v201 op_sel:[1,0,1] op_sel_hi:[1,1,1]
    v_fma_mix_f32 v210, v93, v202, v202 op_sel:[0,0,1] op_sel_hi:[1,1,1]
    v_fma_mix_f32 v211, v93, v203, v203 op_sel:[1,0,1] op_sel_hi:[1,1,1]
    v_fma_mix_f32 v212, v94, v204, v204 op_sel:[0,0,1] op_sel_hi:[1,1,1]
    v_mfma_f32_32x32x16_bf16 v[96:111], v[80:83], v[176:179], v[96:111]
    ds_read_b64_tr_b16 v[164:165], v3 offset:53248
    ds_read_b64_tr_b16 v[166:167], v3 offset:53760
    v_fma_mix_f32 v213, v94, v205, v205 op_sel:[1,0,1] op_sel_hi:[1,1,1]
    v_fma_mix_f32 v214, v95, v206, v206 op_sel:[0,0,1] op_sel_hi:[1,1,1]
    v_fma_mix_f32 v215, v95, v207, v207 op_sel:[1,0,1] op_sel_hi:[1,1,1]
    v_cvt_pk_bf16_f32 v92, v208, v209
    s_waitcnt lgkmcnt(8)
    v_mfma_f32_32x32x16_bf16 v[112:127], v[80:83], v[180:183], v[112:127]
    ds_read_b64_tr_b16 v[168:169], v2 offset:55296
    ds_read_b64_tr_b16 v[170:171], v2 offset:55808
    v_cvt_pk_bf16_f32 v93, v210, v211
    v_cvt_pk_bf16_f32 v94, v212, v213
    v_cvt_pk_bf16_f32 v95, v214, v215
    s_nop 1
    s_waitcnt lgkmcnt(8)
    v_mfma_f32_32x32x16_bf16 v[96:111], v[84:87], v[184:187], v[96:111]
    ds_read_b64_tr_b16 v[172:173], v3 offset:55296
    ds_read_b64_tr_b16 v[174:175], v3 offset:55808
    s_waitcnt lgkmcnt(8)
    v_mfma_f32_32x32x16_bf16 v[112:127], v[84:87], v[188:191], v[112:127]
    ds_read_b64_tr_b16 v[176:177], v4 offset:12288
    ds_read_b64_tr_b16 v[178:179], v4 offset:12800
    s_waitcnt lgkmcnt(8)
    v_mfma_f32_32x32x16_bf16 v[96:111], v[88:91], v[160:163], v[96:111]
    ds_read_b64_tr_b16 v[180:181], v5 offset:12288
    ds_read_b64_tr_b16 v[182:183], v5 offset:12800
    s_waitcnt lgkmcnt(8)
    v_mfma_f32_32x32x16_bf16 v[112:127], v[88:91], v[164:167], v[112:127]
    ds_read_b64_tr_b16 v[184:185], v4 offset:14336
    ds_read_b64_tr_b16 v[186:187], v4 offset:14848
    s_mov_b32 exec_lo, 0x0
    s_mov_b32 exec_hi, 0xff
    buffer_load_dword v252, v229, s[16:19], s48 offen
    s_mov_b64 exec, -1
    s_waitcnt lgkmcnt(8)
    v_mfma_f32_32x32x16_bf16 v[96:111], v[92:95], v[168:171], v[96:111]
    ds_read_b64_tr_b16 v[188:189], v5 offset:14336
    ds_read_b64_tr_b16 v[190:191], v5 offset:14848
    s_waitcnt lgkmcnt(8)
    v_mfma_f32_32x32x16_bf16 v[112:127], v[92:95], v[172:175], v[112:127]
    s_waitcnt vmcnt(2)
    s_barrier
    s_mov_b32 s61, 0
P_f_37:
    v_cmp_ne_u32 vcc, 1, v234
    s_add_u32 s61, s61, 1
    s_cbranch_vccz P_fe_38
    s_cmp_gt_u32 s61, 262144
    s_cbranch_scc1 P_fe_38
    s_mov_b32 s62, 65536
    buffer_load_dword v234, v233, s[8:11], s62 offen sc1
    s_waitcnt vmcnt(0)
    s_branch P_f_37
P_fe_38:
    s_cmp_lg_u32 s44, 3
    s_cbranch_scc1 P_3_40
    s_mov_b32 s20, s78
    s_mov_b32 s21, s79
    s_mov_b32 s22, 0x500
    s_mov_b32 s23, 0x20000
    s_lshl_b32 s49, s3, 7
    v_lshl_add_u32 v233, v0, 1, s49
    s_mul_i32 s49, s46, 640
    buffer_load_ushort v236, v233, s[20:23], s49 offen
P_3_40:
    s_lshl1_add_u32 s62, s44, s3
    s_cmp_ge_u32 s62, 2
    s_cbranch_scc1 P_t_39
    s_mul_i32 s49, s45, 640
    s_mul_i32 s50, s3, 2560
    s_sub_u32 s49, s49, s50
    s_add_u32 s49, s49, 289280
    v_lshlrev_b32 v233, 4, v0
    buffer_load_dwordx4 v[236:239], v233, s[8:11], s49 offen sc1
    s_add_u32 s49, s49, 5120
    buffer_load_dwordx4 v[240:243], v233, s[8:11], s49 offen sc1
    s_add_u32 s49, s49, 5120
    buffer_load_dwordx4 v[244:247], v233, s[8:11], s49 offen sc1
    s_add_u32 s49, s49, 5120
    buffer_load_dwordx4 v[248:251], v233, s[8:11], s49 offen sc1
P_t_39:
    ds_read_b64_tr_b16 v[160:161], v2 offset:8192
    ds_read_b64_tr_b16 v[162:163], v2 offset:8704
    s_waitcnt lgkmcnt(8)
    v_mfma_f32_32x32x16_bf16 v[128:143], v[56:59], v[176:179], v[128:143]
    ds_read_b64_tr_b16 v[164:165], v3 offset:8192
    ds_read_b64_tr_b16 v[166:167], v3 offset:8704
    s_waitcnt lgkmcnt(8)
    v_mfma_f32_32x32x16_bf16 v[144:159], v[56:59], v[180:183], v[144:159]
    ds_read_b64_tr_b16 v[168:169], v2 offset:10240
    ds_read_b64_tr_b16 v[170:171], v2 offset:10752
    s_nop 1
    v_mul_f32 v96, v96, v230
    v_mul_f32 v97, v97, v230
    v_mul_f32 v98, v98, v230
    v_mul_f32 v99, v99, v230
    ds_write_b128 v1, v[96:99] offset:0
    v_mul_f32 v100, v100, v230
    v_mul_f32 v101, v101, v230
    s_waitcnt lgkmcnt(9)
    v_mfma_f32_32x32x16_bf16 v[128:143], v[60:63], v[184:187], v[128:143]
    ds_read_b64_tr_b16 v[172:173], v3 offset:10240
    ds_read_b64_tr_b16 v[174:175], v3 offset:10752
    v_mul_f32 v102, v102, v230
    v_mul_f32 v103, v103, v230
    ds_write_b128 v1, v[100:103] offset:1024
    v_mul_f32 v104, v104, v230
    v_mul_f32 v105, v105, v230
    v_mul_f32 v106, v106, v230
    v_mul_f32 v107, v107, v230
    s_waitcnt lgkmcnt(10)
    v_mfma_f32_32x32x16_bf16 v[144:159], v[60:63], v[188:191], v[144:159]
    ds_read_b64_tr_b16 v[176:177], v2 offset:16384
    ds_read_b64_tr_b16 v[178:179], v2 offset:16896
    ds_write_b128 v1, v[104:107] offset:2048
    v_mul_f32 v108, v108, v230
    v_mul_f32 v109, v109, v230
    v_mul_f32 v110, v110, v230
    v_mul_f32 v111, v111, v230
    ds_write_b128 v1, v[108:111] offset:3072
    v_mul_f32 v112, v112, v230
    s_waitcnt lgkmcnt(12)
    v_mfma_f32_32x32x16_bf16 v[128:143], v[64:67], v[160:163], v[128:143]
    ds_read_b64_tr_b16 v[180:181], v3 offset:16384
    ds_read_b64_tr_b16 v[182:183], v3 offset:16896
    v_mul_f32 v113, v113, v230
    v_mul_f32 v114, v114, v230
    v_mul_f32 v115, v115, v230
    ds_write_b128 v1, v[112:115] offset:4096
    v_mul_f32 v116, v116, v230
    v_mul_f32 v117, v117, v230
    v_mul_f32 v118, v118, v230
    s_waitcnt lgkmcnt(13)
    v_mfma_f32_32x32x16_bf16 v[144:159], v[64:67], v[164:167], v[144:159]
    ds_read_b64_tr_b16 v[184:185], v2 offset:18432
    ds_read_b64_tr_b16 v[186:187], v2 offset:18944
    v_mul_f32 v119, v119, v230
    ds_write_b128 v1, v[116:119] offset:5120
    v_mul_f32 v120, v120, v230
    v_mul_f32 v121, v121, v230
    v_mul_f32 v122, v122, v230
    v_mul_f32 v123, v123, v230
    ds_write_b128 v1, v[120:123] offset:6144
    s_waitcnt lgkmcnt(15)
    v_mfma_f32_32x32x16_bf16 v[128:143], v[68:71], v[168:171], v[128:143]
    ds_read_b64_tr_b16 v[188:189], v3 offset:18432
    ds_read_b64_tr_b16 v[190:191], v3 offset:18944
    v_mul_f32 v124, v124, v230
    v_mul_f32 v125, v125, v230
    v_mul_f32 v126, v126, v230
    v_mul_f32 v127, v127, v230
    ds_write_b128 v1, v[124:127] offset:7168
    s_waitcnt lgkmcnt(15)
    v_mfma_f32_32x32x16_bf16 v[144:159], v[68:71], v[172:175], v[144:159]
    s_waitcnt lgkmcnt(0)
    s_barrier
    s_add_u32 m0, s31, 8192
    s_nop 0
    buffer_load_dwordx4 v224, s[16:19], s48 offen lds
    s_add_u32 m0, s31, 9216
    s_nop 0
    buffer_load_dwordx4 v225, s[16:19], s48 offen lds
    s_add_u32 m0, s31, 10240
    s_nop 0
    buffer_load_dwordx4 v226, s[16:19], s48 offen lds
    s_add_u32 m0, s31, 11264
    s_nop 0
    buffer_load_dwordx4 v227, s[16:19], s48 offen lds
    s_add_u32 m0, s31, 12288
    s_nop 0
    buffer_load_dwordx4 v228, s[16:19], s48 offen lds
    ds_read_b64_tr_b16 v[160:161], v2 offset:36864
    ds_read_b64_tr_b16 v[162:163], v2 offset:37376
    ds_read_b128 v[96:99], v9 offset:0
    v_mfma_f32_32x32x16_bf16 v[128:143], v[72:75], v[176:179], v[128:143]
    ds_read_b64_tr_b16 v[164:165], v3 offset:36864
    ds_read_b64_tr_b16 v[166:167], v3 offset:37376
    ds_read_b128 v[100:103], v9 offset:1024
    v_mfma_f32_32x32x16_bf16 v[144:159], v[72:75], v[180:183], v[144:159]
    ds_read_b64_tr_b16 v[168:169], v2 offset:38912
    ds_read_b64_tr_b16 v[170:171], v2 offset:39424
    ds_read_b128 v[104:107], v9 offset:2048
    v_mfma_f32_32x32x16_bf16 v[128:143], v[76:79], v[184:187], v[128:143]
    ds_read_b64_tr_b16 v[172:173], v3 offset:38912
    ds_read_b64_tr_b16 v[174:175], v3 offset:39424
    ds_read_b128 v[108:111], v9 offset:3072
    v_mfma_f32_32x32x16_bf16 v[144:159], v[76:79], v[188:191], v[144:159]
    ds_read_b64_tr_b16 v[176:177], v2 offset:57344
    ds_read_b64_tr_b16 v[178:179], v2 offset:57856
    ds_read_b128 v[112:115], v9 offset:4096
    s_waitcnt lgkmcnt(13)
    v_mfma_f32_32x32x16_bf16 v[128:143], v[80:83], v[160:163], v[128:143]
    ds_read_b64_tr_b16 v[180:181], v3 offset:57344
    ds_read_b64_tr_b16 v[182:183], v3 offset:57856
    ds_read_b128 v[116:119], v9 offset:5120
    s_waitcnt lgkmcnt(13)
    v_mfma_f32_32x32x16_bf16 v[144:159], v[80:83], v[164:167], v[144:159]
    ds_read_b64_tr_b16 v[184:185], v2 offset:59392
    ds_read_b64_tr_b16 v[186:187], v2 offset:59904
    ds_read_b128 v[120:123], v9 offset:6144
    s_waitcnt lgkmcnt(13)
    v_mfma_f32_32x32x16_bf16 v[128:143], v[84:87], v[168:171], v[128:143]
    ds_read_b64_tr_b16 v[188:189], v3 offset:59392
    ds_read_b64_tr_b16 v[190:191], v3 offset:59904
    ds_read_b128 v[124:127], v9 offset:7168
    s_waitcnt lgkmcnt(13)
    v_mfma_f32_32x32x16_bf16 v[144:159], v[84:87], v[172:175], v[144:159]
    s_waitcnt lgkmcnt(10)
    v_mfma_f32_32x32x16_bf16 v[128:143], v[88:91], v[176:179], v[128:143]
    s_waitcnt lgkmcnt(7)
    v_mfma_f32_32x32x16_bf16 v[144:159], v[88:91], v[180:183], v[144:159]
    s_waitcnt lgkmcnt(4)
    v_mfma_f32_32x32x16_bf16 v[128:143], v[92:95], v[184:187], v[128:143]
    s_waitcnt lgkmcnt(1)
    v_mfma_f32_32x32x16_bf16 v[144:159], v[92:95], v[188:191], v[144:159]
    s_cmp_lg_u32 s44, 3
    s_cbranch_scc1 P_3_43
    s_waitcnt vmcnt(5)
    v_lshlrev_b32 v236, 16, v236
    v_mul_f32 v238, 0xbfb8aa3b, v236
    v_exp_f32 v238, v238
    s_nop 0
    v_add_f32 v238, 1.0, v238
    v_rcp_f32 v238, v238
    s_nop 0
    v_mul_f32 v236, v236, v238
    v_cvt_pk_bf16_f32 v236, v236, 0
    v_lshlrev_b32 v237, 16, v236
    ds_write_b16 v233, v236 offset:13312
P_3_43:
    s_lshl1_add_u32 s62, s44, s3
    s_cmp_ge_u32 s62, 2
    s_cbranch_scc1 P_t_41
    v_lshrrev_b32 v11, 1, v0
    v_lshlrev_b32 v11, 6, v11
    v_and_b32 v12, 1, v0
    s_mov_b32 exec_hi, 0xff
    s_cmp_eq_u32 s3, 1
    s_waitcnt vmcnt(5)
    v_add_f32 v236, v236, v240
    v_add_f32 v244, v244, v248
    v_add_f32 v237, v237, v241
    v_add_f32 v245, v245, v249
    v_add_f32 v238, v238, v242
    v_add_f32 v246, v246, v250
    v_add_f32 v239, v239, v243
    v_add_f32 v247, v247, v251
    v_add_f32 v236, v236, v244
    v_add_f32 v237, v237, v245
    v_add_f32 v238, v238, v246
    v_add_f32 v239, v239, v247
    s_cbranch_scc1 P_t2_42
    v_cvt_pk_bf16_f32 v13, v236, v237
    v_lshlrev_b32 v236, 16, v13
    v_and_b32 v237, 0xffff0000, v13
    v_cvt_pk_bf16_f32 v13, v238, v239
    v_lshlrev_b32 v238, 16, v13
    v_and_b32 v239, 0xffff0000, v13
    v_add_f32 v236, 1.0, v236
    v_add_f32 v237, 1.0, v237
    v_add_f32 v238, 1.0, v238
    v_add_f32 v239, 1.0, v239
    v_cvt_pk_bf16_f32 v13, v236, v237
    v_lshlrev_b32 v236, 16, v13
    v_and_b32 v237, 0xffff0000, v13
    v_cvt_pk_bf16_f32 v13, v238, v239
    v_lshlrev_b32 v238, 16, v13
    v_and_b32 v239, 0xffff0000, v13
    v_lshl_add_u32 v11, v12, 4, v11
    ds_write_b128 v11, v[236:239] offset:13312
    s_branch P_t_41
P_t2_42:
    v_cvt_pk_bf16_f32 v236, v236, v237
    v_cvt_pk_bf16_f32 v237, v238, v239
    v_lshl_add_u32 v11, v12, 3, v11
    ds_write_b64 v11, v[236:237] offset:13344
P_t_41:
    s_mov_b64 exec, -1
    s_waitcnt lgkmcnt(0)
    s_nop 9
    v_fma_f32 v128, v128, v230, v96
    v_fma_f32 v129, v129, v230, v97
    v_fma_f32 v130, v130, v230, v98
    v_fma_f32 v131, v131, v230, v99
    v_fma_f32 v132, v132, v230, v100
    v_fma_f32 v133, v133, v230, v101
    v_fma_f32 v134, v134, v230, v102
    v_fma_f32 v135, v135, v230, v103
    v_fma_f32 v136, v136, v230, v104
    v_fma_f32 v137, v137, v230, v105
    v_fma_f32 v138, v138, v230, v106
    v_fma_f32 v139, v139, v230, v107
    v_fma_f32 v140, v140, v230, v108
    v_fma_f32 v141, v141, v230, v109
    v_fma_f32 v142, v142, v230, v110
    v_fma_f32 v143, v143, v230, v111
    v_cvt_pk_bf16_f32 v16, v128, v129
    v_cvt_pk_bf16_f32 v17, v130, v131
    v_cvt_pk_bf16_f32 v18, v132, v133
    v_cvt_pk_bf16_f32 v19, v134, v135
    v_cvt_pk_bf16_f32 v20, v136, v137
    v_cvt_pk_bf16_f32 v21, v138, v139
    v_cvt_pk_bf16_f32 v22, v140, v141
    v_cvt_pk_bf16_f32 v23, v142, v143
    buffer_store_dwordx4 v[16:19], v216, s[8:11], s39 offen offset:0 sc1
    buffer_store_dwordx4 v[20:23], v216, s[8:11], s39 offen offset:640 sc1
    s_nop 1
    v_fma_f32 v144, v144, v230, v112
    v_fma_f32 v145, v145, v230, v113
    v_fma_f32 v146, v146, v230, v114
    v_fma_f32 v147, v147, v230, v115
    v_fma_f32 v148, v148, v230, v116
    v_fma_f32 v149, v149, v230, v117
    v_fma_f32 v150, v150, v230, v118
    v_fma_f32 v151, v151, v230, v119
    v_fma_f32 v152, v152, v230, v120
    v_fma_f32 v153, v153, v230, v121
    v_fma_f32 v154, v154, v230, v122
    v_fma_f32 v155, v155, v230, v123
    v_fma_f32 v156, v156, v230, v124
    v_fma_f32 v157, v157, v230, v125
    v_fma_f32 v158, v158, v230, v126
    v_fma_f32 v159, v159, v230, v127
    v_cvt_pk_bf16_f32 v24, v144, v145
    v_cvt_pk_bf16_f32 v25, v146, v147
    v_cvt_pk_bf16_f32 v26, v148, v149
    v_cvt_pk_bf16_f32 v27, v150, v151
    v_cvt_pk_bf16_f32 v28, v152, v153
    v_cvt_pk_bf16_f32 v29, v154, v155
    v_cvt_pk_bf16_f32 v30, v156, v157
    v_cvt_pk_bf16_f32 v31, v158, v159
    buffer_store_dwordx4 v[24:27], v217, s[8:11], s39 offen offset:0 sc1
    buffer_store_dwordx4 v[28:31], v217, s[8:11], s39 offen offset:640 sc1
    s_waitcnt vmcnt(4) lgkmcnt(0)
B_e_29:
    s_lshl4_add_u32 s56, s25, s24
    s_barrier
    s_and_b32 s24, s5, 3
    s_lshl2_add_u32 s24, s4, s24
    s_lshr_b32 s25, s5, 2
    s_and_b32 s26, s3, 3
    s_lshr_b32 s27, s3, 2
    s_mov_b32 s28, 0
    s_mov_b32 s30, 0xfffff
    s_mov_b32 s31, 0xfffff
    v_lshlrev_b32 v4, 4, v0
    v_and_b32 v1, 31, v0
    v_lshlrev_b32 v6, 3, v1
    v_lshrrev_b32 v7, 5, v0
    v_lshl_add_u32 v7, v7, 10, v6
    s_mul_i32 s32, s24, 81920
    s_mul_i32 s33, s25, 10240
    s_add_u32 s32, s32, s33
    s_lshl_b32 s39, s3, 10
    s_add_u32 s40, s32, s39
    s_add_u32 s40, s40, 4194304
    s_add_u32 s39, s39, 61440
    s_mul_i32 s32, s26, 2560
    s_lshl_b32 s33, s27, 8
    s_add_u32 s32, s32, s33
    s_add_u32 s32, s32, 61440
    v_add_u32 v195, s32, v7
    v_xor_b32 v194, 256, v195
    v_add_u32 v197, s32, v6
    v_xor_b32 v196, 256, v197
    s_mul_i32 s41, s27, 81920
    s_lshl_b32 s33, s26, 10
    s_add_u32 s41, s41, s33
    s_mul_i32 s42, s24, 163840
    s_add_u32 s42, s42, s41
    s_add_u32 s42, s42, 7340032
    v_mov_b32 v199, v7
    s_mul_i32 s33, s26, 3072
    s_add_u32 s33, s33, 40960
    s_mul_i32 s34, s27, 81920
    s_sub_u32 s35, 81920, s34
    s_add_u32 s34, s34, s33
    s_add_u32 s35, s35, s33
    v_add_u32 v233, s34, v4
    v_add_u32 v234, s35, v4
    s_lshl2_add_u32 s35, s3, 53248
    v_mov_b32 v235, s35
    v_and_b32 v1, 7, v0
    v_lshlrev_b32 v1, 2, v1
    v_add_u32 v236, 53248, v1
    s_mov_b32 s34, 0x7b800000
    s_lshl_b32 s33, s25, 4
    s_lshl2_add_u32 s33, s26, s33
    s_lshl1_add_u32 s33, s27, s33
    s_mul_i32 s33, s33, 20480
    s_add_u32 s33, s33, 12582912
    s_lshl_b32 s37, s24, 9
    s_add_u32 s37, s37, s33
    s_lshl_b32 s38, s24, 7
    s_add_u32 s38, s38, 16384
    s_add_u32 s38, s38, s33
    v_and_b32 v1, 15, v0
    v_bfe_u32 v6, v0, 4, 1
    v_mul_u32_u24 v6, 20480, v6
    v_lshl_add_u32 v7, v1, 4, v6
    v_lshl_add_u32 v232, v1, 3, v6
    v_lshrrev_b32 v6, 5, v0
    v_lshl_add_u32 v231, v6, 8, v7
    s_mul_i32 s32, s24, 20
    s_add_u32 s33, s32, 19
    s_lshr_b32 s32, s32, 7
    s_lshr_b32 s33, s33, 7
    s_sub_u32 s33, s33, s32
    v_bfe_u32 v1, v0, 4, 1
    v_mul_u32_u24 v1, s33, v1
    v_lshrrev_b32 v10, 5, v0
    v_mul_u32_u24 v10, 5, v10
    v_add3_u32 v10, v10, v1, s32
    v_add_u32 v10, 5, v10
    v_and_b32 v1, 15, v0
    v_lshl_add_u32 v10, v10, 4, v1
    v_lshlrev_b32 v237, 7, v10
    v_and_b32 v1, 1, v0
    v_mul_u32_u24 v1, s33, v1
    v_add_u32 v1, s32, v1
    v_bfe_u32 v11, v0, 1, 1
    v_lshl_add_u32 v11, v1, 4, v11
    s_lshl_b32 s32, s25, 1
    v_add_lshl_u32 v238, v11, s32, 7
    v_lshlrev_b32 v193, 7, v0
    v_lshlrev_b32 v222, 4, v0
    s_cmp_lg_u32 s44, 0
    s_cbranch_scc1 P_cw_44
    v_bfe_u32 v1, v0, 2, 2
    v_lshrrev_b32 v12, 4, v0
    v_lshlrev_b32 v10, 7, v1
    v_lshrrev_b32 v1, 1, v1
    v_and_b32 v11, 1, v12
    v_lshl_or_b32 v1, v11, 1, v1
    s_and_b32 s47, s3, 3
    v_xor_b32 v1, s47, v1
    v_lshl_add_u32 v10, v1, 5, v10
    v_and_b32 v1, 3, v0
    v_lshl_add_u32 v10, v1, 3, v10
    s_and_b32 s49, s3, 4
    v_add_u32 v1, s49, v12
    v_mul_u32_u24 v1, 20480, v1
    v_add_u32 v10, v10, v1
    ds_read_b64_tr_b16 v[200:201], v10 offset:8192
    ds_read_b64_tr_b16 v[202:203], v10 offset:8704
    ds_read_b64_tr_b16 v[204:205], v10 offset:9216
    ds_read_b64_tr_b16 v[206:207], v10 offset:9728
    ds_read_b64_tr_b16 v[208:209], v10 offset:10240
    ds_read_b64_tr_b16 v[210:211], v10 offset:10752
    ds_read_b64_tr_b16 v[212:213], v10 offset:11264
    ds_read_b64_tr_b16 v[214:215], v10 offset:11776
    ds_read_b64_tr_b16 v[216:217], v10 offset:12288
    ds_read_b64_tr_b16 v[218:219], v10 offset:12800
    v_lshlrev_b32 v11, 6, v12
    s_lshl2_add_u32 s50, s46, s47
    s_mul_i32 s51, s50, 40960
    s_mul_i32 s52, s45, 10240
    s_add_u32 s51, s51, s52
    s_lshl_b32 s52, s49, 8
    s_add_u32 s51, s51, s52
    s_add_u32 s51, s51, 30408704
    s_mul_i32 s53, s45, 112
    s_add_u32 s53, s53, s50
    s_lshl_b32 s53, s53, 8
    s_lshl_b32 s52, s49, 5
    s_add_u32 s53, s53, s52
    s_add_u32 s53, s53, 327680
    s_add_u32 s55, s51, 1024
    s_add_u32 s52, s51, 2048
    s_add_u32 s54, s51, 3072
    s_add_u32 s49, s51, 8192
    v_lshlrev_b32 v13, 2, v0
    v_mov_b32 v14, 0x7f000000
    v_cmp_gt_u32 vcc, 32, v0
    s_nop 1
    v_cndmask_b32 v221, v14, v13, vcc
    v_mov_b32 v220, 0
    v_mov_b32 v15, 0
    ds_read_b128 v[16:19], v11 offset:13312
    ds_read_b128 v[20:23], v11 offset:13328
    ds_read_b128 v[24:27], v11 offset:13344
    ds_read_b128 v[28:31], v11 offset:13568
    ds_read_b128 v[32:35], v11 offset:13584
    ds_read_b128 v[36:39], v11 offset:13600
    ds_read_b128 v[40:43], v11 offset:13824
    ds_read_b128 v[44:47], v11 offset:13840
    ds_read_b128 v[48:51], v11 offset:13856
    ds_read_b128 v[52:55], v11 offset:14080
    ds_read_b128 v[56:59], v11 offset:14096
    ds_read_b128 v[60:63], v11 offset:14112
    ds_read_b128 v[64:67], v11 offset:14336
    ds_read_b128 v[68:71], v11 offset:14352
    ds_read_b128 v[72:75], v11 offset:14368
    s_waitcnt lgkmcnt(0)
    s_waitcnt vmcnt(0)
    s_barrier
    s_cmp_lg_u32 s3, 0
    s_cbranch_scc1 sig_46
    s_lshl_b32 s60, s56, 7
    s_add_u32 s60, s60, 0
    v_lshlrev_b32 v254, 2, v0
    v_mov_b32 v255, 1
    s_mov_b32 exec_hi, 0
    buffer_store_dword v255, v254, s[8:11], s60 offen sc1
    s_mov_b64 exec, -1
sig_46:
    v_lshlrev_b32 v76, 16, v200
    v_and_b32 v77, s7, v200
    v_dot2c_f32_bf16 v15, v200, v24
    v_pk_mul_f32 v[76:77], v[76:77], v[16:17]
    v_cvt_pk_bf16_f32 v200, v76, v77
    v_dot2c_f32_bf16 v220, s6, v200
    v_lshlrev_b32 v78, 16, v201
    v_and_b32 v79, s7, v201
    v_dot2c_f32_bf16 v15, v201, v25
    v_pk_mul_f32 v[78:79], v[78:79], v[18:19]
    v_cvt_pk_bf16_f32 v201, v78, v79
    v_dot2c_f32_bf16 v220, s6, v201
    v_lshlrev_b32 v76, 16, v202
    v_and_b32 v77, s7, v202
    v_dot2c_f32_bf16 v15, v202, v26
    v_pk_mul_f32 v[76:77], v[76:77], v[20:21]
    v_cvt_pk_bf16_f32 v202, v76, v77
    v_dot2c_f32_bf16 v220, s6, v202
    v_lshlrev_b32 v78, 16, v203
    v_and_b32 v79, s7, v203
    v_dot2c_f32_bf16 v15, v203, v27
    v_pk_mul_f32 v[78:79], v[78:79], v[22:23]
    v_cvt_pk_bf16_f32 v203, v78, v79
    v_dot2c_f32_bf16 v220, s6, v203
    v_lshlrev_b32 v76, 16, v204
    v_and_b32 v77, s7, v204
    v_dot2c_f32_bf16 v15, v204, v36
    v_pk_mul_f32 v[76:77], v[76:77], v[28:29]
    v_cvt_pk_bf16_f32 v204, v76, v77
    v_dot2c_f32_bf16 v220, s6, v204
    v_lshlrev_b32 v78, 16, v205
    v_and_b32 v79, s7, v205
    v_dot2c_f32_bf16 v15, v205, v37
    v_pk_mul_f32 v[78:79], v[78:79], v[30:31]
    v_cvt_pk_bf16_f32 v205, v78, v79
    v_dot2c_f32_bf16 v220, s6, v205
    v_lshlrev_b32 v76, 16, v206
    v_and_b32 v77, s7, v206
    v_dot2c_f32_bf16 v15, v206, v38
    v_pk_mul_f32 v[76:77], v[76:77], v[32:33]
    v_cvt_pk_bf16_f32 v206, v76, v77
    v_dot2c_f32_bf16 v220, s6, v206
    v_lshlrev_b32 v78, 16, v207
    v_and_b32 v79, s7, v207
    v_dot2c_f32_bf16 v15, v207, v39
    v_pk_mul_f32 v[78:79], v[78:79], v[34:35]
    v_cvt_pk_bf16_f32 v207, v78, v79
    v_dot2c_f32_bf16 v220, s6, v207
    v_lshlrev_b32 v76, 16, v208
    v_and_b32 v77, s7, v208
    v_dot2c_f32_bf16 v15, v208, v48
    v_pk_mul_f32 v[76:77], v[76:77], v[40:41]
    v_cvt_pk_bf16_f32 v208, v76, v77
    v_dot2c_f32_bf16 v220, s6, v208
    v_lshlrev_b32 v78, 16, v209
    v_and_b32 v79, s7, v209
    v_dot2c_f32_bf16 v15, v209, v49
    v_pk_mul_f32 v[78:79], v[78:79], v[42:43]
    v_cvt_pk_bf16_f32 v209, v78, v79
    v_dot2c_f32_bf16 v220, s6, v209
    v_lshlrev_b32 v76, 16, v210
    v_and_b32 v77, s7, v210
    v_dot2c_f32_bf16 v15, v210, v50
    v_pk_mul_f32 v[76:77], v[76:77], v[44:45]
    v_cvt_pk_bf16_f32 v210, v76, v77
    v_dot2c_f32_bf16 v220, s6, v210
    v_lshlrev_b32 v78, 16, v211
    v_and_b32 v79, s7, v211
    v_dot2c_f32_bf16 v15, v211, v51
    v_pk_mul_f32 v[78:79], v[78:79], v[46:47]
    v_cvt_pk_bf16_f32 v211, v78, v79
    v_dot2c_f32_bf16 v220, s6, v211
    v_lshlrev_b32 v76, 16, v212
    v_and_b32 v77, s7, v212
    v_dot2c_f32_bf16 v15, v212, v60
    v_pk_mul_f32 v[76:77], v[76:77], v[52:53]
    v_cvt_pk_bf16_f32 v212, v76, v77
    v_dot2c_f32_bf16 v220, s6, v212
    v_lshlrev_b32 v78, 16, v213
    v_and_b32 v79, s7, v213
    v_dot2c_f32_bf16 v15, v213, v61
    v_pk_mul_f32 v[78:79], v[78:79], v[54:55]
    v_cvt_pk_bf16_f32 v213, v78, v79
    v_dot2c_f32_bf16 v220, s6, v213
    v_lshlrev_b32 v76, 16, v214
    v_and_b32 v77, s7, v214
    v_dot2c_f32_bf16 v15, v214, v62
    v_pk_mul_f32 v[76:77], v[76:77], v[56:57]
    v_cvt_pk_bf16_f32 v214, v76, v77
    v_dot2c_f32_bf16 v220, s6, v214
    v_lshlrev_b32 v78, 16, v215
    v_and_b32 v79, s7, v215
    v_dot2c_f32_bf16 v15, v215, v63
    v_pk_mul_f32 v[78:79], v[78:79], v[58:59]
    v_cvt_pk_bf16_f32 v215, v78, v79
    v_dot2c_f32_bf16 v220, s6, v215
    v_lshlrev_b32 v76, 16, v216
    v_and_b32 v77, s7, v216
    v_dot2c_f32_bf16 v15, v216, v72
    v_pk_mul_f32 v[76:77], v[76:77], v[64:65]
    v_cvt_pk_bf16_f32 v216, v76, v77
    v_dot2c_f32_bf16 v220, s6, v216
    v_lshlrev_b32 v78, 16, v217
    v_and_b32 v79, s7, v217
    v_dot2c_f32_bf16 v15, v217, v73
    v_pk_mul_f32 v[78:79], v[78:79], v[66:67]
    v_cvt_pk_bf16_f32 v217, v78, v79
    v_dot2c_f32_bf16 v220, s6, v217
    v_lshlrev_b32 v76, 16, v218
    v_and_b32 v77, s7, v218
    v_dot2c_f32_bf16 v15, v218, v74
    v_pk_mul_f32 v[76:77], v[76:77], v[68:69]
    v_cvt_pk_bf16_f32 v218, v76, v77
    v_dot2c_f32_bf16 v220, s6, v218
    v_lshlrev_b32 v78, 16, v219
    v_and_b32 v79, s7, v219
    v_dot2c_f32_bf16 v15, v219, v75
    v_pk_mul_f32 v[78:79], v[78:79], v[70:71]
    v_cvt_pk_bf16_f32 v219, v78, v79
    v_dot2c_f32_bf16 v220, s6, v219
    s_nop 2
    v_permlane16_swap_b32 v220, v15
    v_add_f32 v220, v220, v15
    v_mov_b32 v15, v220
    s_nop 1
    v_permlane32_swap_b32 v220, v15
    v_add_f32 v220, v220, v15
    s_branch P_ce_45
P_cw_44:
    s_cmp_lg_u32 s44, 3
    s_cbranch_scc1 P_cw2_47
    v_lshrrev_b32 v13, 4, v0
    v_bfe_u32 v14, v0, 2, 2
    v_mul_u32_u24 v15, 20480, v13
    v_lshl_add_u32 v15, v14, 7, v15
    v_lshrrev_b32 v14, 1, v14
    v_and_b32 v16, 1, v13
    v_lshl_or_b32 v14, v16, 1, v14
    s_and_b32 s49, s3, 3
    v_xor_b32 v14, s49, v14
    v_lshl_add_u32 v15, v14, 5, v15
    v_and_b32 v16, 3, v0
    v_lshl_add_u32 v15, v16, 3, v15
    v_add_u32 v16, 81920, v15
    v_lshlrev_b32 v13, 4, v13
    ds_read_b128 v[20:23], v13 offset:13312
    ds_read_b64_tr_b16 v[60:61], v15 offset:8192
    ds_read_b64_tr_b16 v[62:63], v15 offset:8704
    ds_read_b128 v[24:27], v13 offset:13376
    ds_read_b64_tr_b16 v[64:65], v16 offset:8192
    ds_read_b64_tr_b16 v[66:67], v16 offset:8704
    ds_read_b128 v[28:31], v13 offset:13440
    ds_read_b64_tr_b16 v[68:69], v15 offset:9216
    ds_read_b64_tr_b16 v[70:71], v15 offset:9728
    ds_read_b128 v[32:35], v13 offset:13504
    ds_read_b64_tr_b16 v[72:73], v16 offset:9216
    ds_read_b64_tr_b16 v[74:75], v16 offset:9728
    ds_read_b128 v[36:39], v13 offset:13568
    ds_read_b64_tr_b16 v[76:77], v15 offset:10240
    ds_read_b64_tr_b16 v[78:79], v15 offset:10752
    ds_read_b128 v[40:43], v13 offset:13632
    ds_read_b64_tr_b16 v[80:81], v16 offset:10240
    ds_read_b64_tr_b16 v[82:83], v16 offset:10752
    ds_read_b128 v[44:47], v13 offset:13696
    ds_read_b64_tr_b16 v[84:85], v15 offset:11264
    ds_read_b64_tr_b16 v[86:87], v15 offset:11776
    ds_read_b128 v[48:51], v13 offset:13760
    ds_read_b64_tr_b16 v[88:89], v16 offset:11264
    ds_read_b64_tr_b16 v[90:91], v16 offset:11776
    ds_read_b128 v[52:55], v13 offset:13824
    ds_read_b64_tr_b16 v[92:93], v15 offset:12288
    ds_read_b64_tr_b16 v[94:95], v15 offset:12800
    ds_read_b128 v[56:59], v13 offset:13888
    ds_read_b64_tr_b16 v[96:97], v16 offset:12288
    ds_read_b64_tr_b16 v[98:99], v16 offset:12800
    s_mul_i32 s51, s46, 5120
    s_lshl2_add_u32 s49, s45, s49
    s_lshl_b32 s49, s49, 6
    s_add_u32 s51, s51, s49
    s_add_u32 s51, s51, 311296
    s_mov_b32 s52, 0x7f000000
    s_mov_b32 s49, s52
    s_mov_b32 s55, s52
    s_mov_b32 s54, s52
    s_mov_b32 s53, 0
    v_mov_b32 v221, 0x7f000000
    v_and_b32 v1, 15, v0
    s_cmp_lt_u32 s3, 4
    s_cselect_b32 s50, 0, 64
    v_cmp_eq_u32 vcc, s50, v1
    s_waitcnt lgkmcnt(0)
    v_mfma_f32_16x16x32_bf16 v[200:203], v[60:63], v[20:23], 0
    v_mfma_f32_16x16x32_bf16 v[200:203], v[64:67], v[24:27], v[200:203]
    v_mfma_f32_16x16x32_bf16 v[200:203], v[68:71], v[28:31], v[200:203]
    v_mfma_f32_16x16x32_bf16 v[200:203], v[72:75], v[32:35], v[200:203]
    v_mfma_f32_16x16x32_bf16 v[200:203], v[76:79], v[36:39], v[200:203]
    v_mfma_f32_16x16x32_bf16 v[200:203], v[80:83], v[40:43], v[200:203]
    v_mfma_f32_16x16x32_bf16 v[200:203], v[84:87], v[44:47], v[200:203]
    v_mfma_f32_16x16x32_bf16 v[200:203], v[88:91], v[48:51], v[200:203]
    v_mfma_f32_16x16x32_bf16 v[200:203], v[92:95], v[52:55], v[200:203]
    v_mfma_f32_16x16x32_bf16 v[200:203], v[96:99], v[56:59], v[200:203]
    v_cndmask_b32 v222, v221, v13, vcc
    s_waitcnt vmcnt(0)
    s_barrier
    s_cmp_lg_u32 s3, 0
    s_cbranch_scc1 sig_50
    s_lshl_b32 s60, s56, 7
    s_add_u32 s60, s60, 0
    v_lshlrev_b32 v254, 2, v0
    v_mov_b32 v255, 1
    s_mov_b32 exec_hi, 0
    buffer_store_dword v255, v254, s[8:11], s60 offen sc1
    s_mov_b64 exec, -1
sig_50:
    s_branch P_ce_45
P_cw2_47:
    v_bfe_u32 v1, v0, 2, 2
    v_lshrrev_b32 v12, 4, v0
    v_mul_u32_u24 v10, 40960, v12
    v_mul_u32_u24 v11, 1280, v1
    v_add3_u32 v10, v10, v11, 0
    v_lshlrev_b32 v1, 6, v1
    v_and_b32 v12, 3, v0
    s_mul_i32 s49, s3, 160
    v_lshl_add_u32 v11, v12, 4, s49
    v_add_u32 v11, 0, v11
    v_xor_b32 v11, v11, v1
    v_add_u32 v11, v11, v10
    ds_read_b64_tr_b16 v[200:201], v11 offset:8192
    ds_read_b64_tr_b16 v[202:203], v11 offset:28672
    v_lshl_add_u32 v11, v12, 4, s49
    v_add_u32 v11, 8, v11
    v_xor_b32 v11, v11, v1
    v_add_u32 v11, v11, v10
    ds_read_b64_tr_b16 v[204:205], v11 offset:8192
    ds_read_b64_tr_b16 v[206:207], v11 offset:28672
    v_lshl_add_u32 v11, v12, 4, s49
    v_add_u32 v11, 64, v11
    v_xor_b32 v11, v11, v1
    v_add_u32 v11, v11, v10
    ds_read_b64_tr_b16 v[208:209], v11 offset:8192
    ds_read_b64_tr_b16 v[210:211], v11 offset:28672
    v_lshl_add_u32 v11, v12, 4, s49
    v_add_u32 v11, 72, v11
    v_xor_b32 v11, v11, v1
    v_add_u32 v11, v11, v10
    ds_read_b64_tr_b16 v[212:213], v11 offset:8192
    ds_read_b64_tr_b16 v[214:215], v11 offset:28672
    v_lshl_add_u32 v11, v12, 3, s49
    v_add_u32 v11, 128, v11
    v_xor_b32 v11, v11, v1
    v_add_u32 v11, v11, v10
    ds_read_b64_tr_b16 v[216:217], v11 offset:8192
    ds_read_b64_tr_b16 v[218:219], v11 offset:28672
    s_mul_i32 s49, s3, s46
    s_lshl1_add_u32 s49, s49, s45
    s_mul_i32 s49, s49, 5120
    s_add_u32 s49, s49, s47
    s_cmp_ge_u32 s45, s46
    s_cselect_b32 s50, 2048, 0
    s_add_u32 s51, s49, s50
    s_sub_u32 s52, s49, s50
    s_add_u32 s49, s49, 4096
    s_mov_b32 s55, s51
    s_mov_b32 s54, s52
    s_mov_b32 s53, 0
    v_mov_b32 v220, 0
    v_mov_b32 v221, 0x7f000000
    s_cmp_eq_u32 s44, 2
    s_cselect_b64 vcc, -1, 0
    v_cndmask_b32 v222, v222, v221, vcc
    s_waitcnt lgkmcnt(0)
    s_waitcnt vmcnt(0)
    s_barrier
    s_cmp_lg_u32 s3, 0
    s_cbranch_scc1 sig_51
    s_lshl_b32 s60, s56, 7
    s_add_u32 s60, s60, 0
    v_lshlrev_b32 v254, 2, v0
    v_mov_b32 v255, 1
    s_mov_b32 exec_hi, 0
    buffer_store_dword v255, v254, s[8:11], s60 offen sc1
    s_mov_b64 exec, -1
sig_51:
P_ce_45:
    s_branch centry_2
helper_entry:
    s_lshl1_add_u32 s24, s4, s5
    s_sub_u32 s24, s24, 30
    s_waitcnt lgkmcnt(0)
    s_mov_b32 s8, s86
    s_mov_b32 s9, s87
    s_mov_b32 s10, 0x2400000
    s_mov_b32 s11, 0x20000
    s_mov_b32 s12, s80
    s_mov_b32 s13, s81
    s_mov_b32 s14, 0x4b0000
    s_mov_b32 s15, 0x20000
    s_mov_b32 s16, s78
    s_mov_b32 s17, s79
    s_mov_b32 s18, 0x500
    s_mov_b32 s19, 0x20000
    v_lshrrev_b32 v1, 3, v0
    v_mul_u32_u24 v2, 7680, v1
    v_bfe_u32 v1, v0, 4, 1
    s_and_b32 s28, s3, 1
    v_lshl_or_b32 v1, s28, 1, v1
    v_lshlrev_b32 v1, 1, v1
    v_and_b32 v3, 7, v0
    v_xor_b32 v1, v1, v3
    v_lshl_add_u32 v2, v1, 4, v2
    s_lshl_b32 s28, s3, 7
    v_lshl_add_u32 v4, v0, 1, s28
    buffer_load_ushort v10, v4, s[16:19], 0 offen
    buffer_load_ushort v12, v4, s[16:19], 0 offen offset:1024
    s_and_b32 s25, s24, 3
    s_lshr_b32 s26, s24, 2
    s_mul_i32 s34, s25, 1228800
    s_mul_i32 s28, s26, 640
    s_add_u32 s34, s34, s28
    s_mul_i32 s35, s3, 61440
    s_add_u32 s34, s34, s35
    s_mov_b32 s30, s34
    s_mov_b32 s31, s3
    s_lshl_b32 s29, s3, 10
    s_mul_i32 s40, s25, 5120
    s_mul_i32 s33, s26, 1280
    s_add_u32 s40, s40, s33
    s_cmp_ge_u32 s3, 6
    s_cbranch_scc1 H_z_52
    s_add_u32 m0, s29, 0
    s_add_u32 s31, s31, 6
    buffer_load_dwordx4 v2, s[12:15], s30 offen lds
    s_cmp_ge_u32 s31, 20
    s_cselect_b32 s32, 0xffed4080, 0
    s_cselect_b32 s33, 20, 0
    s_sub_u32 s31, s31, s33
    s_add_u32 s30, s30, s32
    s_add_u32 s30, s30, 368640
    s_add_u32 m0, s29, 6144
    s_add_u32 s31, s31, 6
    buffer_load_dwordx4 v2, s[12:15], s30 offen lds
    s_cmp_ge_u32 s31, 20
    s_cselect_b32 s32, 0xffed4080, 0
    s_cselect_b32 s33, 20, 0
    s_sub_u32 s31, s31, s33
    s_add_u32 s30, s30, s32
    s_add_u32 s30, s30, 368640
    s_add_u32 m0, s29, 12288
    s_add_u32 s31, s31, 6
    buffer_load_dwordx4 v2, s[12:15], s30 offen lds
    s_cmp_ge_u32 s31, 20
    s_cselect_b32 s32, 0xffed4080, 0
    s_cselect_b32 s33, 20, 0
    s_sub_u32 s31, s31, s33
    s_add_u32 s30, s30, s32
    s_add_u32 s30, s30, 368640
    s_add_u32 m0, s29, 18432
    s_add_u32 s31, s31, 6
    buffer_load_dwordx4 v2, s[12:15], s30 offen lds
    s_cmp_ge_u32 s31, 20
    s_cselect_b32 s32, 0xffed4080, 0
    s_cselect_b32 s33, 20, 0
    s_sub_u32 s31, s31, s33
    s_add_u32 s30, s30, s32
    s_add_u32 s30, s30, 368640
    s_add_u32 m0, s29, 24576
    s_add_u32 s31, s31, 6
    buffer_load_dwordx4 v2, s[12:15], s30 offen lds
    s_cmp_ge_u32 s31, 20
    s_cselect_b32 s32, 0xffed4080, 0
    s_cselect_b32 s33, 20, 0
    s_sub_u32 s31, s31, s33
    s_add_u32 s30, s30, s32
    s_add_u32 s30, s30, 368640
    s_add_u32 m0, s29, 30720
    s_add_u32 s31, s31, 6
    buffer_load_dwordx4 v2, s[12:15], s30 offen lds
    s_cmp_ge_u32 s31, 20
    s_cselect_b32 s32, 0xffed4080, 0
    s_cselect_b32 s33, 20, 0
    s_sub_u32 s31, s31, s33
    s_add_u32 s30, s30, s32
    s_add_u32 s30, s30, 368640
    s_add_u32 m0, s29, 36864
    s_add_u32 s31, s31, 6
    buffer_load_dwordx4 v2, s[12:15], s30 offen lds
    s_cmp_ge_u32 s31, 20
    s_cselect_b32 s32, 0xffed4080, 0
    s_cselect_b32 s33, 20, 0
    s_sub_u32 s31, s31, s33
    s_add_u32 s30, s30, s32
    s_add_u32 s30, s30, 368640
    s_add_u32 m0, s29, 43008
    s_add_u32 s31, s31, 6
    buffer_load_dwordx4 v2, s[12:15], s30 offen lds
    s_cmp_ge_u32 s31, 20
    s_cselect_b32 s32, 0xffed4080, 0
    s_cselect_b32 s33, 20, 0
    s_sub_u32 s31, s31, s33
    s_add_u32 s30, s30, s32
    s_add_u32 s30, s30, 368640
    s_add_u32 m0, s29, 49152
    s_add_u32 s31, s31, 6
    buffer_load_dwordx4 v2, s[12:15], s30 offen lds
    s_cmp_ge_u32 s31, 20
    s_cselect_b32 s32, 0xffed4080, 0
    s_cselect_b32 s33, 20, 0
    s_sub_u32 s31, s31, s33
    s_add_u32 s30, s30, s32
    s_add_u32 s30, s30, 368640
    s_add_u32 m0, s29, 55296
    s_add_u32 s31, s31, 6
    buffer_load_dwordx4 v2, s[12:15], s30 offen lds
    s_cmp_ge_u32 s31, 20
    s_cselect_b32 s32, 0xffed4080, 0
    s_cselect_b32 s33, 20, 0
    s_sub_u32 s31, s31, s33
    s_add_u32 s30, s30, s32
    s_add_u32 s30, s30, 368640
    s_add_u32 m0, s29, 61440
    s_add_u32 s31, s31, 6
    buffer_load_dwordx4 v2, s[12:15], s30 offen lds
    s_cmp_ge_u32 s31, 20
    s_cselect_b32 s32, 0xffed4080, 0
    s_cselect_b32 s33, 20, 0
    s_sub_u32 s31, s31, s33
    s_add_u32 s30, s30, s32
    s_add_u32 s30, s30, 368640
    s_add_u32 m0, s29, 67584
    s_add_u32 s31, s31, 6
    buffer_load_dwordx4 v2, s[12:15], s30 offen lds
    s_cmp_ge_u32 s31, 20
    s_cselect_b32 s32, 0xffed4080, 0
    s_cselect_b32 s33, 20, 0
    s_sub_u32 s31, s31, s33
    s_add_u32 s30, s30, s32
    s_add_u32 s30, s30, 368640
    s_add_u32 m0, s29, 73728
    s_add_u32 s31, s31, 6
    buffer_load_dwordx4 v2, s[12:15], s30 offen lds
    s_cmp_ge_u32 s31, 20
    s_cselect_b32 s32, 0xffed4080, 0
    s_cselect_b32 s33, 20, 0
    s_sub_u32 s31, s31, s33
    s_add_u32 s30, s30, s32
    s_add_u32 s30, s30, 368640
    s_add_u32 m0, s29, 79872
    s_add_u32 s31, s31, 6
    buffer_load_dwordx4 v2, s[12:15], s30 offen lds
    s_cmp_ge_u32 s31, 20
    s_cselect_b32 s32, 0xffed4080, 0
    s_cselect_b32 s33, 20, 0
    s_sub_u32 s31, s31, s33
    s_add_u32 s30, s30, s32
    s_add_u32 s30, s30, 368640
    s_add_u32 m0, s29, 86016
    s_add_u32 s31, s31, 6
    buffer_load_dwordx4 v2, s[12:15], s30 offen lds
    s_cmp_ge_u32 s31, 20
    s_cselect_b32 s32, 0xffed4080, 0
    s_cselect_b32 s33, 20, 0
    s_sub_u32 s31, s31, s33
    s_add_u32 s30, s30, s32
    s_add_u32 s30, s30, 368640
    s_add_u32 m0, s29, 92160
    s_add_u32 s31, s31, 6
    buffer_load_dwordx4 v2, s[12:15], s30 offen lds
    s_cmp_ge_u32 s31, 20
    s_cselect_b32 s32, 0xffed4080, 0
    s_cselect_b32 s33, 20, 0
    s_sub_u32 s31, s31, s33
    s_add_u32 s30, s30, s32
    s_add_u32 s30, s30, 368640
    s_cmp_ge_u32 s3, 4
    s_cbranch_scc1 H_sk_54
    s_add_u32 m0, s29, 98304
    s_add_u32 s31, s31, 6
    buffer_load_dwordx4 v2, s[12:15], s30 offen lds
H_sk_54:
    s_waitcnt vmcnt(16)
    s_branch H_zz_53
H_z_52:
    s_cmp_eq_u32 s3, 6
    s_cbranch_scc1 H_6_55
    s_setprio 3
    v_lshlrev_b32 v5, 4, v0
    v_mov_b32 v16, 0
    v_mov_b32 v17, 0
    v_mov_b32 v18, 0
    v_mov_b32 v19, 0
    s_add_u32 s28, s40, 262144
    buffer_store_dwordx4 v[16:19], v5, s[8:11], s28 offen sc1
    s_mov_b64 exec, 0xffff
    buffer_store_dwordx4 v[16:19], v5, s[8:11], s28 offen offset:1024 sc1
    s_lshl_b32 s28, s24, 7
    s_add_u32 s28, s28, 65536
    s_mov_b64 exec, 0xff
    buffer_store_dwordx4 v[16:19], v5, s[8:11], s28 offen sc1
    s_lshl_b32 s33, s24, 2
    v_mov_b32 v15, s33
    v_mov_b32 v20, 1
    s_mov_b64 exec, 1
    s_waitcnt vmcnt(0)
    global_store_dword v15, v20, s[84:85] sc1
    s_mov_b64 exec, -1
    s_setprio 0
    s_branch H_zz_53
H_6_55:
    s_waitcnt vmcnt(0)
H_zz_53:
    v_lshlrev_b32 v10, 16, v10
    v_mul_f32 v6, 0xbfb8aa3b, v10
    v_exp_f32 v6, v6
    s_nop 0
    v_add_f32 v6, 1.0, v6
    v_rcp_f32 v6, v6
    s_nop 0
    v_mul_f32 v10, v10, v6
    v_cvt_pk_bf16_f32 v10, v10, 0
    v_lshlrev_b32 v11, 16, v10
    v_lshlrev_b32 v12, 16, v12
    v_mul_f32 v6, 0xbfb8aa3b, v12
    v_exp_f32 v6, v6
    s_nop 0
    v_add_f32 v6, 1.0, v6
    v_rcp_f32 v6, v6
    s_nop 0
    v_mul_f32 v12, v12, v6
    v_cvt_pk_bf16_f32 v12, v12, 0
    v_lshlrev_b32 v13, 16, v12
    v_add_u32 v4, 126976, v4
    ds_write_b16 v4, v10
    s_cmp_ge_u32 s3, 2
    s_cbranch_scc1 H_c_58
    ds_write_b16 v4, v12 offset:1024
H_c_58:
    v_lshrrev_b32 v5, 4, v0
    v_bfe_u32 v6, v0, 2, 2
    v_lshlrev_b32 v7, 10, v5
    v_lshl_add_u32 v7, v6, 7, v7
    v_lshrrev_b32 v6, 1, v6
    v_and_b32 v8, 1, v5
    v_lshl_or_b32 v6, v8, 1, v6
    v_lshlrev_b32 v6, 5, v6
    v_and_b32 v8, 3, v0
    v_lshl_add_u32 v7, v8, 3, v7
    v_lshlrev_b32 v5, 4, v5
    s_and_b32 s28, s3, 1
    s_lshl_b32 s28, s28, 6
    v_xor_b32 v9, s28, v6
    s_lshr_b32 s28, s3, 1
    s_mul_i32 s28, s28, 20480
    v_add3_u32 v9, v9, v7, s28
    v_xor_b32 v10, 32, v9
    v_add_u32 v11, 81920, v9
    v_add_u32 v12, 81920, v10
    s_mul_i32 s28, s25, 320
    v_add_u32 v3, 126976, v5
    v_add_u32 v13, s28, v3
    v_and_b32 v14, 1, v0
    v_lshl_add_u32 v14, v14, 6, v5
    s_mov_b32 s36, 0xaaaaaaaa
    s_mov_b32 s37, 0xaaaaaaaa
    s_mov_b32 s38, 0x00030003
    s_mov_b32 s39, 0x00030003
    s_lshl_b32 s33, s3, 7
    s_add_u32 s40, s40, s33
    s_add_u32 s28, s40, 262144
    v_and_b32 v15, 15, v0
    v_lshlrev_b32 v15, 2, v15
    v_mov_b32 v60, 0
    s_cmp_ge_u32 s3, 6
    s_cbranch_scc1 H_w_59
    s_waitcnt vmcnt(0)
H_w_59:
    s_waitcnt lgkmcnt(0)
    s_barrier
    s_lshl3_add_u32 s33, s24, s3
    s_cmp_lg_u32 s33, 6
    s_cbranch_scc1 H_c0_60
    global_load_dword v60, v15, s[84:85] sc1
H_c0_60:
    ds_read_b128 v[16:19], v13 offset:0
    ds_read_b128 v[20:23], v13 offset:64
    ds_read_b128 v[24:27], v13 offset:128
    ds_read_b128 v[28:31], v13 offset:192
    ds_read_b128 v[32:35], v13 offset:256
    ds_read_b64_tr_b16 v[64:65], v9 offset:0
    ds_read_b64_tr_b16 v[66:67], v9 offset:512
    ds_read_b64_tr_b16 v[68:69], v9 offset:4096
    ds_read_b64_tr_b16 v[70:71], v9 offset:4608
    ds_read_b64_tr_b16 v[72:73], v9 offset:8192
    ds_read_b64_tr_b16 v[74:75], v9 offset:8704
    ds_read_b64_tr_b16 v[76:77], v9 offset:12288
    ds_read_b64_tr_b16 v[78:79], v9 offset:12800
    ds_read_b64_tr_b16 v[80:81], v9 offset:16384
    ds_read_b64_tr_b16 v[82:83], v9 offset:16896
    ds_read_b64_tr_b16 v[84:85], v10 offset:0
    ds_read_b64_tr_b16 v[86:87], v10 offset:512
    ds_read_b64_tr_b16 v[88:89], v10 offset:4096
    ds_read_b64_tr_b16 v[90:91], v10 offset:4608
    ds_read_b64_tr_b16 v[92:93], v10 offset:8192
    ds_read_b64_tr_b16 v[94:95], v10 offset:8704
    ds_read_b64_tr_b16 v[96:97], v10 offset:12288
    ds_read_b64_tr_b16 v[98:99], v10 offset:12800
    ds_read_b64_tr_b16 v[100:101], v10 offset:16384
    ds_read_b64_tr_b16 v[102:103], v10 offset:16896
    s_waitcnt lgkmcnt(0)
    v_mfma_f32_16x16x32_bf16 v[36:39], v[64:67], v[16:19], 0
    v_mfma_f32_16x16x32_bf16 v[40:43], v[84:87], v[16:19], 0
    v_mfma_f32_16x16x32_bf16 v[36:39], v[68:71], v[20:23], v[36:39]
    v_mfma_f32_16x16x32_bf16 v[40:43], v[88:91], v[20:23], v[40:43]
    v_mfma_f32_16x16x32_bf16 v[36:39], v[72:75], v[24:27], v[36:39]
    v_mfma_f32_16x16x32_bf16 v[40:43], v[92:95], v[24:27], v[40:43]
    v_mfma_f32_16x16x32_bf16 v[36:39], v[76:79], v[28:31], v[36:39]
    v_mfma_f32_16x16x32_bf16 v[40:43], v[96:99], v[28:31], v[40:43]
    v_mfma_f32_16x16x32_bf16 v[36:39], v[80:83], v[32:35], v[36:39]
    v_mfma_f32_16x16x32_bf16 v[40:43], v[100:103], v[32:35], v[40:43]
    ds_read_b64_tr_b16 v[104:105], v11 offset:0
    ds_read_b64_tr_b16 v[106:107], v11 offset:512
    ds_read_b64_tr_b16 v[108:109], v11 offset:4096
    ds_read_b64_tr_b16 v[110:111], v11 offset:4608
    ds_read_b64_tr_b16 v[112:113], v11 offset:8192
    ds_read_b64_tr_b16 v[114:115], v11 offset:8704
    ds_read_b64_tr_b16 v[116:117], v11 offset:12288
    ds_read_b64_tr_b16 v[118:119], v11 offset:12800
    ds_read_b64_tr_b16 v[120:121], v11 offset:16384
    ds_read_b64_tr_b16 v[122:123], v11 offset:16896
    ds_read_b64_tr_b16 v[124:125], v12 offset:0
    ds_read_b64_tr_b16 v[126:127], v12 offset:512
    ds_read_b64_tr_b16 v[128:129], v12 offset:4096
    ds_read_b64_tr_b16 v[130:131], v12 offset:4608
    ds_read_b64_tr_b16 v[132:133], v12 offset:8192
    ds_read_b64_tr_b16 v[134:135], v12 offset:8704
    ds_read_b64_tr_b16 v[136:137], v12 offset:12288
    ds_read_b64_tr_b16 v[138:139], v12 offset:12800
    ds_read_b64_tr_b16 v[140:141], v12 offset:16384
    ds_read_b64_tr_b16 v[142:143], v12 offset:16896
    v_cndmask_b32 v52, v36, v40, s[36:37]
    v_cndmask_b32 v53, v37, v41, s[36:37]
    v_cndmask_b32 v54, v38, v42, s[36:37]
    v_cndmask_b32 v55, v39, v43, s[36:37]
    v_or_b32 v52, 1, v52
    v_or_b32 v53, 1, v53
    v_or_b32 v54, 1, v54
    v_or_b32 v55, 1, v55
    s_mov_b64 exec, s[38:39]
    buffer_store_dwordx4 v[52:55], v14, s[8:11], s28 offen sc1
    s_mov_b64 exec, -1
    s_waitcnt lgkmcnt(0)
    s_cmp_ge_u32 s3, 2
    s_cbranch_scc1 H_t_61
    v_mfma_f32_16x16x32_bf16 v[44:47], v[104:107], v[16:19], 0
    v_mfma_f32_16x16x32_bf16 v[48:51], v[124:127], v[16:19], 0
    v_mfma_f32_16x16x32_bf16 v[44:47], v[108:111], v[20:23], v[44:47]
    v_mfma_f32_16x16x32_bf16 v[48:51], v[128:131], v[20:23], v[48:51]
    v_mfma_f32_16x16x32_bf16 v[44:47], v[112:115], v[24:27], v[44:47]
    v_mfma_f32_16x16x32_bf16 v[48:51], v[132:135], v[24:27], v[48:51]
    v_mfma_f32_16x16x32_bf16 v[44:47], v[116:119], v[28:31], v[44:47]
    v_mfma_f32_16x16x32_bf16 v[48:51], v[136:139], v[28:31], v[48:51]
    v_mfma_f32_16x16x32_bf16 v[44:47], v[120:123], v[32:35], v[44:47]
    v_mfma_f32_16x16x32_bf16 v[48:51], v[140:143], v[32:35], v[48:51]
    s_nop 7
    v_cndmask_b32 v56, v44, v48, s[36:37]
    v_cndmask_b32 v57, v45, v49, s[36:37]
    v_cndmask_b32 v58, v46, v50, s[36:37]
    v_cndmask_b32 v59, v47, v51, s[36:37]
    v_or_b32 v56, 1, v56
    v_or_b32 v57, 1, v57
    v_or_b32 v58, 1, v58
    v_or_b32 v59, 1, v59
    s_mov_b64 exec, s[38:39]
    buffer_store_dwordx4 v[56:59], v14, s[8:11], s28 offen offset:1024 sc1
    s_mov_b64 exec, -1
H_t_61:
    s_lshl3_add_u32 s33, s24, s3
    s_cmp_lg_u32 s33, 6
    s_cbranch_scc1 H_col_62
    s_mov_b32 s61, 0
    s_waitcnt vmcnt(1)
    s_branch H_q_63
H_p_56:
    global_load_dword v60, v15, s[84:85] sc1
    s_add_u32 s61, s61, 1
    s_cmp_gt_u32 s61, 262144
    s_waitcnt vmcnt(0)
    s_cbranch_scc1 H_pe_57
H_q_63:
    v_cmp_ne_u32 vcc, 1, v60
    s_cbranch_vccnz H_p_56
H_pe_57:
    v_lshlrev_b32 v15, 2, v0
    v_mov_b32 v60, 1
    s_mov_b32 exec_hi, 0
    global_store_dword v15, v60, s[84:85] offset:128 sc1
    s_mov_b64 exec, -1
H_col_62:
    s_cmp_ge_u32 s3, 5
    s_cbranch_scc1 H_f_64
    s_cmp_ge_u32 s3, 2
    s_addc_u32 s28, s3, 0
    s_lshl4_add_u32 s28, s28, s24
    s_lshl_b32 s28, s28, 11
    v_lshlrev_b32 v15, 4, v0
    v_mov_b32 v60, 0
    v_mov_b32 v61, 0
    v_mov_b32 v62, 0
    v_mov_b32 v63, 0
    buffer_store_dwordx4 v[60:63], v15, s[8:11], s28 offen offset:0 sc1
    buffer_store_dwordx4 v[60:63], v15, s[8:11], s28 offen offset:1024 sc1
H_f_64:
    s_barrier
    s_add_u32 s30, s34, 3840
    s_mov_b32 s31, s3
    s_add_u32 m0, s29, 0
    s_add_u32 s31, s31, 8
    buffer_load_dwordx4 v2, s[12:15], s30 offen lds
    s_cmp_ge_u32 s31, 20
    s_cselect_b32 s32, 0xffed4080, 0
    s_cselect_b32 s33, 20, 0
    s_sub_u32 s31, s31, s33
    s_add_u32 s30, s30, s32
    s_add_u32 s30, s30, 491520
    s_add_u32 m0, s29, 8192
    s_add_u32 s31, s31, 8
    buffer_load_dwordx4 v2, s[12:15], s30 offen lds
    s_cmp_ge_u32 s31, 20
    s_cselect_b32 s32, 0xffed4080, 0
    s_cselect_b32 s33, 20, 0
    s_sub_u32 s31, s31, s33
    s_add_u32 s30, s30, s32
    s_add_u32 s30, s30, 491520
    s_add_u32 m0, s29, 16384
    s_add_u32 s31, s31, 8
    buffer_load_dwordx4 v2, s[12:15], s30 offen lds
    s_cmp_ge_u32 s31, 20
    s_cselect_b32 s32, 0xffed4080, 0
    s_cselect_b32 s33, 20, 0
    s_sub_u32 s31, s31, s33
    s_add_u32 s30, s30, s32
    s_add_u32 s30, s30, 491520
    s_add_u32 m0, s29, 24576
    s_add_u32 s31, s31, 8
    buffer_load_dwordx4 v2, s[12:15], s30 offen lds
    s_cmp_ge_u32 s31, 20
    s_cselect_b32 s32, 0xffed4080, 0
    s_cselect_b32 s33, 20, 0
    s_sub_u32 s31, s31, s33
    s_add_u32 s30, s30, s32
    s_add_u32 s30, s30, 491520
    s_add_u32 m0, s29, 32768
    s_add_u32 s31, s31, 8
    buffer_load_dwordx4 v2, s[12:15], s30 offen lds
    s_cmp_ge_u32 s31, 20
    s_cselect_b32 s32, 0xffed4080, 0
    s_cselect_b32 s33, 20, 0
    s_sub_u32 s31, s31, s33
    s_add_u32 s30, s30, s32
    s_add_u32 s30, s30, 491520
    s_add_u32 m0, s29, 40960
    s_add_u32 s31, s31, 8
    buffer_load_dwordx4 v2, s[12:15], s30 offen lds
    s_cmp_ge_u32 s31, 20
    s_cselect_b32 s32, 0xffed4080, 0
    s_cselect_b32 s33, 20, 0
    s_sub_u32 s31, s31, s33
    s_add_u32 s30, s30, s32
    s_add_u32 s30, s30, 491520
    s_add_u32 m0, s29, 49152
    s_add_u32 s31, s31, 8
    buffer_load_dwordx4 v2, s[12:15], s30 offen lds
    s_cmp_ge_u32 s31, 20
    s_cselect_b32 s32, 0xffed4080, 0
    s_cselect_b32 s33, 20, 0
    s_sub_u32 s31, s31, s33
    s_add_u32 s30, s30, s32
    s_add_u32 s30, s30, 491520
    s_add_u32 m0, s29, 57344
    s_add_u32 s31, s31, 8
    buffer_load_dwordx4 v2, s[12:15], s30 offen lds
    s_cmp_ge_u32 s31, 20
    s_cselect_b32 s32, 0xffed4080, 0
    s_cselect_b32 s33, 20, 0
    s_sub_u32 s31, s31, s33
    s_add_u32 s30, s30, s32
    s_add_u32 s30, s30, 491520
    s_add_u32 m0, s29, 65536
    s_add_u32 s31, s31, 8
    buffer_load_dwordx4 v2, s[12:15], s30 offen lds
    s_cmp_ge_u32 s31, 20
    s_cselect_b32 s32, 0xffed4080, 0
    s_cselect_b32 s33, 20, 0
    s_sub_u32 s31, s31, s33
    s_add_u32 s30, s30, s32
    s_add_u32 s30, s30, 491520
    s_add_u32 m0, s29, 73728
    s_add_u32 s31, s31, 8
    buffer_load_dwordx4 v2, s[12:15], s30 offen lds
    s_cmp_ge_u32 s31, 20
    s_cselect_b32 s32, 0xffed4080, 0
    s_cselect_b32 s33, 20, 0
    s_sub_u32 s31, s31, s33
    s_add_u32 s30, s30, s32
    s_add_u32 s30, s30, 491520
    s_add_u32 m0, s29, 81920
    s_add_u32 s31, s31, 8
    buffer_load_dwordx4 v2, s[12:15], s30 offen lds
    s_cmp_ge_u32 s31, 20
    s_cselect_b32 s32, 0xffed4080, 0
    s_cselect_b32 s33, 20, 0
    s_sub_u32 s31, s31, s33
    s_add_u32 s30, s30, s32
    s_add_u32 s30, s30, 491520
    s_add_u32 m0, s29, 90112
    s_add_u32 s31, s31, 8
    buffer_load_dwordx4 v2, s[12:15], s30 offen lds
    s_cmp_ge_u32 s31, 20
    s_cselect_b32 s32, 0xffed4080, 0
    s_cselect_b32 s33, 20, 0
    s_sub_u32 s31, s31, s33
    s_add_u32 s30, s30, s32
    s_add_u32 s30, s30, 491520
    s_cmp_ge_u32 s3, 4
    s_cbranch_scc1 H_sk_65
    s_add_u32 m0, s29, 98304
    s_add_u32 s31, s31, 8
    buffer_load_dwordx4 v2, s[12:15], s30 offen lds
H_sk_65:
    s_add_u32 s28, s40, 286720
    s_waitcnt vmcnt(0)
    s_barrier
    ds_read_b128 v[16:19], v13 offset:0
    ds_read_b128 v[20:23], v13 offset:64
    ds_read_b128 v[24:27], v13 offset:128
    ds_read_b128 v[28:31], v13 offset:192
    ds_read_b128 v[32:35], v13 offset:256
    ds_read_b64_tr_b16 v[64:65], v9 offset:0
    ds_read_b64_tr_b16 v[66:67], v9 offset:512
    ds_read_b64_tr_b16 v[68:69], v9 offset:4096
    ds_read_b64_tr_b16 v[70:71], v9 offset:4608
    ds_read_b64_tr_b16 v[72:73], v9 offset:8192
    ds_read_b64_tr_b16 v[74:75], v9 offset:8704
    ds_read_b64_tr_b16 v[76:77], v9 offset:12288
    ds_read_b64_tr_b16 v[78:79], v9 offset:12800
    ds_read_b64_tr_b16 v[80:81], v9 offset:16384
    ds_read_b64_tr_b16 v[82:83], v9 offset:16896
    ds_read_b64_tr_b16 v[84:85], v10 offset:0
    ds_read_b64_tr_b16 v[86:87], v10 offset:512
    ds_read_b64_tr_b16 v[88:89], v10 offset:4096
    ds_read_b64_tr_b16 v[90:91], v10 offset:4608
    ds_read_b64_tr_b16 v[92:93], v10 offset:8192
    ds_read_b64_tr_b16 v[94:95], v10 offset:8704
    ds_read_b64_tr_b16 v[96:97], v10 offset:12288
    ds_read_b64_tr_b16 v[98:99], v10 offset:12800
    ds_read_b64_tr_b16 v[100:101], v10 offset:16384
    ds_read_b64_tr_b16 v[102:103], v10 offset:16896
    s_waitcnt lgkmcnt(0)
    v_mfma_f32_16x16x32_bf16 v[36:39], v[64:67], v[16:19], 0
    v_mfma_f32_16x16x32_bf16 v[40:43], v[84:87], v[16:19], 0
    v_mfma_f32_16x16x32_bf16 v[36:39], v[68:71], v[20:23], v[36:39]
    v_mfma_f32_16x16x32_bf16 v[40:43], v[88:91], v[20:23], v[40:43]
    v_mfma_f32_16x16x32_bf16 v[36:39], v[72:75], v[24:27], v[36:39]
    v_mfma_f32_16x16x32_bf16 v[40:43], v[92:95], v[24:27], v[40:43]
    v_mfma_f32_16x16x32_bf16 v[36:39], v[76:79], v[28:31], v[36:39]
    v_mfma_f32_16x16x32_bf16 v[40:43], v[96:99], v[28:31], v[40:43]
    v_mfma_f32_16x16x32_bf16 v[36:39], v[80:83], v[32:35], v[36:39]
    v_mfma_f32_16x16x32_bf16 v[40:43], v[100:103], v[32:35], v[40:43]
    ds_read_b64_tr_b16 v[104:105], v11 offset:0
    ds_read_b64_tr_b16 v[106:107], v11 offset:512
    ds_read_b64_tr_b16 v[108:109], v11 offset:4096
    ds_read_b64_tr_b16 v[110:111], v11 offset:4608
    ds_read_b64_tr_b16 v[112:113], v11 offset:8192
    ds_read_b64_tr_b16 v[114:115], v11 offset:8704
    ds_read_b64_tr_b16 v[116:117], v11 offset:12288
    ds_read_b64_tr_b16 v[118:119], v11 offset:12800
    ds_read_b64_tr_b16 v[120:121], v11 offset:16384
    ds_read_b64_tr_b16 v[122:123], v11 offset:16896
    ds_read_b64_tr_b16 v[124:125], v12 offset:0
    ds_read_b64_tr_b16 v[126:127], v12 offset:512
    ds_read_b64_tr_b16 v[128:129], v12 offset:4096
    ds_read_b64_tr_b16 v[130:131], v12 offset:4608
    ds_read_b64_tr_b16 v[132:133], v12 offset:8192
    ds_read_b64_tr_b16 v[134:135], v12 offset:8704
    ds_read_b64_tr_b16 v[136:137], v12 offset:12288
    ds_read_b64_tr_b16 v[138:139], v12 offset:12800
    ds_read_b64_tr_b16 v[140:141], v12 offset:16384
    ds_read_b64_tr_b16 v[142:143], v12 offset:16896
    v_cndmask_b32 v52, v36, v40, s[36:37]
    v_cndmask_b32 v53, v37, v41, s[36:37]
    v_cndmask_b32 v54, v38, v42, s[36:37]
    v_cndmask_b32 v55, v39, v43, s[36:37]
    s_mov_b64 exec, s[38:39]
    buffer_store_dwordx4 v[52:55], v14, s[8:11], s28 offen sc1
    s_mov_b64 exec, -1
    s_waitcnt lgkmcnt(0)
    s_cmp_ge_u32 s3, 2
    s_cbranch_scc1 H_t_66
    v_mfma_f32_16x16x32_bf16 v[44:47], v[104:107], v[16:19], 0
    v_mfma_f32_16x16x32_bf16 v[48:51], v[124:127], v[16:19], 0
    v_mfma_f32_16x16x32_bf16 v[44:47], v[108:111], v[20:23], v[44:47]
    v_mfma_f32_16x16x32_bf16 v[48:51], v[128:131], v[20:23], v[48:51]
    v_mfma_f32_16x16x32_bf16 v[44:47], v[112:115], v[24:27], v[44:47]
    v_mfma_f32_16x16x32_bf16 v[48:51], v[132:135], v[24:27], v[48:51]
    v_mfma_f32_16x16x32_bf16 v[44:47], v[116:119], v[28:31], v[44:47]
    v_mfma_f32_16x16x32_bf16 v[48:51], v[136:139], v[28:31], v[48:51]
    v_mfma_f32_16x16x32_bf16 v[44:47], v[120:123], v[32:35], v[44:47]
    v_mfma_f32_16x16x32_bf16 v[48:51], v[140:143], v[32:35], v[48:51]
    s_nop 7
    v_cndmask_b32 v56, v44, v48, s[36:37]
    v_cndmask_b32 v57, v45, v49, s[36:37]
    v_cndmask_b32 v58, v46, v50, s[36:37]
    v_cndmask_b32 v59, v47, v51, s[36:37]
    s_mov_b64 exec, s[38:39]
    buffer_store_dwordx4 v[56:59], v14, s[8:11], s28 offen offset:1024 sc1
    s_mov_b64 exec, -1
H_t_66:
    v_mov_b32 v17, 128
    s_mov_b32 s61, 0
go_67:
    s_sleep 2
    global_load_dword v16, v17, s[84:85] sc1
    s_add_u32 s61, s61, 1
    s_cmp_gt_u32 s61, 262144
    s_waitcnt vmcnt(0)
    s_cbranch_scc1 goe_69
goc_68:
    v_cmp_ne_u32 vcc, 1, v16
    s_cbranch_vccnz go_67
goe_69:
    s_barrier
    s_cmp_lg_u32 s3, 0
    s_cbranch_scc1 sig_70
    s_lshl_b32 s60, s24, 7
    s_add_u32 s60, s60, 65536
    v_lshlrev_b32 v254, 2, v0
    v_mov_b32 v255, 1
    s_mov_b32 exec_hi, 0
    buffer_store_dword v255, v254, s[8:11], s60 offen sc1
    s_mov_b64 exec, -1
sig_70:
    v_and_b32 v10, 15, v0
    v_lshlrev_b32 v10, 7, v10
    s_mov_b32 s57, 65536
    s_cmp_lg_u32 s3, 0
    s_cbranch_scc1 polle_72
    s_mov_b32 s61, 0
poll_71:
    buffer_load_dword v11, v10, s[8:11], s57 offen sc1
    s_add_u32 s61, s61, 1
    s_cmp_gt_u32 s61, 262144
    s_waitcnt vmcnt(0)
    s_cbranch_scc1 polle_72
    v_cmp_ne_u32 vcc, 1, v11
    s_sleep 4
    s_cbranch_vccnz poll_71
polle_72:
    s_mov_b32 s49, 0
    s_mov_b32 s51, 0
    s_mov_b32 s52, 0
    s_mov_b32 s53, 0
    s_mov_b32 s54, 0
    s_mov_b32 s55, 0
    v_mov_b32 v221, 0x7f000000
    v_mov_b32 v222, 0x7f000000
    s_and_b32 s24, s5, 3
    s_lshl2_add_u32 s24, s4, s24
    s_lshr_b32 s25, s5, 2
    s_and_b32 s26, s3, 3
    s_lshr_b32 s27, s3, 2
    s_mov_b32 s28, 0
    s_mov_b32 s30, 0xfffff
    s_mov_b32 s31, 0xfffff
    v_lshlrev_b32 v4, 4, v0
    v_and_b32 v1, 31, v0
    v_lshlrev_b32 v6, 3, v1
    v_lshrrev_b32 v7, 5, v0
    v_lshl_add_u32 v7, v7, 10, v6
    s_mul_i32 s32, s24, 81920
    s_mul_i32 s33, s25, 10240
    s_add_u32 s32, s32, s33
    s_lshl_b32 s39, s3, 10
    s_add_u32 s40, s32, s39
    s_add_u32 s40, s40, 4194304
    s_add_u32 s39, s39, 61440
    s_mul_i32 s32, s26, 2560
    s_lshl_b32 s33, s27, 8
    s_add_u32 s32, s32, s33
    s_add_u32 s32, s32, 61440
    v_add_u32 v195, s32, v7
    v_xor_b32 v194, 256, v195
    v_add_u32 v197, s32, v6
    v_xor_b32 v196, 256, v197
    s_mul_i32 s41, s27, 81920
    s_lshl_b32 s33, s26, 10
    s_add_u32 s41, s41, s33
    s_mul_i32 s42, s24, 163840
    s_add_u32 s42, s42, s41
    s_add_u32 s42, s42, 7340032
    v_mov_b32 v199, v7
    s_mul_i32 s33, s26, 3072
    s_add_u32 s33, s33, 40960
    s_mul_i32 s34, s27, 81920
    s_sub_u32 s35, 81920, s34
    s_add_u32 s34, s34, s33
    s_add_u32 s35, s35, s33
    v_add_u32 v233, s34, v4
    v_add_u32 v234, s35, v4
    s_lshl2_add_u32 s35, s3, 53248
    v_mov_b32 v235, s35
    v_and_b32 v1, 7, v0
    v_lshlrev_b32 v1, 2, v1
    v_add_u32 v236, 53248, v1
    s_mov_b32 s34, 0x7b800000
    s_lshl_b32 s33, s25, 4
    s_lshl2_add_u32 s33, s26, s33
    s_lshl1_add_u32 s33, s27, s33
    s_mul_i32 s33, s33, 20480
    s_add_u32 s33, s33, 12582912
    s_lshl_b32 s37, s24, 9
    s_add_u32 s37, s37, s33
    s_lshl_b32 s38, s24, 7
    s_add_u32 s38, s38, 16384
    s_add_u32 s38, s38, s33
    v_and_b32 v1, 15, v0
    v_bfe_u32 v6, v0, 4, 1
    v_mul_u32_u24 v6, 20480, v6
    v_lshl_add_u32 v7, v1, 4, v6
    v_lshl_add_u32 v232, v1, 3, v6
    v_lshrrev_b32 v6, 5, v0
    v_lshl_add_u32 v231, v6, 8, v7
    s_mul_i32 s32, s24, 20
    s_add_u32 s33, s32, 19
    s_lshr_b32 s32, s32, 7
    s_lshr_b32 s33, s33, 7
    s_sub_u32 s33, s33, s32
    v_bfe_u32 v1, v0, 4, 1
    v_mul_u32_u24 v1, s33, v1
    v_lshrrev_b32 v10, 5, v0
    v_mul_u32_u24 v10, 5, v10
    v_add3_u32 v10, v10, v1, s32
    v_add_u32 v10, 5, v10
    v_and_b32 v1, 15, v0
    v_lshl_add_u32 v10, v10, 4, v1
    v_lshlrev_b32 v237, 7, v10
    v_and_b32 v1, 1, v0
    v_mul_u32_u24 v1, s33, v1
    v_add_u32 v1, s32, v1
    v_bfe_u32 v11, v0, 1, 1
    v_lshl_add_u32 v11, v1, 4, v11
    s_lshl_b32 s32, s25, 1
    v_add_lshl_u32 v238, v11, s32, 7
    v_lshlrev_b32 v193, 7, v0
centry_2:
    s_mov_b32 s44, 0
    s_mov_b32 s46, 0
    s_mov_b32 s50, 0
    s_mov_b32 s101, 0
    s_mov_b32 s57, 0
    s_cmp_lg_u32 s3, 0
    s_cbranch_scc1 polle_74
    s_mov_b32 s61, 0
poll_73:
    buffer_load_dword v12, v237, s[8:11], s57 offen sc1
    buffer_load_dword v13, v238, s[8:11], s57 offen sc1
    s_add_u32 s61, s61, 1
    s_cmp_gt_u32 s61, 262144
    s_waitcnt vmcnt(0)
    s_cbranch_scc1 polle_74
    v_and_b32 v12, v12, v13
    v_cmp_ne_u32 vcc, 1, v12
    s_cbranch_vccnz poll_73
polle_74:
    s_and_b32 s57, s3, 3
    s_lshl_b32 s57, s57, 13
    s_add_u32 s57, s57, 32768
    s_barrier
C_restart_77:
    s_cmp_ge_u32 s3, 2
    s_cbranch_scc1 C_q_81
    s_add_u32 m0, s39, 8192
    s_add_u32 s62, s40, 8192
    buffer_load_dwordx4 v4, s[8:11], s62 offen sc1 lds
C_q_81:
    s_mov_b32 m0, s39
    s_nop 0
    buffer_load_dwordx4 v4, s[8:11], s40 offen sc1 lds
    s_add_u32 m0, s41, 0
    s_add_u32 s62, s42, 0
    buffer_load_dwordx4 v4, s[8:11], s62 offen sc1 lds
    s_add_u32 m0, s41, 4096
    s_add_u32 s62, s42, 4096
    buffer_load_dwordx4 v4, s[8:11], s62 offen sc1 lds
    s_add_u32 m0, s41, 8192
    s_add_u32 s62, s42, 8192
    buffer_load_dwordx4 v4, s[8:11], s62 offen sc1 lds
    s_add_u32 m0, s41, 12288
    s_add_u32 s62, s42, 12288
    buffer_load_dwordx4 v4, s[8:11], s62 offen sc1 lds
    s_add_u32 m0, s41, 16384
    s_add_u32 s62, s42, 16384
    buffer_load_dwordx4 v4, s[8:11], s62 offen sc1 lds
    v_mov_b32 v192, 0xdddddddd
    v_and_b32 v1, 31, v0
    v_lshrrev_b32 v6, 5, v0
    v_lshrrev_b32 v7, 4, v1
    v_xor_b32 v7, v7, v6
    v_lshl_add_u32 v7, v1, 1, v7
    s_mul_i32 s33, s27, 81920
    v_lshl_add_u32 v3, v7, 4, s33
    v_add_u32 v2, s33, v199
    v_add_u32 v5, 256, v2
    v_lshl_add_u32 v15, v0, 3, s33
    v_cmp_eq_u32 vcc, 20, v1
    v_mov_b32 v7, 0x3f803f80
    v_mov_b32 v80, 0
    v_mov_b32 v81, 0
    v_mov_b32 v82, 0
    v_mov_b32 v83, 0
    v_mov_b32 v84, 0
    v_mov_b32 v85, 0
    v_mov_b32 v86, 0
    v_mov_b32 v87, 0
    v_mov_b32 v88, 0
    v_mov_b32 v89, 0
    v_mov_b32 v90, 0
    v_mov_b32 v91, 0
    v_mov_b32 v92, 0
    v_mov_b32 v93, 0
    v_mov_b32 v94, 0
    v_mov_b32 v95, 0
    v_mov_b32 v96, 0
    v_mov_b32 v97, 0
    v_mov_b32 v98, 0
    v_mov_b32 v99, 0
    v_mov_b32 v100, 0
    v_mov_b32 v101, 0
    v_mov_b32 v102, 0
    v_mov_b32 v103, 0
    v_mov_b32 v104, 0
    v_mov_b32 v105, 0
    v_mov_b32 v106, 0
    v_mov_b32 v107, 0
    v_mov_b32 v108, 0
    v_mov_b32 v109, 0
    v_mov_b32 v110, 0
    v_mov_b32 v111, 0
    v_cndmask_b32 v176, 0, v7, vcc
    v_cndmask_b32 v177, 0, v7, vcc
    v_cndmask_b32 v178, 0, v7, vcc
    v_cndmask_b32 v179, 0, v7, vcc
    v_cndmask_b32 v180, 0, v7, vcc
    v_cndmask_b32 v181, 0, v7, vcc
    v_cndmask_b32 v182, 0, v7, vcc
    v_cndmask_b32 v183, 0, v7, vcc
    v_cndmask_b32 v184, 0, v7, vcc
    v_cndmask_b32 v185, 0, v7, vcc
    v_cndmask_b32 v186, 0, v7, vcc
    v_cndmask_b32 v187, 0, v7, vcc
    v_cndmask_b32 v188, 0, v7, vcc
    v_cndmask_b32 v189, 0, v7, vcc
    v_cndmask_b32 v190, 0, v7, vcc
    v_cndmask_b32 v191, 0, v7, vcc
    v_lshlrev_b32 v1, 3, v0
    s_waitcnt vmcnt(3)
    v_cmp_gt_u32 vcc, 32, v0
    s_barrier
    ds_read_b64 v[8:9], v196 offset:2048
    ds_read_b64 v[10:11], v197 offset:2048
    ds_read2st64_b64 v[144:147], v194 offset0:0 offset1:1
    ds_read2st64_b64 v[148:151], v195 offset0:0 offset1:1
    ds_read2st64_b64 v[160:163], v199 offset0:0 offset1:1
    ds_read2st64_b64 v[168:171], v1 offset0:4 offset1:9
    s_waitcnt lgkmcnt(4)
    v_cndmask_b32 v152, 0, v8, vcc
    v_cndmask_b32 v154, v8, 0, vcc
    v_cndmask_b32 v153, 0, v9, vcc
    v_cndmask_b32 v155, v9, 0, vcc
    v_cndmask_b32 v156, 0, v10, vcc
    v_cndmask_b32 v158, v10, 0, vcc
    v_cndmask_b32 v157, 0, v11, vcc
    v_cndmask_b32 v159, v11, 0, vcc
    s_cmp_lg_u32 s28, 0
    s_cbranch_scc1 C_exact_78
    s_waitcnt lgkmcnt(0)
    v_mfma_f32_32x32x16_bf16 v[16:31], v[160:163], v[144:147], 0
    v_mfma_f32_32x32x16_bf16 v[32:47], v[160:163], v[148:151], 0
    v_mfma_f32_32x32x8bf16_1k v[16:31], v[168:169], v[152:153], v[16:31]
    v_mfma_f32_32x32x8bf16_1k v[32:47], v[168:169], v[156:157], v[32:47]
    ds_read2st64_b64 v[160:163], v2 offset0:0 offset1:1
    ds_read2st64_b64 v[168:171], v15 offset0:4 offset1:9
    s_nop 9
    v_max3_f32 v6, v16, v17, v18
    v_max3_f32 v6, v6, v19, v31
    v_max3_f32 v6, v6, v20, v21
    v_max3_f32 v6, v6, v22, v23
    v_max3_f32 v6, v6, v24, v25
    v_max3_f32 v6, v6, v26, v27
    v_max3_f32 v6, v6, v28, v29
    v_max3_f32 v6, v6, v30, v30
    v_max3_f32 v7, v32, v33, v34
    v_max3_f32 v7, v7, v35, v47
    v_max3_f32 v7, v7, v36, v37
    v_max3_f32 v7, v7, v38, v39
    v_max3_f32 v7, v7, v40, v41
    v_max3_f32 v7, v7, v42, v43
    v_max3_f32 v7, v7, v44, v45
    v_max3_f32 v7, v7, v46, v46
    s_mov_b32 s33, 0xc2000000
C_havem_79:
    v_mov_b32 v12, v6
    v_mov_b32 v13, v7
    s_nop 1
    v_permlane32_swap_b32 v6, v12
    v_permlane32_swap_b32 v7, v13
    v_max_f32 v6, v6, v12
    v_max_f32 v7, v7, v13
    v_sub_f32 v112, s33, v6
    v_sub_f32 v128, s33, v7
    v_mov_b32 v113, v112
    v_mov_b32 v114, v112
    v_mov_b32 v115, v112
    v_mov_b32 v116, v112
    v_mov_b32 v117, v112
    v_mov_b32 v118, v112
    v_mov_b32 v119, v112
    v_mov_b32 v120, v112
    v_mov_b32 v121, v112
    v_mov_b32 v122, v112
    v_mov_b32 v123, v112
    v_mov_b32 v124, v112
    v_mov_b32 v125, v112
    v_mov_b32 v126, v112
    v_mov_b32 v127, v112
    s_waitcnt vmcnt(0) lgkmcnt(0)
    s_nop 0
    v_mfma_f32_32x32x16_bf16 v[16:31], v[160:163], v[144:147], v[112:127]
    v_mfma_f32_32x32x8bf16_1k v[16:31], v[168:169], v[152:153], v[16:31]
    s_barrier
    s_mov_b64 exec, s[30:31]
    ds_read_b128 v[176:179], v3 offset:10240
    ds_read_b128 v[180:183], v3 offset:10880
    s_mov_b64 exec, -1
    v_mov_b32 v129, v128
    v_mov_b32 v130, v128
    v_mov_b32 v131, v128
    v_mov_b32 v132, v128
    v_mov_b32 v133, v128
    v_mov_b32 v134, v128
    v_mov_b32 v135, v128
    v_mov_b32 v136, v128
    v_mov_b32 v137, v128
    v_mov_b32 v138, v128
    v_mov_b32 v139, v128
    v_mov_b32 v140, v128
    v_mov_b32 v141, v128
    v_mov_b32 v142, v128
    v_mov_b32 v143, v128
    s_nop 1
    v_mfma_f32_32x32x16_bf16 v[32:47], v[160:163], v[148:151], v[128:143]
    v_exp_f32 v16, v16
    v_exp_f32 v17, v17
    v_exp_f32 v18, v18
    v_exp_f32 v19, v19
    ds_read2st64_b64 v[164:167], v5 offset0:0 offset1:1
    v_mfma_f32_32x32x8bf16_1k v[32:47], v[168:169], v[156:157], v[32:47]
    v_exp_f32 v20, v20
    v_exp_f32 v21, v21
    v_exp_f32 v22, v22
    v_exp_f32 v23, v23
    v_exp_f32 v24, v24
    v_exp_f32 v25, v25
    v_exp_f32 v26, v26
    v_exp_f32 v27, v27
    s_add_u32 m0, s41, 20480
    s_add_u32 s62, s42, 20480
    buffer_load_dwordx4 v4, s[8:11], s62 offen sc1 lds
    v_exp_f32 v28, v28
    v_exp_f32 v29, v29
    v_exp_f32 v30, v30
    v_exp_f32 v31, v31
    s_waitcnt lgkmcnt(0)
    v_mfma_f32_32x32x16_bf16 v[48:63], v[164:167], v[144:147], v[112:127]
    v_exp_f32 v32, v32
    v_exp_f32 v33, v33
    v_exp_f32 v34, v34
    v_exp_f32 v35, v35
    v_mfma_f32_32x32x8bf16_1k v[48:63], v[168:169], v[154:155], v[48:63]
    v_exp_f32 v36, v36
    v_exp_f32 v37, v37
    v_exp_f32 v38, v38
    v_exp_f32 v39, v39
    s_mov_b64 exec, s[30:31]
    ds_read_b128 v[184:187], v3 offset:11520
    ds_read_b128 v[188:191], v3 offset:12160
    s_mov_b64 exec, -1
    v_smfmac_f32_32x32x32_bf16 v[80:95], v[176:179], v[16:23], v192
    v_exp_f32 v40, v40
    v_exp_f32 v41, v41
    v_exp_f32 v42, v42
    v_exp_f32 v43, v43
    s_add_u32 m0, s41, 24576
    s_add_u32 s62, s42, 24576
    buffer_load_dwordx4 v4, s[8:11], s62 offen sc1 lds
    v_smfmac_f32_32x32x32_bf16 v[80:95], v[180:183], v[24:31], v192
    v_exp_f32 v44, v44
    v_exp_f32 v45, v45
    v_exp_f32 v46, v46
    v_exp_f32 v47, v47
    v_mfma_f32_32x32x16_bf16 v[64:79], v[164:167], v[148:151], v[128:143]
    v_exp_f32 v48, v48
    v_exp_f32 v49, v49
    v_exp_f32 v50, v50
    v_exp_f32 v51, v51
    ds_read2st64_b64 v[160:163], v2 offset0:5 offset1:6
    v_mfma_f32_32x32x8bf16_1k v[64:79], v[168:169], v[158:159], v[64:79]
    v_exp_f32 v52, v52
    v_exp_f32 v53, v53
    v_exp_f32 v54, v54
    v_exp_f32 v55, v55
    v_smfmac_f32_32x32x32_bf16 v[96:111], v[176:179], v[32:39], v192
    v_exp_f32 v56, v56
    v_exp_f32 v57, v57
    v_exp_f32 v58, v58
    v_exp_f32 v59, v59
    s_add_u32 m0, s41, 28672
    s_add_u32 s62, s42, 28672
    buffer_load_dwordx4 v4, s[8:11], s62 offen sc1 lds
    v_smfmac_f32_32x32x32_bf16 v[96:111], v[180:183], v[40:47], v192
    v_exp_f32 v60, v60
    v_exp_f32 v61, v61
    v_exp_f32 v62, v62
    v_exp_f32 v63, v63
    s_waitcnt lgkmcnt(0)
    v_mfma_f32_32x32x16_bf16 v[16:31], v[160:163], v[144:147], v[112:127]
    v_exp_f32 v64, v64
    v_exp_f32 v65, v65
    v_exp_f32 v66, v66
    v_exp_f32 v67, v67
    v_mfma_f32_32x32x8bf16_1k v[16:31], v[170:171], v[152:153], v[16:31]
    v_exp_f32 v68, v68
    v_exp_f32 v69, v69
    v_exp_f32 v70, v70
    v_exp_f32 v71, v71
    s_mov_b64 exec, s[30:31]
    ds_read_b128 v[176:179], v3 offset:12800
    ds_read_b128 v[180:183], v3 offset:13440
    s_mov_b64 exec, -1
    v_smfmac_f32_32x32x32_bf16 v[80:95], v[184:187], v[48:55], v192
    v_exp_f32 v72, v72
    v_exp_f32 v73, v73
    v_exp_f32 v74, v74
    v_exp_f32 v75, v75
    s_add_u32 m0, s41, 32768
    s_add_u32 s62, s42, 32768
    buffer_load_dwordx4 v4, s[8:11], s62 offen sc1 lds
    v_smfmac_f32_32x32x32_bf16 v[80:95], v[188:191], v[56:63], v192
    v_exp_f32 v76, v76
    v_exp_f32 v77, v77
    v_exp_f32 v78, v78
    v_exp_f32 v79, v79
    v_mfma_f32_32x32x16_bf16 v[32:47], v[160:163], v[148:151], v[128:143]
    v_exp_f32 v16, v16
    v_exp_f32 v17, v17
    v_exp_f32 v18, v18
    v_exp_f32 v19, v19
    ds_read2st64_b64 v[164:167], v5 offset0:5 offset1:6
    v_mfma_f32_32x32x8bf16_1k v[32:47], v[170:171], v[156:157], v[32:47]
    v_exp_f32 v20, v20
    v_exp_f32 v21, v21
    v_exp_f32 v22, v22
    v_exp_f32 v23, v23
    ds_read2st64_b64 v[172:175], v15 offset0:14 offset1:19
    v_smfmac_f32_32x32x32_bf16 v[96:111], v[184:187], v[64:71], v192
    v_exp_f32 v24, v24
    v_exp_f32 v25, v25
    v_exp_f32 v26, v26
    v_exp_f32 v27, v27
    s_add_u32 m0, s41, 36864
    s_add_u32 s62, s42, 36864
    buffer_load_dwordx4 v4, s[8:11], s62 offen sc1 lds
    v_smfmac_f32_32x32x32_bf16 v[96:111], v[188:191], v[72:79], v192
    v_exp_f32 v28, v28
    v_exp_f32 v29, v29
    v_exp_f32 v30, v30
    v_exp_f32 v31, v31
    s_waitcnt lgkmcnt(0)
    v_mfma_f32_32x32x16_bf16 v[48:63], v[164:167], v[144:147], v[112:127]
    v_exp_f32 v32, v32
    v_exp_f32 v33, v33
    v_exp_f32 v34, v34
    v_exp_f32 v35, v35
    v_mfma_f32_32x32x8bf16_1k v[48:63], v[170:171], v[154:155], v[48:63]
    v_exp_f32 v36, v36
    v_exp_f32 v37, v37
    v_exp_f32 v38, v38
    v_exp_f32 v39, v39
    s_mov_b64 exec, s[30:31]
    ds_read_b128 v[184:187], v3 offset:14080
    ds_read_b128 v[188:191], v3 offset:14720
    s_mov_b64 exec, -1
    v_smfmac_f32_32x32x32_bf16 v[80:95], v[176:179], v[16:23], v192
    v_exp_f32 v40, v40
    v_exp_f32 v41, v41
    v_exp_f32 v42, v42
    v_exp_f32 v43, v43
    buffer_store_dwordx4 v[200:203], v222, s[8:11], s51 offen offset:0 sc1
    v_smfmac_f32_32x32x32_bf16 v[80:95], v[180:183], v[24:31], v192
    v_exp_f32 v44, v44
    v_exp_f32 v45, v45
    v_exp_f32 v46, v46
    v_exp_f32 v47, v47
    v_mfma_f32_32x32x16_bf16 v[64:79], v[164:167], v[148:151], v[128:143]
    v_exp_f32 v48, v48
    v_exp_f32 v49, v49
    v_exp_f32 v50, v50
    v_exp_f32 v51, v51
    ds_read2st64_b64 v[160:163], v2 offset0:10 offset1:11
    v_mfma_f32_32x32x8bf16_1k v[64:79], v[170:171], v[158:159], v[64:79]
    v_exp_f32 v52, v52
    v_exp_f32 v53, v53
    v_exp_f32 v54, v54
    v_exp_f32 v55, v55
    v_smfmac_f32_32x32x32_bf16 v[96:111], v[176:179], v[32:39], v192
    v_exp_f32 v56, v56
    v_exp_f32 v57, v57
    v_exp_f32 v58, v58
    v_exp_f32 v59, v59
    buffer_store_dwordx4 v[204:207], v222, s[8:11], s55 offen offset:1024 sc1
    v_smfmac_f32_32x32x32_bf16 v[96:111], v[180:183], v[40:47], v192
    v_exp_f32 v60, v60
    v_exp_f32 v61, v61
    v_exp_f32 v62, v62
    v_exp_f32 v63, v63
    s_waitcnt lgkmcnt(0)
    v_mfma_f32_32x32x16_bf16 v[16:31], v[160:163], v[144:147], v[112:127]
    v_exp_f32 v64, v64
    v_exp_f32 v65, v65
    v_exp_f32 v66, v66
    v_exp_f32 v67, v67
    v_mfma_f32_32x32x8bf16_1k v[16:31], v[172:173], v[152:153], v[16:31]
    v_exp_f32 v68, v68
    v_exp_f32 v69, v69
    v_exp_f32 v70, v70
    v_exp_f32 v71, v71
    s_mov_b64 exec, s[30:31]
    ds_read_b128 v[176:179], v3 offset:15360
    ds_read_b128 v[180:183], v3 offset:16000
    s_mov_b64 exec, -1
    v_smfmac_f32_32x32x32_bf16 v[80:95], v[184:187], v[48:55], v192
    v_exp_f32 v72, v72
    v_exp_f32 v73, v73
    v_exp_f32 v74, v74
    v_exp_f32 v75, v75
    buffer_store_dwordx4 v[208:211], v222, s[8:11], s52 offen offset:2048 sc1
    v_smfmac_f32_32x32x32_bf16 v[80:95], v[188:191], v[56:63], v192
    v_exp_f32 v76, v76
    v_exp_f32 v77, v77
    v_exp_f32 v78, v78
    v_exp_f32 v79, v79
    v_mfma_f32_32x32x16_bf16 v[32:47], v[160:163], v[148:151], v[128:143]
    v_exp_f32 v16, v16
    v_exp_f32 v17, v17
    v_exp_f32 v18, v18
    v_exp_f32 v19, v19
    ds_read2st64_b64 v[164:167], v5 offset0:10 offset1:11
    v_mfma_f32_32x32x8bf16_1k v[32:47], v[172:173], v[156:157], v[32:47]
    v_exp_f32 v20, v20
    v_exp_f32 v21, v21
    v_exp_f32 v22, v22
    v_exp_f32 v23, v23
    v_smfmac_f32_32x32x32_bf16 v[96:111], v[184:187], v[64:71], v192
    v_exp_f32 v24, v24
    v_exp_f32 v25, v25
    v_exp_f32 v26, v26
    v_exp_f32 v27, v27
    buffer_store_dwordx4 v[212:215], v222, s[8:11], s54 offen offset:3072 sc1
    v_smfmac_f32_32x32x32_bf16 v[96:111], v[188:191], v[72:79], v192
    v_exp_f32 v28, v28
    v_exp_f32 v29, v29
    v_exp_f32 v30, v30
    v_exp_f32 v31, v31
    s_waitcnt lgkmcnt(0)
    v_mfma_f32_32x32x16_bf16 v[48:63], v[164:167], v[144:147], v[112:127]
    v_exp_f32 v32, v32
    v_exp_f32 v33, v33
    v_exp_f32 v34, v34
    v_exp_f32 v35, v35
    v_mfma_f32_32x32x8bf16_1k v[48:63], v[172:173], v[154:155], v[48:63]
    v_exp_f32 v36, v36
    v_exp_f32 v37, v37
    v_exp_f32 v38, v38
    v_exp_f32 v39, v39
    s_mov_b64 exec, s[30:31]
    ds_read_b128 v[184:187], v3 offset:16640
    ds_read_b128 v[188:191], v3 offset:17280
    s_mov_b64 exec, -1
    v_smfmac_f32_32x32x32_bf16 v[80:95], v[176:179], v[16:23], v192
    v_exp_f32 v40, v40
    v_exp_f32 v41, v41
    v_exp_f32 v42, v42
    v_exp_f32 v43, v43
    buffer_store_dwordx4 v[216:219], v222, s[8:11], s49 offen offset:0 sc1
    v_smfmac_f32_32x32x32_bf16 v[80:95], v[180:183], v[24:31], v192
    v_exp_f32 v44, v44
    v_exp_f32 v45, v45
    v_exp_f32 v46, v46
    v_exp_f32 v47, v47
    v_mfma_f32_32x32x16_bf16 v[64:79], v[164:167], v[148:151], v[128:143]
    v_exp_f32 v48, v48
    v_exp_f32 v49, v49
    v_exp_f32 v50, v50
    v_exp_f32 v51, v51
    ds_read2st64_b64 v[160:163], v2 offset0:15 offset1:16
    v_mfma_f32_32x32x8bf16_1k v[64:79], v[172:173], v[158:159], v[64:79]
    v_exp_f32 v52, v52
    v_exp_f32 v53, v53
    v_exp_f32 v54, v54
    v_exp_f32 v55, v55
    v_smfmac_f32_32x32x32_bf16 v[96:111], v[176:179], v[32:39], v192
    v_exp_f32 v56, v56
    v_exp_f32 v57, v57
    v_exp_f32 v58, v58
    v_exp_f32 v59, v59
    buffer_store_dword v220, v221, s[8:11], s53 offen sc1
    v_smfmac_f32_32x32x32_bf16 v[96:111], v[180:183], v[40:47], v192
    v_exp_f32 v60, v60
    v_exp_f32 v61, v61
    v_exp_f32 v62, v62
    v_exp_f32 v63, v63
    s_waitcnt lgkmcnt(0)
    v_mfma_f32_32x32x16_bf16 v[16:31], v[160:163], v[144:147], v[112:127]
    v_exp_f32 v64, v64
    v_exp_f32 v65, v65
    v_exp_f32 v66, v66
    v_exp_f32 v67, v67
    v_mfma_f32_32x32x8bf16_1k v[16:31], v[174:175], v[152:153], v[16:31]
    v_exp_f32 v68, v68
    v_exp_f32 v69, v69
    v_exp_f32 v70, v70
    v_exp_f32 v71, v71
    s_mov_b64 exec, s[30:31]
    ds_read_b128 v[176:179], v3 offset:17920
    ds_read_b128 v[180:183], v3 offset:18560
    s_mov_b64 exec, -1
    v_smfmac_f32_32x32x32_bf16 v[80:95], v[184:187], v[48:55], v192
    v_exp_f32 v72, v72
    v_exp_f32 v73, v73
    v_exp_f32 v74, v74
    v_exp_f32 v75, v75
    s_add_u32 m0, s41, 40960
    s_add_u32 s62, s42, 40960
    buffer_load_dwordx4 v4, s[8:11], s62 offen sc1 lds
    v_smfmac_f32_32x32x32_bf16 v[80:95], v[188:191], v[56:63], v192
    v_exp_f32 v76, v76
    v_exp_f32 v77, v77
    v_exp_f32 v78, v78
    v_exp_f32 v79, v79
    s_waitcnt vmcnt(7)
    s_barrier
    v_mfma_f32_32x32x16_bf16 v[32:47], v[160:163], v[148:151], v[128:143]
    v_exp_f32 v16, v16
    v_exp_f32 v17, v17
    v_exp_f32 v18, v18
    v_exp_f32 v19, v19
    ds_read2st64_b64 v[164:167], v5 offset0:15 offset1:16
    v_mfma_f32_32x32x8bf16_1k v[32:47], v[174:175], v[156:157], v[32:47]
    v_exp_f32 v20, v20
    v_exp_f32 v21, v21
    v_exp_f32 v22, v22
    v_exp_f32 v23, v23
    ds_read2st64_b64 v[168:171], v15 offset0:44 offset1:49
    v_smfmac_f32_32x32x32_bf16 v[96:111], v[184:187], v[64:71], v192
    v_exp_f32 v24, v24
    v_exp_f32 v25, v25
    v_exp_f32 v26, v26
    v_exp_f32 v27, v27
    s_add_u32 m0, s41, 45056
    s_add_u32 s62, s42, 45056
    buffer_load_dwordx4 v4, s[8:11], s62 offen sc1 lds
    v_smfmac_f32_32x32x32_bf16 v[96:111], v[188:191], v[72:79], v192
    v_exp_f32 v28, v28
    v_exp_f32 v29, v29
    v_exp_f32 v30, v30
    v_exp_f32 v31, v31
    s_waitcnt lgkmcnt(0)
    v_mfma_f32_32x32x16_bf16 v[48:63], v[164:167], v[144:147], v[112:127]
    v_exp_f32 v32, v32
    v_exp_f32 v33, v33
    v_exp_f32 v34, v34
    v_exp_f32 v35, v35
    v_mfma_f32_32x32x8bf16_1k v[48:63], v[174:175], v[154:155], v[48:63]
    v_exp_f32 v36, v36
    v_exp_f32 v37, v37
    v_exp_f32 v38, v38
    v_exp_f32 v39, v39
    s_mov_b64 exec, s[30:31]
    ds_read_b128 v[184:187], v3 offset:19200
    ds_read_b128 v[188:191], v3 offset:19840
    s_mov_b64 exec, -1
    v_smfmac_f32_32x32x32_bf16 v[80:95], v[176:179], v[16:23], v192
    v_exp_f32 v40, v40
    v_exp_f32 v41, v41
    v_exp_f32 v42, v42
    v_exp_f32 v43, v43
    s_add_u32 m0, s41, 49152
    s_add_u32 s62, s42, 49152
    buffer_load_dwordx4 v4, s[8:11], s62 offen sc1 lds
    v_smfmac_f32_32x32x32_bf16 v[80:95], v[180:183], v[24:31], v192
    v_exp_f32 v44, v44
    v_exp_f32 v45, v45
    v_exp_f32 v46, v46
    v_exp_f32 v47, v47
    v_mfma_f32_32x32x16_bf16 v[64:79], v[164:167], v[148:151], v[128:143]
    v_exp_f32 v48, v48
    v_exp_f32 v49, v49
    v_exp_f32 v50, v50
    v_exp_f32 v51, v51
    ds_read2st64_b64 v[160:163], v2 offset0:40 offset1:41
    v_mfma_f32_32x32x8bf16_1k v[64:79], v[174:175], v[158:159], v[64:79]
    v_exp_f32 v52, v52
    v_exp_f32 v53, v53
    v_exp_f32 v54, v54
    v_exp_f32 v55, v55
    v_smfmac_f32_32x32x32_bf16 v[96:111], v[176:179], v[32:39], v192
    v_exp_f32 v56, v56
    v_exp_f32 v57, v57
    v_exp_f32 v58, v58
    v_exp_f32 v59, v59
    s_add_u32 m0, s41, 53248
    s_add_u32 s62, s42, 53248
    buffer_load_dwordx4 v4, s[8:11], s62 offen sc1 lds
    v_smfmac_f32_32x32x32_bf16 v[96:111], v[180:183], v[40:47], v192
    v_exp_f32 v60, v60
    v_exp_f32 v61, v61
    v_exp_f32 v62, v62
    v_exp_f32 v63, v63
    s_waitcnt lgkmcnt(0)
    v_mfma_f32_32x32x16_bf16 v[16:31], v[160:163], v[144:147], v[112:127]
    v_exp_f32 v64, v64
    v_exp_f32 v65, v65
    v_exp_f32 v66, v66
    v_exp_f32 v67, v67
    v_mfma_f32_32x32x8bf16_1k v[16:31], v[168:169], v[152:153], v[16:31]
    v_exp_f32 v68, v68
    v_exp_f32 v69, v69
    v_exp_f32 v70, v70
    v_exp_f32 v71, v71
    s_mov_b64 exec, s[30:31]
    ds_read_b128 v[176:179], v3 offset:30720
    ds_read_b128 v[180:183], v3 offset:31360
    s_mov_b64 exec, -1
    v_smfmac_f32_32x32x32_bf16 v[80:95], v[184:187], v[48:55], v192
    v_exp_f32 v72, v72
    v_exp_f32 v73, v73
    v_exp_f32 v74, v74
    v_exp_f32 v75, v75
    s_add_u32 m0, s41, 57344
    s_add_u32 s62, s42, 57344
    buffer_load_dwordx4 v4, s[8:11], s62 offen sc1 lds
    v_smfmac_f32_32x32x32_bf16 v[80:95], v[188:191], v[56:63], v192
    v_exp_f32 v76, v76
    v_exp_f32 v77, v77
    v_exp_f32 v78, v78
    v_exp_f32 v79, v79
    v_mfma_f32_32x32x16_bf16 v[32:47], v[160:163], v[148:151], v[128:143]
    v_exp_f32 v16, v16
    v_exp_f32 v17, v17
    v_exp_f32 v18, v18
    v_exp_f32 v19, v19
    ds_read2st64_b64 v[164:167], v5 offset0:40 offset1:41
    v_mfma_f32_32x32x8bf16_1k v[32:47], v[168:169], v[156:157], v[32:47]
    v_exp_f32 v20, v20
    v_exp_f32 v21, v21
    v_exp_f32 v22, v22
    v_exp_f32 v23, v23
    v_smfmac_f32_32x32x32_bf16 v[96:111], v[184:187], v[64:71], v192
    v_exp_f32 v24, v24
    v_exp_f32 v25, v25
    v_exp_f32 v26, v26
    v_exp_f32 v27, v27
    s_add_u32 m0, s41, 61440
    s_add_u32 s62, s42, 61440
    buffer_load_dwordx4 v4, s[8:11], s62 offen sc1 lds
    v_smfmac_f32_32x32x32_bf16 v[96:111], v[188:191], v[72:79], v192
    v_exp_f32 v28, v28
    v_exp_f32 v29, v29
    v_exp_f32 v30, v30
    v_exp_f32 v31, v31
    s_waitcnt lgkmcnt(0)
    v_mfma_f32_32x32x16_bf16 v[48:63], v[164:167], v[144:147], v[112:127]
    v_exp_f32 v32, v32
    v_exp_f32 v33, v33
    v_exp_f32 v34, v34
    v_exp_f32 v35, v35
    v_mfma_f32_32x32x8bf16_1k v[48:63], v[168:169], v[154:155], v[48:63]
    v_exp_f32 v36, v36
    v_exp_f32 v37, v37
    v_exp_f32 v38, v38
    v_exp_f32 v39, v39
    s_mov_b64 exec, s[30:31]
    ds_read_b128 v[184:187], v3 offset:32000
    ds_read_b128 v[188:191], v3 offset:32640
    s_mov_b64 exec, -1
    v_smfmac_f32_32x32x32_bf16 v[80:95], v[176:179], v[16:23], v192
    v_exp_f32 v40, v40
    v_exp_f32 v41, v41
    v_exp_f32 v42, v42
    v_exp_f32 v43, v43
    s_add_u32 m0, s41, 65536
    s_add_u32 s62, s42, 65536
    buffer_load_dwordx4 v4, s[8:11], s62 offen sc1 lds
    v_smfmac_f32_32x32x32_bf16 v[80:95], v[180:183], v[24:31], v192
    v_exp_f32 v44, v44
    v_exp_f32 v45, v45
    v_exp_f32 v46, v46
    v_exp_f32 v47, v47
    v_mfma_f32_32x32x16_bf16 v[64:79], v[164:167], v[148:151], v[128:143]
    v_exp_f32 v48, v48
    v_exp_f32 v49, v49
    v_exp_f32 v50, v50
    v_exp_f32 v51, v51
    ds_read2st64_b64 v[160:163], v2 offset0:45 offset1:46
    v_mfma_f32_32x32x8bf16_1k v[64:79], v[168:169], v[158:159], v[64:79]
    v_exp_f32 v52, v52
    v_exp_f32 v53, v53
    v_exp_f32 v54, v54
    v_exp_f32 v55, v55
    v_smfmac_f32_32x32x32_bf16 v[96:111], v[176:179], v[32:39], v192
    v_exp_f32 v56, v56
    v_exp_f32 v57, v57
    v_exp_f32 v58, v58
    v_exp_f32 v59, v59
    s_add_u32 m0, s41, 69632
    s_add_u32 s62, s42, 69632
    buffer_load_dwordx4 v4, s[8:11], s62 offen sc1 lds
    v_smfmac_f32_32x32x32_bf16 v[96:111], v[180:183], v[40:47], v192
    v_exp_f32 v60, v60
    v_exp_f32 v61, v61
    v_exp_f32 v62, v62
    v_exp_f32 v63, v63
    s_waitcnt lgkmcnt(0)
    v_mfma_f32_32x32x16_bf16 v[16:31], v[160:163], v[144:147], v[112:127]
    v_exp_f32 v64, v64
    v_exp_f32 v65, v65
    v_exp_f32 v66, v66
    v_exp_f32 v67, v67
    v_mfma_f32_32x32x8bf16_1k v[16:31], v[170:171], v[152:153], v[16:31]
    v_exp_f32 v68, v68
    v_exp_f32 v69, v69
    v_exp_f32 v70, v70
    v_exp_f32 v71, v71
    s_mov_b64 exec, s[30:31]
    ds_read_b128 v[176:179], v3 offset:33280
    ds_read_b128 v[180:183], v3 offset:33920
    s_mov_b64 exec, -1
    v_smfmac_f32_32x32x32_bf16 v[80:95], v[184:187], v[48:55], v192
    v_exp_f32 v72, v72
    v_exp_f32 v73, v73
    v_exp_f32 v74, v74
    v_exp_f32 v75, v75
    s_add_u32 m0, s41, 73728
    s_add_u32 s62, s42, 73728
    buffer_load_dwordx4 v4, s[8:11], s62 offen sc1 lds
    v_smfmac_f32_32x32x32_bf16 v[80:95], v[188:191], v[56:63], v192
    v_exp_f32 v76, v76
    v_exp_f32 v77, v77
    v_exp_f32 v78, v78
    v_exp_f32 v79, v79
    v_mfma_f32_32x32x16_bf16 v[32:47], v[160:163], v[148:151], v[128:143]
    v_exp_f32 v16, v16
    v_exp_f32 v17, v17
    v_exp_f32 v18, v18
    v_exp_f32 v19, v19
    ds_read2st64_b64 v[164:167], v5 offset0:45 offset1:46
    v_mfma_f32_32x32x8bf16_1k v[32:47], v[170:171], v[156:157], v[32:47]
    v_exp_f32 v20, v20
    v_exp_f32 v21, v21
    v_exp_f32 v22, v22
    v_exp_f32 v23, v23
    ds_read2st64_b64 v[172:175], v15 offset0:54 offset1:59
    v_smfmac_f32_32x32x32_bf16 v[96:111], v[184:187], v[64:71], v192
    v_exp_f32 v24, v24
    v_exp_f32 v25, v25
    v_exp_f32 v26, v26
    v_exp_f32 v27, v27
    s_add_u32 m0, s41, 77824
    s_add_u32 s62, s42, 77824
    buffer_load_dwordx4 v4, s[8:11], s62 offen sc1 lds
    v_smfmac_f32_32x32x32_bf16 v[96:111], v[188:191], v[72:79], v192
    v_exp_f32 v28, v28
    v_exp_f32 v29, v29
    v_exp_f32 v30, v30
    v_exp_f32 v31, v31
    s_waitcnt lgkmcnt(0)
    v_mfma_f32_32x32x16_bf16 v[48:63], v[164:167], v[144:147], v[112:127]
    v_exp_f32 v32, v32
    v_exp_f32 v33, v33
    v_exp_f32 v34, v34
    v_exp_f32 v35, v35
    v_mfma_f32_32x32x8bf16_1k v[48:63], v[170:171], v[154:155], v[48:63]
    v_exp_f32 v36, v36
    v_exp_f32 v37, v37
    v_exp_f32 v38, v38
    v_exp_f32 v39, v39
    s_mov_b64 exec, s[30:31]
    ds_read_b128 v[184:187], v3 offset:34560
    ds_read_b128 v[188:191], v3 offset:35200
    s_mov_b64 exec, -1
    v_smfmac_f32_32x32x32_bf16 v[80:95], v[176:179], v[16:23], v192
    v_exp_f32 v40, v40
    v_exp_f32 v41, v41
    v_exp_f32 v42, v42
    v_exp_f32 v43, v43
    s_and_b32 s43, s5, 3
    s_lshr_b32 s44, s5, 2
    s_and_b32 s45, s3, 3
    s_lshr_b32 s46, s3, 2
    s_lshl1_add_u32 s47, s44, s46
    s_mul_i32 s58, s47, 51200
    s_lshl_b32 s47, s45, 10
    s_add_u32 s58, s58, s47
    s_add_u32 s58, s58, 26214400
    s_mul_i32 s63, s46, 81920
    s_add_u32 s63, s63, s47
    s_mul_i32 s59, s46, 81920
    s_add_u32 s59, s59, s47
    v_smfmac_f32_32x32x32_bf16 v[80:95], v[180:183], v[24:31], v192
    v_exp_f32 v44, v44
    v_exp_f32 v45, v45
    v_exp_f32 v46, v46
    v_exp_f32 v47, v47
    v_mfma_f32_32x32x16_bf16 v[64:79], v[164:167], v[148:151], v[128:143]
    v_exp_f32 v48, v48
    v_exp_f32 v49, v49
    v_exp_f32 v50, v50
    v_exp_f32 v51, v51
    ds_read2st64_b64 v[160:163], v2 offset0:50 offset1:51
    v_mfma_f32_32x32x8bf16_1k v[64:79], v[170:171], v[158:159], v[64:79]
    v_exp_f32 v52, v52
    v_exp_f32 v53, v53
    v_exp_f32 v54, v54
    v_exp_f32 v55, v55
    v_smfmac_f32_32x32x32_bf16 v[96:111], v[176:179], v[32:39], v192
    v_exp_f32 v56, v56
    v_exp_f32 v57, v57
    v_exp_f32 v58, v58
    v_exp_f32 v59, v59
    v_smfmac_f32_32x32x32_bf16 v[96:111], v[180:183], v[40:47], v192
    v_exp_f32 v60, v60
    v_exp_f32 v61, v61
    v_exp_f32 v62, v62
    v_exp_f32 v63, v63
    s_waitcnt lgkmcnt(0)
    s_waitcnt vmcnt(0)
    s_barrier
    s_cmp_lg_u32 s3, 0
    s_cbranch_scc1 sig_82
    s_lshl_b32 s60, s2, 7
    s_add_u32 s60, s60, 32768
    v_lshlrev_b32 v254, 2, v0
    v_mov_b32 v255, 1
    s_mov_b32 exec_hi, 0
    buffer_store_dword v255, v254, s[8:11], s60 offen sc1
    s_mov_b64 exec, -1
sig_82:
    v_mfma_f32_32x32x16_bf16 v[16:31], v[160:163], v[144:147], v[112:127]
    v_exp_f32 v64, v64
    v_exp_f32 v65, v65
    v_exp_f32 v66, v66
    v_exp_f32 v67, v67
    v_mfma_f32_32x32x8bf16_1k v[16:31], v[172:173], v[152:153], v[16:31]
    v_exp_f32 v68, v68
    v_exp_f32 v69, v69
    v_exp_f32 v70, v70
    v_exp_f32 v71, v71
    s_mov_b64 exec, s[30:31]
    ds_read_b128 v[176:179], v3 offset:35840
    ds_read_b128 v[180:183], v3 offset:36480
    s_mov_b64 exec, -1
    v_smfmac_f32_32x32x32_bf16 v[80:95], v[184:187], v[48:55], v192
    v_exp_f32 v72, v72
    v_exp_f32 v73, v73
    v_exp_f32 v74, v74
    v_exp_f32 v75, v75
    v_smfmac_f32_32x32x32_bf16 v[80:95], v[188:191], v[56:63], v192
    v_exp_f32 v76, v76
    v_exp_f32 v77, v77
    v_exp_f32 v78, v78
    v_exp_f32 v79, v79
    v_mfma_f32_32x32x16_bf16 v[32:47], v[160:163], v[148:151], v[128:143]
    v_exp_f32 v16, v16
    v_exp_f32 v17, v17
    v_exp_f32 v18, v18
    v_exp_f32 v19, v19
    ds_read2st64_b64 v[164:167], v5 offset0:50 offset1:51
    v_mfma_f32_32x32x8bf16_1k v[32:47], v[172:173], v[156:157], v[32:47]
    v_exp_f32 v20, v20
    v_exp_f32 v21, v21
    v_exp_f32 v22, v22
    v_exp_f32 v23, v23
    v_smfmac_f32_32x32x32_bf16 v[96:111], v[184:187], v[64:71], v192
    v_exp_f32 v24, v24
    v_exp_f32 v25, v25
    v_exp_f32 v26, v26
    v_exp_f32 v27, v27
    v_smfmac_f32_32x32x32_bf16 v[96:111], v[188:191], v[72:79], v192
    v_exp_f32 v28, v28
    v_exp_f32 v29, v29
    v_exp_f32 v30, v30
    v_exp_f32 v31, v31
    s_waitcnt lgkmcnt(0)
    v_mfma_f32_32x32x16_bf16 v[48:63], v[164:167], v[144:147], v[112:127]
    v_exp_f32 v32, v32
    v_exp_f32 v33, v33
    v_exp_f32 v34, v34
    v_exp_f32 v35, v35
    v_mfma_f32_32x32x8bf16_1k v[48:63], v[172:173], v[154:155], v[48:63]
    v_exp_f32 v36, v36
    v_exp_f32 v37, v37
    v_exp_f32 v38, v38
    v_exp_f32 v39, v39
    s_mov_b64 exec, s[30:31]
    ds_read_b128 v[184:187], v3 offset:37120
    ds_read_b128 v[188:191], v3 offset:37760
    s_mov_b64 exec, -1
    v_smfmac_f32_32x32x32_bf16 v[80:95], v[176:179], v[16:23], v192
    v_exp_f32 v40, v40
    v_exp_f32 v41, v41
    v_exp_f32 v42, v42
    v_exp_f32 v43, v43
    v_smfmac_f32_32x32x32_bf16 v[80:95], v[180:183], v[24:31], v192
    v_exp_f32 v44, v44
    v_exp_f32 v45, v45
    v_exp_f32 v46, v46
    v_exp_f32 v47, v47
    v_mfma_f32_32x32x16_bf16 v[64:79], v[164:167], v[148:151], v[128:143]
    v_exp_f32 v48, v48
    v_exp_f32 v49, v49
    v_exp_f32 v50, v50
    v_exp_f32 v51, v51
    ds_read2st64_b64 v[160:163], v2 offset0:55 offset1:56
    v_mfma_f32_32x32x8bf16_1k v[64:79], v[172:173], v[158:159], v[64:79]
    v_exp_f32 v52, v52
    v_exp_f32 v53, v53
    v_exp_f32 v54, v54
    v_exp_f32 v55, v55
    v_smfmac_f32_32x32x32_bf16 v[96:111], v[176:179], v[32:39], v192
    v_exp_f32 v56, v56
    v_exp_f32 v57, v57
    v_exp_f32 v58, v58
    v_exp_f32 v59, v59
    v_smfmac_f32_32x32x32_bf16 v[96:111], v[180:183], v[40:47], v192
    v_exp_f32 v60, v60
    v_exp_f32 v61, v61
    v_exp_f32 v62, v62
    v_exp_f32 v63, v63
    s_waitcnt lgkmcnt(0)
    v_mfma_f32_32x32x16_bf16 v[16:31], v[160:163], v[144:147], v[112:127]
    v_exp_f32 v64, v64
    v_exp_f32 v65, v65
    v_exp_f32 v66, v66
    v_exp_f32 v67, v67
    v_mfma_f32_32x32x8bf16_1k v[16:31], v[174:175], v[152:153], v[16:31]
    v_exp_f32 v68, v68
    v_exp_f32 v69, v69
    v_exp_f32 v70, v70
    v_exp_f32 v71, v71
    s_mov_b64 exec, s[30:31]
    ds_read_b128 v[176:179], v3 offset:38400
    ds_read_b128 v[180:183], v3 offset:39040
    s_mov_b64 exec, -1
    v_smfmac_f32_32x32x32_bf16 v[80:95], v[184:187], v[48:55], v192
    v_exp_f32 v72, v72
    v_exp_f32 v73, v73
    v_exp_f32 v74, v74
    v_exp_f32 v75, v75
    v_smfmac_f32_32x32x32_bf16 v[80:95], v[188:191], v[56:63], v192
    v_exp_f32 v76, v76
    v_exp_f32 v77, v77
    v_exp_f32 v78, v78
    v_exp_f32 v79, v79
    v_mfma_f32_32x32x16_bf16 v[32:47], v[160:163], v[148:151], v[128:143]
    v_exp_f32 v16, v16
    v_exp_f32 v17, v17
    v_exp_f32 v18, v18
    v_exp_f32 v19, v19
    ds_read2st64_b64 v[164:167], v5 offset0:55 offset1:56
    v_mfma_f32_32x32x8bf16_1k v[32:47], v[174:175], v[156:157], v[32:47]
    v_exp_f32 v20, v20
    v_exp_f32 v21, v21
    v_exp_f32 v22, v22
    v_exp_f32 v23, v23
    ds_read2st64_b64 v[168:171], v15 offset0:84 offset1:89
    v_smfmac_f32_32x32x32_bf16 v[96:111], v[184:187], v[64:71], v192
    v_exp_f32 v24, v24
    v_exp_f32 v25, v25
    v_exp_f32 v26, v26
    v_exp_f32 v27, v27
    v_smfmac_f32_32x32x32_bf16 v[96:111], v[188:191], v[72:79], v192
    v_exp_f32 v28, v28
    v_exp_f32 v29, v29
    v_exp_f32 v30, v30
    v_exp_f32 v31, v31
    s_waitcnt lgkmcnt(0)
    v_mfma_f32_32x32x16_bf16 v[48:63], v[164:167], v[144:147], v[112:127]
    v_exp_f32 v32, v32
    v_exp_f32 v33, v33
    v_exp_f32 v34, v34
    v_exp_f32 v35, v35
    v_mfma_f32_32x32x8bf16_1k v[48:63], v[174:175], v[154:155], v[48:63]
    v_exp_f32 v36, v36
    v_exp_f32 v37, v37
    v_exp_f32 v38, v38
    v_exp_f32 v39, v39
    s_mov_b64 exec, s[30:31]
    ds_read_b128 v[184:187], v3 offset:39680
    ds_read_b128 v[188:191], v3 offset:40320
    s_mov_b64 exec, -1
    v_smfmac_f32_32x32x32_bf16 v[80:95], v[176:179], v[16:23], v192
    v_exp_f32 v40, v40
    v_exp_f32 v41, v41
    v_exp_f32 v42, v42
    v_exp_f32 v43, v43
    v_smfmac_f32_32x32x32_bf16 v[80:95], v[180:183], v[24:31], v192
    v_exp_f32 v44, v44
    v_exp_f32 v45, v45
    v_exp_f32 v46, v46
    v_exp_f32 v47, v47
    v_mfma_f32_32x32x16_bf16 v[64:79], v[164:167], v[148:151], v[128:143]
    v_exp_f32 v48, v48
    v_exp_f32 v49, v49
    v_exp_f32 v50, v50
    v_exp_f32 v51, v51
    ds_read2st64_b64 v[160:163], v2 offset0:80 offset1:81
    v_mfma_f32_32x32x8bf16_1k v[64:79], v[174:175], v[158:159], v[64:79]
    v_exp_f32 v52, v52
    v_exp_f32 v53, v53
    v_exp_f32 v54, v54
    v_exp_f32 v55, v55
    v_smfmac_f32_32x32x32_bf16 v[96:111], v[176:179], v[32:39], v192
    v_exp_f32 v56, v56
    v_exp_f32 v57, v57
    v_exp_f32 v58, v58
    v_exp_f32 v59, v59
    v_smfmac_f32_32x32x32_bf16 v[96:111], v[180:183], v[40:47], v192
    v_exp_f32 v60, v60
    v_exp_f32 v61, v61
    v_exp_f32 v62, v62
    v_exp_f32 v63, v63
    s_waitcnt lgkmcnt(0)
    v_mfma_f32_32x32x16_bf16 v[16:31], v[160:163], v[144:147], v[112:127]
    v_exp_f32 v64, v64
    v_exp_f32 v65, v65
    v_exp_f32 v66, v66
    v_exp_f32 v67, v67
    v_mfma_f32_32x32x8bf16_1k v[16:31], v[168:169], v[152:153], v[16:31]
    v_exp_f32 v68, v68
    v_exp_f32 v69, v69
    v_exp_f32 v70, v70
    v_exp_f32 v71, v71
    v_add_u32 v3, 40960, v3
    s_mov_b64 exec, s[30:31]
    ds_read_b128 v[176:179], v3 offset:10240
    ds_read_b128 v[180:183], v3 offset:10880
    s_mov_b64 exec, -1
    v_smfmac_f32_32x32x32_bf16 v[80:95], v[184:187], v[48:55], v192
    v_exp_f32 v72, v72
    v_exp_f32 v73, v73
    v_exp_f32 v74, v74
    v_exp_f32 v75, v75
    buffer_load_dword v217, v193, s[8:11], s57 offen sc1
    v_smfmac_f32_32x32x32_bf16 v[80:95], v[188:191], v[56:63], v192
    v_exp_f32 v76, v76
    v_exp_f32 v77, v77
    v_exp_f32 v78, v78
    v_exp_f32 v79, v79
    v_mfma_f32_32x32x16_bf16 v[32:47], v[160:163], v[148:151], v[128:143]
    v_exp_f32 v16, v16
    v_exp_f32 v17, v17
    v_exp_f32 v18, v18
    v_exp_f32 v19, v19
    ds_read2st64_b64 v[164:167], v5 offset0:80 offset1:81
    v_mfma_f32_32x32x8bf16_1k v[32:47], v[168:169], v[156:157], v[32:47]
    v_exp_f32 v20, v20
    v_exp_f32 v21, v21
    v_exp_f32 v22, v22
    v_exp_f32 v23, v23
    v_smfmac_f32_32x32x32_bf16 v[96:111], v[184:187], v[64:71], v192
    v_exp_f32 v24, v24
    v_exp_f32 v25, v25
    v_exp_f32 v26, v26
    v_exp_f32 v27, v27
    v_smfmac_f32_32x32x32_bf16 v[96:111], v[188:191], v[72:79], v192
    v_exp_f32 v28, v28
    v_exp_f32 v29, v29
    v_exp_f32 v30, v30
    v_exp_f32 v31, v31
    s_waitcnt lgkmcnt(0)
    v_mfma_f32_32x32x16_bf16 v[48:63], v[164:167], v[144:147], v[112:127]
    v_exp_f32 v32, v32
    v_exp_f32 v33, v33
    v_exp_f32 v34, v34
    v_exp_f32 v35, v35
    v_mfma_f32_32x32x8bf16_1k v[48:63], v[168:169], v[154:155], v[48:63]
    v_exp_f32 v36, v36
    v_exp_f32 v37, v37
    v_exp_f32 v38, v38
    v_exp_f32 v39, v39
    s_mov_b64 exec, s[30:31]
    ds_read_b128 v[184:187], v3 offset:11520
    ds_read_b128 v[188:191], v3 offset:12160
    s_mov_b64 exec, -1
    v_smfmac_f32_32x32x32_bf16 v[80:95], v[176:179], v[16:23], v192
    v_exp_f32 v40, v40
    v_exp_f32 v41, v41
    v_exp_f32 v42, v42
    v_exp_f32 v43, v43
    v_smfmac_f32_32x32x32_bf16 v[80:95], v[180:183], v[24:31], v192
    v_exp_f32 v44, v44
    v_exp_f32 v45, v45
    v_exp_f32 v46, v46
    v_exp_f32 v47, v47
    s_waitcnt vmcnt(0)
    v_cmp_ne_u32 vcc, 1, v217
    s_cbranch_vccnz Cspin_75
Cret_76:
    s_barrier
    v_mfma_f32_32x32x16_bf16 v[64:79], v[164:167], v[148:151], v[128:143]
    v_exp_f32 v48, v48
    v_exp_f32 v49, v49
    v_exp_f32 v50, v50
    v_exp_f32 v51, v51
    ds_read2st64_b64 v[160:163], v2 offset0:85 offset1:86
    v_mfma_f32_32x32x8bf16_1k v[64:79], v[168:169], v[158:159], v[64:79]
    v_exp_f32 v52, v52
    v_exp_f32 v53, v53
    v_exp_f32 v54, v54
    v_exp_f32 v55, v55
    v_smfmac_f32_32x32x32_bf16 v[96:111], v[176:179], v[32:39], v192
    v_exp_f32 v56, v56
    v_exp_f32 v57, v57
    v_exp_f32 v58, v58
    v_exp_f32 v59, v59
    s_and_b32 s49, s4, 1
    s_lshr_b32 s50, s5, 2
    s_lshl3_add_u32 s49, s49, s50
    s_mul_i32 s49, s49, 441370
    s_lshr_b32 s49, s49, 16
    s_lshl_b32 s49, s49, 8
    s_add_u32 s50, s49, 328448
    s_and_b32 s51, s3, 4
    s_lshl_b32 s51, s51, 8
    s_add_u32 s49, s49, s51
    s_add_u32 s49, s49, 327680
    v_lshlrev_b32 v216, 2, v0
    buffer_load_dword v200, v216, s[8:11], s49 offen offset:0 sc1
    buffer_load_dword v204, v216, s[8:11], s49 offen offset:256 sc1
    buffer_load_dword v208, v216, s[8:11], s49 offen offset:512 sc1
    buffer_load_dword v212, v216, s[8:11], s50 offen offset:0 sc1
    v_smfmac_f32_32x32x32_bf16 v[96:111], v[180:183], v[40:47], v192
    v_exp_f32 v60, v60
    v_exp_f32 v61, v61
    v_exp_f32 v62, v62
    v_exp_f32 v63, v63
    s_waitcnt lgkmcnt(0)
    v_mfma_f32_32x32x16_bf16 v[16:31], v[160:163], v[144:147], v[112:127]
    v_exp_f32 v64, v64
    v_exp_f32 v65, v65
    v_exp_f32 v66, v66
    v_exp_f32 v67, v67
    v_mfma_f32_32x32x8bf16_1k v[16:31], v[170:171], v[152:153], v[16:31]
    v_exp_f32 v68, v68
    v_exp_f32 v69, v69
    v_exp_f32 v70, v70
    v_exp_f32 v71, v71
    s_mov_b64 exec, s[30:31]
    ds_read_b128 v[176:179], v3 offset:12800
    ds_read_b128 v[180:183], v3 offset:13440
    s_mov_b64 exec, -1
    v_smfmac_f32_32x32x32_bf16 v[80:95], v[184:187], v[48:55], v192
    v_exp_f32 v72, v72
    v_exp_f32 v73, v73
    v_exp_f32 v74, v74
    v_exp_f32 v75, v75
    s_add_u32 s49, s49, 28672
    s_add_u32 s50, s50, 28672
    buffer_load_dword v201, v216, s[8:11], s49 offen offset:0 sc1
    buffer_load_dword v205, v216, s[8:11], s49 offen offset:256 sc1
    buffer_load_dword v209, v216, s[8:11], s49 offen offset:512 sc1
    buffer_load_dword v213, v216, s[8:11], s50 offen offset:0 sc1
    v_smfmac_f32_32x32x32_bf16 v[80:95], v[188:191], v[56:63], v192
    v_exp_f32 v76, v76
    v_exp_f32 v77, v77
    v_exp_f32 v78, v78
    v_exp_f32 v79, v79
    v_mfma_f32_32x32x16_bf16 v[32:47], v[160:163], v[148:151], v[128:143]
    v_exp_f32 v16, v16
    v_exp_f32 v17, v17
    v_exp_f32 v18, v18
    v_exp_f32 v19, v19
    ds_read2st64_b64 v[164:167], v5 offset0:85 offset1:86
    v_mfma_f32_32x32x8bf16_1k v[32:47], v[170:171], v[156:157], v[32:47]
    v_exp_f32 v20, v20
    v_exp_f32 v21, v21
    v_exp_f32 v22, v22
    v_exp_f32 v23, v23
    ds_read2st64_b64 v[172:175], v15 offset0:94 offset1:99
    v_smfmac_f32_32x32x32_bf16 v[96:111], v[184:187], v[64:71], v192
    v_exp_f32 v24, v24
    v_exp_f32 v25, v25
    v_exp_f32 v26, v26
    v_exp_f32 v27, v27
    s_add_u32 s49, s49, 28672
    s_add_u32 s50, s50, 28672
    buffer_load_dword v202, v216, s[8:11], s49 offen offset:0 sc1
    buffer_load_dword v206, v216, s[8:11], s49 offen offset:256 sc1
    buffer_load_dword v210, v216, s[8:11], s49 offen offset:512 sc1
    buffer_load_dword v214, v216, s[8:11], s50 offen offset:0 sc1
    v_smfmac_f32_32x32x32_bf16 v[96:111], v[188:191], v[72:79], v192
    v_exp_f32 v28, v28
    v_exp_f32 v29, v29
    v_exp_f32 v30, v30
    v_exp_f32 v31, v31
    s_waitcnt lgkmcnt(0)
    v_mfma_f32_32x32x16_bf16 v[48:63], v[164:167], v[144:147], v[112:127]
    v_exp_f32 v32, v32
    v_exp_f32 v33, v33
    v_exp_f32 v34, v34
    v_exp_f32 v35, v35
    v_mfma_f32_32x32x8bf16_1k v[48:63], v[170:171], v[154:155], v[48:63]
    v_exp_f32 v36, v36
    v_exp_f32 v37, v37
    v_exp_f32 v38, v38
    v_exp_f32 v39, v39
    s_mov_b64 exec, s[30:31]
    ds_read_b128 v[184:187], v3 offset:14080
    ds_read_b128 v[188:191], v3 offset:14720
    s_mov_b64 exec, -1
    v_smfmac_f32_32x32x32_bf16 v[80:95], v[176:179], v[16:23], v192
    v_exp_f32 v40, v40
    v_exp_f32 v41, v41
    v_exp_f32 v42, v42
    v_exp_f32 v43, v43
    s_add_u32 s49, s49, 28672
    s_add_u32 s50, s50, 28672
    buffer_load_dword v203, v216, s[8:11], s49 offen offset:0 sc1
    buffer_load_dword v207, v216, s[8:11], s49 offen offset:256 sc1
    buffer_load_dword v211, v216, s[8:11], s49 offen offset:512 sc1
    buffer_load_dword v215, v216, s[8:11], s50 offen offset:0 sc1
    v_smfmac_f32_32x32x32_bf16 v[80:95], v[180:183], v[24:31], v192
    v_exp_f32 v44, v44
    v_exp_f32 v45, v45
    v_exp_f32 v46, v46
    v_exp_f32 v47, v47
    v_mfma_f32_32x32x16_bf16 v[64:79], v[164:167], v[148:151], v[128:143]
    v_exp_f32 v48, v48
    v_exp_f32 v49, v49
    v_exp_f32 v50, v50
    v_exp_f32 v51, v51
    ds_read2st64_b64 v[160:163], v2 offset0:90 offset1:91
    v_mfma_f32_32x32x8bf16_1k v[64:79], v[170:171], v[158:159], v[64:79]
    v_exp_f32 v52, v52
    v_exp_f32 v53, v53
    v_exp_f32 v54, v54
    v_exp_f32 v55, v55
    v_smfmac_f32_32x32x32_bf16 v[96:111], v[176:179], v[32:39], v192
    v_exp_f32 v56, v56
    v_exp_f32 v57, v57
    v_exp_f32 v58, v58
    v_exp_f32 v59, v59
    s_add_u32 m0, s59, 0
    s_add_u32 s62, s58, 0
    buffer_load_dwordx4 v4, s[8:11], s62 offen sc1 lds
    v_smfmac_f32_32x32x32_bf16 v[96:111], v[180:183], v[40:47], v192
    v_exp_f32 v60, v60
    v_exp_f32 v61, v61
    v_exp_f32 v62, v62
    v_exp_f32 v63, v63
    s_waitcnt lgkmcnt(0)
    v_mfma_f32_32x32x16_bf16 v[16:31], v[160:163], v[144:147], v[112:127]
    v_exp_f32 v64, v64
    v_exp_f32 v65, v65
    v_exp_f32 v66, v66
    v_exp_f32 v67, v67
    v_mfma_f32_32x32x8bf16_1k v[16:31], v[172:173], v[152:153], v[16:31]
    v_exp_f32 v68, v68
    v_exp_f32 v69, v69
    v_exp_f32 v70, v70
    v_exp_f32 v71, v71
    s_mov_b64 exec, s[30:31]
    ds_read_b128 v[176:179], v3 offset:15360
    ds_read_b128 v[180:183], v3 offset:16000
    s_mov_b64 exec, -1
    v_smfmac_f32_32x32x32_bf16 v[80:95], v[184:187], v[48:55], v192
    v_exp_f32 v72, v72
    v_exp_f32 v73, v73
    v_exp_f32 v74, v74
    v_exp_f32 v75, v75
    s_add_u32 m0, s59, 4096
    s_add_u32 s62, s58, 4096
    buffer_load_dwordx4 v4, s[8:11], s62 offen sc1 lds
    v_smfmac_f32_32x32x32_bf16 v[80:95], v[188:191], v[56:63], v192
    v_exp_f32 v76, v76
    v_exp_f32 v77, v77
    v_exp_f32 v78, v78
    v_exp_f32 v79, v79
    v_mfma_f32_32x32x16_bf16 v[32:47], v[160:163], v[148:151], v[128:143]
    v_exp_f32 v16, v16
    v_exp_f32 v17, v17
    v_exp_f32 v18, v18
    v_exp_f32 v19, v19
    ds_read2st64_b64 v[164:167], v5 offset0:90 offset1:91
    v_mfma_f32_32x32x8bf16_1k v[32:47], v[172:173], v[156:157], v[32:47]
    v_exp_f32 v20, v20
    v_exp_f32 v21, v21
    v_exp_f32 v22, v22
    v_exp_f32 v23, v23
    v_smfmac_f32_32x32x32_bf16 v[96:111], v[184:187], v[64:71], v192
    v_exp_f32 v24, v24
    v_exp_f32 v25, v25
    v_exp_f32 v26, v26
    v_exp_f32 v27, v27
    s_add_u32 m0, s59, 8192
    s_add_u32 s62, s58, 8192
    buffer_load_dwordx4 v4, s[8:11], s62 offen sc1 lds
    v_smfmac_f32_32x32x32_bf16 v[96:111], v[188:191], v[72:79], v192
    v_exp_f32 v28, v28
    v_exp_f32 v29, v29
    v_exp_f32 v30, v30
    v_exp_f32 v31, v31
    s_waitcnt lgkmcnt(0)
    v_mfma_f32_32x32x16_bf16 v[48:63], v[164:167], v[144:147], v[112:127]
    v_exp_f32 v32, v32
    v_exp_f32 v33, v33
    v_exp_f32 v34, v34
    v_exp_f32 v35, v35
    v_mfma_f32_32x32x8bf16_1k v[48:63], v[172:173], v[154:155], v[48:63]
    v_exp_f32 v36, v36
    v_exp_f32 v37, v37
    v_exp_f32 v38, v38
    v_exp_f32 v39, v39
    s_mov_b64 exec, s[30:31]
    ds_read_b128 v[184:187], v3 offset:16640
    ds_read_b128 v[188:191], v3 offset:17280
    s_mov_b64 exec, -1
    v_smfmac_f32_32x32x32_bf16 v[80:95], v[176:179], v[16:23], v192
    v_exp_f32 v40, v40
    v_exp_f32 v41, v41
    v_exp_f32 v42, v42
    v_exp_f32 v43, v43
    s_add_u32 m0, s59, 12288
    s_add_u32 s62, s58, 12288
    buffer_load_dwordx4 v4, s[8:11], s62 offen sc1 lds
    v_smfmac_f32_32x32x32_bf16 v[80:95], v[180:183], v[24:31], v192
    v_exp_f32 v44, v44
    v_exp_f32 v45, v45
    v_exp_f32 v46, v46
    v_exp_f32 v47, v47
    v_mfma_f32_32x32x16_bf16 v[64:79], v[164:167], v[148:151], v[128:143]
    v_exp_f32 v48, v48
    v_exp_f32 v49, v49
    v_exp_f32 v50, v50
    v_exp_f32 v51, v51
    ds_read2st64_b64 v[160:163], v2 offset0:95 offset1:96
    v_mfma_f32_32x32x8bf16_1k v[64:79], v[172:173], v[158:159], v[64:79]
    v_exp_f32 v52, v52
    v_exp_f32 v53, v53
    v_exp_f32 v54, v54
    v_exp_f32 v55, v55
    v_smfmac_f32_32x32x32_bf16 v[96:111], v[176:179], v[32:39], v192
    v_exp_f32 v56, v56
    v_exp_f32 v57, v57
    v_exp_f32 v58, v58
    v_exp_f32 v59, v59
    s_add_u32 m0, s59, 16384
    s_add_u32 s62, s58, 16384
    buffer_load_dwordx4 v4, s[8:11], s62 offen sc1 lds
    v_smfmac_f32_32x32x32_bf16 v[96:111], v[180:183], v[40:47], v192
    v_exp_f32 v60, v60
    v_exp_f32 v61, v61
    v_exp_f32 v62, v62
    v_exp_f32 v63, v63
    s_waitcnt lgkmcnt(0)
    v_mfma_f32_32x32x16_bf16 v[16:31], v[160:163], v[144:147], v[112:127]
    v_exp_f32 v64, v64
    v_exp_f32 v65, v65
    v_exp_f32 v66, v66
    v_exp_f32 v67, v67
    v_mfma_f32_32x32x8bf16_1k v[16:31], v[174:175], v[152:153], v[16:31]
    v_exp_f32 v68, v68
    v_exp_f32 v69, v69
    v_exp_f32 v70, v70
    v_exp_f32 v71, v71
    s_mov_b64 exec, s[30:31]
    ds_read_b128 v[176:179], v3 offset:17920
    ds_read_b128 v[180:183], v3 offset:18560
    s_mov_b64 exec, -1
    v_smfmac_f32_32x32x32_bf16 v[80:95], v[184:187], v[48:55], v192
    v_exp_f32 v72, v72
    v_exp_f32 v73, v73
    v_exp_f32 v74, v74
    v_exp_f32 v75, v75
    s_add_u32 m0, s59, 20480
    s_add_u32 s62, s58, 20480
    buffer_load_dwordx4 v4, s[8:11], s62 offen sc1 lds
    v_smfmac_f32_32x32x32_bf16 v[80:95], v[188:191], v[56:63], v192
    v_exp_f32 v76, v76
    v_exp_f32 v77, v77
    v_exp_f32 v78, v78
    v_exp_f32 v79, v79
    v_mfma_f32_32x32x16_bf16 v[32:47], v[160:163], v[148:151], v[128:143]
    v_exp_f32 v16, v16
    v_exp_f32 v17, v17
    v_exp_f32 v18, v18
    v_exp_f32 v19, v19
    ds_read2st64_b64 v[164:167], v5 offset0:95 offset1:96
    v_mfma_f32_32x32x8bf16_1k v[32:47], v[174:175], v[156:157], v[32:47]
    v_exp_f32 v20, v20
    v_exp_f32 v21, v21
    v_exp_f32 v22, v22
    v_exp_f32 v23, v23
    ds_read2st64_b64 v[168:171], v15 offset0:124 offset1:129
    v_smfmac_f32_32x32x32_bf16 v[96:111], v[184:187], v[64:71], v192
    v_exp_f32 v24, v24
    v_exp_f32 v25, v25
    v_exp_f32 v26, v26
    v_exp_f32 v27, v27
    s_add_u32 m0, s63, 24576
    s_add_u32 s62, s58, 24576
    buffer_load_dwordx4 v4, s[8:11], s62 offen sc1 lds
    v_smfmac_f32_32x32x32_bf16 v[96:111], v[188:191], v[72:79], v192
    v_exp_f32 v28, v28
    v_exp_f32 v29, v29
    v_exp_f32 v30, v30
    v_exp_f32 v31, v31
    s_waitcnt lgkmcnt(0)
    v_mfma_f32_32x32x16_bf16 v[48:63], v[164:167], v[144:147], v[112:127]
    v_exp_f32 v32, v32
    v_exp_f32 v33, v33
    v_exp_f32 v34, v34
    v_exp_f32 v35, v35
    v_mfma_f32_32x32x8bf16_1k v[48:63], v[174:175], v[154:155], v[48:63]
    v_exp_f32 v36, v36
    v_exp_f32 v37, v37
    v_exp_f32 v38, v38
    v_exp_f32 v39, v39
    s_mov_b64 exec, s[30:31]
    ds_read_b128 v[184:187], v3 offset:19200
    ds_read_b128 v[188:191], v3 offset:19840
    s_mov_b64 exec, -1
    v_smfmac_f32_32x32x32_bf16 v[80:95], v[176:179], v[16:23], v192
    v_exp_f32 v40, v40
    v_exp_f32 v41, v41
    v_exp_f32 v42, v42
    v_exp_f32 v43, v43
    s_add_u32 m0, s63, 28672
    s_add_u32 s62, s58, 28672
    buffer_load_dwordx4 v4, s[8:11], s62 offen sc1 lds
    v_smfmac_f32_32x32x32_bf16 v[80:95], v[180:183], v[24:31], v192
    v_exp_f32 v44, v44
    v_exp_f32 v45, v45
    v_exp_f32 v46, v46
    v_exp_f32 v47, v47
    v_mfma_f32_32x32x16_bf16 v[64:79], v[164:167], v[148:151], v[128:143]
    v_exp_f32 v48, v48
    v_exp_f32 v49, v49
    v_exp_f32 v50, v50
    v_exp_f32 v51, v51
    ds_read2st64_b64 v[160:163], v2 offset0:120 offset1:121
    v_mfma_f32_32x32x8bf16_1k v[64:79], v[174:175], v[158:159], v[64:79]
    v_exp_f32 v52, v52
    v_exp_f32 v53, v53
    v_exp_f32 v54, v54
    v_exp_f32 v55, v55
    v_smfmac_f32_32x32x32_bf16 v[96:111], v[176:179], v[32:39], v192
    v_exp_f32 v56, v56
    v_exp_f32 v57, v57
    v_exp_f32 v58, v58
    v_exp_f32 v59, v59
    s_add_u32 m0, s63, 32768
    s_add_u32 s62, s58, 32768
    buffer_load_dwordx4 v4, s[8:11], s62 offen sc1 lds
    v_smfmac_f32_32x32x32_bf16 v[96:111], v[180:183], v[40:47], v192
    v_exp_f32 v60, v60
    v_exp_f32 v61, v61
    v_exp_f32 v62, v62
    v_exp_f32 v63, v63
    s_waitcnt lgkmcnt(0)
    v_mfma_f32_32x32x16_bf16 v[16:31], v[160:163], v[144:147], v[112:127]
    v_exp_f32 v64, v64
    v_exp_f32 v65, v65
    v_exp_f32 v66, v66
    v_exp_f32 v67, v67
    v_mfma_f32_32x32x8bf16_1k v[16:31], v[168:169], v[152:153], v[16:31]
    v_exp_f32 v68, v68
    v_exp_f32 v69, v69
    v_exp_f32 v70, v70
    v_exp_f32 v71, v71
    s_mov_b64 exec, s[30:31]
    ds_read_b128 v[176:179], v3 offset:30720
    ds_read_b128 v[180:183], v3 offset:31360
    s_mov_b64 exec, -1
    v_smfmac_f32_32x32x32_bf16 v[80:95], v[184:187], v[48:55], v192
    v_exp_f32 v72, v72
    v_exp_f32 v73, v73
    v_exp_f32 v74, v74
    v_exp_f32 v75, v75
    s_add_u32 m0, s63, 36864
    s_add_u32 s62, s58, 36864
    buffer_load_dwordx4 v4, s[8:11], s62 offen sc1 lds
    v_smfmac_f32_32x32x32_bf16 v[80:95], v[188:191], v[56:63], v192
    v_exp_f32 v76, v76
    v_exp_f32 v77, v77
    v_exp_f32 v78, v78
    v_exp_f32 v79, v79
    v_mfma_f32_32x32x16_bf16 v[32:47], v[160:163], v[148:151], v[128:143]
    v_exp_f32 v16, v16
    v_exp_f32 v17, v17
    v_exp_f32 v18, v18
    v_exp_f32 v19, v19
    ds_read2st64_b64 v[164:167], v5 offset0:120 offset1:121
    v_mfma_f32_32x32x8bf16_1k v[32:47], v[168:169], v[156:157], v[32:47]
    v_exp_f32 v20, v20
    v_exp_f32 v21, v21
    v_exp_f32 v22, v22
    v_exp_f32 v23, v23
    v_smfmac_f32_32x32x32_bf16 v[96:111], v[184:187], v[64:71], v192
    v_exp_f32 v24, v24
    v_exp_f32 v25, v25
    v_exp_f32 v26, v26
    v_exp_f32 v27, v27
    s_and_b32 s60, s4, 1
    s_mul_i32 s60, s60, 2170880
    s_add_u32 s60, s60, 30408704
    s_lshl3_add_u32 s62, s5, s3
    s_mul_i32 s62, s62, 8832
    s_add_u32 s62, s62, s60
    v_lshlrev_b32 v218, 7, v0
    buffer_load_dword v219, v218, s[8:11], s62 offen sc1
    s_add_u32 s62, s62, 8192
    s_mov_b64 exec, 31
    buffer_load_dword v219, v218, s[8:11], s62 offen sc1
    s_mov_b64 exec, -1
    v_smfmac_f32_32x32x32_bf16 v[96:111], v[188:191], v[72:79], v192
    v_exp_f32 v28, v28
    v_exp_f32 v29, v29
    v_exp_f32 v30, v30
    v_exp_f32 v31, v31
    s_waitcnt lgkmcnt(0)
    v_mfma_f32_32x32x16_bf16 v[48:63], v[164:167], v[144:147], v[112:127]
    v_exp_f32 v32, v32
    v_exp_f32 v33, v33
    v_exp_f32 v34, v34
    v_exp_f32 v35, v35
    v_mfma_f32_32x32x8bf16_1k v[48:63], v[168:169], v[154:155], v[48:63]
    v_exp_f32 v36, v36
    v_exp_f32 v37, v37
    v_exp_f32 v38, v38
    v_exp_f32 v39, v39
    s_mov_b64 exec, s[30:31]
    ds_read_b128 v[184:187], v3 offset:32000
    ds_read_b128 v[188:191], v3 offset:32640
    s_mov_b64 exec, -1
    v_smfmac_f32_32x32x32_bf16 v[80:95], v[176:179], v[16:23], v192
    v_exp_f32 v40, v40
    v_exp_f32 v41, v41
    v_exp_f32 v42, v42
    v_exp_f32 v43, v43
    v_smfmac_f32_32x32x32_bf16 v[80:95], v[180:183], v[24:31], v192
    v_exp_f32 v44, v44
    v_exp_f32 v45, v45
    v_exp_f32 v46, v46
    v_exp_f32 v47, v47
    v_mfma_f32_32x32x16_bf16 v[64:79], v[164:167], v[148:151], v[128:143]
    v_exp_f32 v48, v48
    v_exp_f32 v49, v49
    v_exp_f32 v50, v50
    v_exp_f32 v51, v51
    ds_read2st64_b64 v[160:163], v2 offset0:125 offset1:126
    v_mfma_f32_32x32x8bf16_1k v[64:79], v[168:169], v[158:159], v[64:79]
    v_exp_f32 v52, v52
    v_exp_f32 v53, v53
    v_exp_f32 v54, v54
    v_exp_f32 v55, v55
    v_smfmac_f32_32x32x32_bf16 v[96:111], v[176:179], v[32:39], v192
    v_exp_f32 v56, v56
    v_exp_f32 v57, v57
    v_exp_f32 v58, v58
    v_exp_f32 v59, v59
    v_smfmac_f32_32x32x32_bf16 v[96:111], v[180:183], v[40:47], v192
    v_exp_f32 v60, v60
    v_exp_f32 v61, v61
    v_exp_f32 v62, v62
    v_exp_f32 v63, v63
    s_waitcnt lgkmcnt(0)
    v_mfma_f32_32x32x16_bf16 v[16:31], v[160:163], v[144:147], v[112:127]
    v_exp_f32 v64, v64
    v_exp_f32 v65, v65
    v_exp_f32 v66, v66
    v_exp_f32 v67, v67
    v_mfma_f32_32x32x8bf16_1k v[16:31], v[170:171], v[152:153], v[16:31]
    v_exp_f32 v68, v68
    v_exp_f32 v69, v69
    v_exp_f32 v70, v70
    v_exp_f32 v71, v71
    s_mov_b64 exec, s[30:31]
    ds_read_b128 v[176:179], v3 offset:33280
    ds_read_b128 v[180:183], v3 offset:33920
    s_mov_b64 exec, -1
    v_smfmac_f32_32x32x32_bf16 v[80:95], v[184:187], v[48:55], v192
    v_exp_f32 v72, v72
    v_exp_f32 v73, v73
    v_exp_f32 v74, v74
    v_exp_f32 v75, v75
    v_smfmac_f32_32x32x32_bf16 v[80:95], v[188:191], v[56:63], v192
    v_exp_f32 v76, v76
    v_exp_f32 v77, v77
    v_exp_f32 v78, v78
    v_exp_f32 v79, v79
    v_mfma_f32_32x32x16_bf16 v[32:47], v[160:163], v[148:151], v[128:143]
    v_exp_f32 v16, v16
    v_exp_f32 v17, v17
    v_exp_f32 v18, v18
    v_exp_f32 v19, v19
    ds_read2st64_b64 v[164:167], v5 offset0:125 offset1:126
    v_mfma_f32_32x32x8bf16_1k v[32:47], v[170:171], v[156:157], v[32:47]
    v_exp_f32 v20, v20
    v_exp_f32 v21, v21
    v_exp_f32 v22, v22
    v_exp_f32 v23, v23
    ds_read2st64_b64 v[172:175], v15 offset0:134 offset1:139
    v_smfmac_f32_32x32x32_bf16 v[96:111], v[184:187], v[64:71], v192
    v_exp_f32 v24, v24
    v_exp_f32 v25, v25
    v_exp_f32 v26, v26
    v_exp_f32 v27, v27
    s_cmp_lg_u32 s3, 5
    s_cbranch_scc1 pf_83
    s_getpc_b64 s[60:61]
pf_83pc:
    s_lshl_b32 s62, s5, 11
    v_add_u32 v218, s62, v193
    v_cmp_gt_u32 vcc, adaLN_cond__mha_block__glu_gated_glu__prompt_kernel_end2-pf_83pc, v218
    s_and_b32 exec_lo, vcc_lo, 0xffff
    s_mov_b32 exec_hi, 0
    s_cbranch_execz pf_83x
    global_load_dword v219, v218, s[60:61]
pf_83x:
    s_mov_b64 exec, -1
pf_83:
    v_smfmac_f32_32x32x32_bf16 v[96:111], v[188:191], v[72:79], v192
    v_exp_f32 v28, v28
    v_exp_f32 v29, v29
    v_exp_f32 v30, v30
    v_exp_f32 v31, v31
    s_waitcnt lgkmcnt(0)
    v_mfma_f32_32x32x16_bf16 v[48:63], v[164:167], v[144:147], v[112:127]
    v_exp_f32 v32, v32
    v_exp_f32 v33, v33
    v_exp_f32 v34, v34
    v_exp_f32 v35, v35
    v_mfma_f32_32x32x8bf16_1k v[48:63], v[170:171], v[154:155], v[48:63]
    v_exp_f32 v36, v36
    v_exp_f32 v37, v37
    v_exp_f32 v38, v38
    v_exp_f32 v39, v39
    s_mov_b64 exec, s[30:31]
    ds_read_b128 v[184:187], v3 offset:34560
    ds_read_b128 v[188:191], v3 offset:35200
    s_mov_b64 exec, -1
    v_smfmac_f32_32x32x32_bf16 v[80:95], v[176:179], v[16:23], v192
    v_exp_f32 v40, v40
    v_exp_f32 v41, v41
    v_exp_f32 v42, v42
    v_exp_f32 v43, v43
    v_smfmac_f32_32x32x32_bf16 v[80:95], v[180:183], v[24:31], v192
    v_exp_f32 v44, v44
    v_exp_f32 v45, v45
    v_exp_f32 v46, v46
    v_exp_f32 v47, v47
    v_mfma_f32_32x32x16_bf16 v[64:79], v[164:167], v[148:151], v[128:143]
    v_exp_f32 v48, v48
    v_exp_f32 v49, v49
    v_exp_f32 v50, v50
    v_exp_f32 v51, v51
    ds_read2st64_b64 v[160:163], v2 offset0:130 offset1:131
    v_mfma_f32_32x32x8bf16_1k v[64:79], v[170:171], v[158:159], v[64:79]
    v_exp_f32 v52, v52
    v_exp_f32 v53, v53
    v_exp_f32 v54, v54
    v_exp_f32 v55, v55
    v_smfmac_f32_32x32x32_bf16 v[96:111], v[176:179], v[32:39], v192
    v_exp_f32 v56, v56
    v_exp_f32 v57, v57
    v_exp_f32 v58, v58
    v_exp_f32 v59, v59
    v_smfmac_f32_32x32x32_bf16 v[96:111], v[180:183], v[40:47], v192
    v_exp_f32 v60, v60
    v_exp_f32 v61, v61
    v_exp_f32 v62, v62
    v_exp_f32 v63, v63
    s_waitcnt lgkmcnt(0)
    v_mfma_f32_32x32x16_bf16 v[16:31], v[160:163], v[144:147], v[112:127]
    v_exp_f32 v64, v64
    v_exp_f32 v65, v65
    v_exp_f32 v66, v66
    v_exp_f32 v67, v67
    v_mfma_f32_32x32x8bf16_1k v[16:31], v[172:173], v[152:153], v[16:31]
    v_exp_f32 v68, v68
    v_exp_f32 v69, v69
    v_exp_f32 v70, v70
    v_exp_f32 v71, v71
    s_mov_b64 exec, s[30:31]
    ds_read_b128 v[176:179], v3 offset:35840
    ds_read_b128 v[180:183], v3 offset:36480
    s_mov_b64 exec, -1
    v_smfmac_f32_32x32x32_bf16 v[80:95], v[184:187], v[48:55], v192
    v_exp_f32 v72, v72
    v_exp_f32 v73, v73
    v_exp_f32 v74, v74
    v_exp_f32 v75, v75
    v_smfmac_f32_32x32x32_bf16 v[80:95], v[188:191], v[56:63], v192
    v_exp_f32 v76, v76
    v_exp_f32 v77, v77
    v_exp_f32 v78, v78
    v_exp_f32 v79, v79
    v_mfma_f32_32x32x16_bf16 v[32:47], v[160:163], v[148:151], v[128:143]
    v_exp_f32 v16, v16
    v_exp_f32 v17, v17
    v_exp_f32 v18, v18
    v_exp_f32 v19, v19
    ds_read2st64_b64 v[164:167], v5 offset0:130 offset1:131
    v_mfma_f32_32x32x8bf16_1k v[32:47], v[172:173], v[156:157], v[32:47]
    v_exp_f32 v20, v20
    v_exp_f32 v21, v21
    v_exp_f32 v22, v22
    v_exp_f32 v23, v23
    v_smfmac_f32_32x32x32_bf16 v[96:111], v[184:187], v[64:71], v192
    v_exp_f32 v24, v24
    v_exp_f32 v25, v25
    v_exp_f32 v26, v26
    v_exp_f32 v27, v27
    v_smfmac_f32_32x32x32_bf16 v[96:111], v[188:191], v[72:79], v192
    v_exp_f32 v28, v28
    v_exp_f32 v29, v29
    v_exp_f32 v30, v30
    v_exp_f32 v31, v31
    s_waitcnt lgkmcnt(0)
    v_mfma_f32_32x32x16_bf16 v[48:63], v[164:167], v[144:147], v[112:127]
    v_exp_f32 v32, v32
    v_exp_f32 v33, v33
    v_exp_f32 v34, v34
    v_exp_f32 v35, v35
    v_mfma_f32_32x32x8bf16_1k v[48:63], v[172:173], v[154:155], v[48:63]
    v_exp_f32 v36, v36
    v_exp_f32 v37, v37
    v_exp_f32 v38, v38
    v_exp_f32 v39, v39
    s_mov_b64 exec, s[30:31]
    ds_read_b128 v[184:187], v3 offset:37120
    ds_read_b128 v[188:191], v3 offset:37760
    s_mov_b64 exec, -1
    v_smfmac_f32_32x32x32_bf16 v[80:95], v[176:179], v[16:23], v192
    v_exp_f32 v40, v40
    v_exp_f32 v41, v41
    v_exp_f32 v42, v42
    v_exp_f32 v43, v43
    v_smfmac_f32_32x32x32_bf16 v[80:95], v[180:183], v[24:31], v192
    v_exp_f32 v44, v44
    v_exp_f32 v45, v45
    v_exp_f32 v46, v46
    v_exp_f32 v47, v47
    v_mfma_f32_32x32x16_bf16 v[64:79], v[164:167], v[148:151], v[128:143]
    v_exp_f32 v48, v48
    v_exp_f32 v49, v49
    v_exp_f32 v50, v50
    v_exp_f32 v51, v51
    ds_read2st64_b64 v[160:163], v2 offset0:135 offset1:136
    v_mfma_f32_32x32x8bf16_1k v[64:79], v[172:173], v[158:159], v[64:79]
    v_exp_f32 v52, v52
    v_exp_f32 v53, v53
    v_exp_f32 v54, v54
    v_exp_f32 v55, v55
    v_smfmac_f32_32x32x32_bf16 v[96:111], v[176:179], v[32:39], v192
    v_exp_f32 v56, v56
    v_exp_f32 v57, v57
    v_exp_f32 v58, v58
    v_exp_f32 v59, v59
    v_smfmac_f32_32x32x32_bf16 v[96:111], v[180:183], v[40:47], v192
    v_exp_f32 v60, v60
    v_exp_f32 v61, v61
    v_exp_f32 v62, v62
    v_exp_f32 v63, v63
    s_waitcnt lgkmcnt(0)
    v_mfma_f32_32x32x16_bf16 v[16:31], v[160:163], v[144:147], v[112:127]
    v_exp_f32 v64, v64
    v_exp_f32 v65, v65
    v_exp_f32 v66, v66
    v_exp_f32 v67, v67
    v_mfma_f32_32x32x8bf16_1k v[16:31], v[174:175], v[152:153], v[16:31]
    v_exp_f32 v68, v68
    v_exp_f32 v69, v69
    v_exp_f32 v70, v70
    v_exp_f32 v71, v71
    s_mov_b64 exec, s[30:31]
    ds_read_b128 v[176:179], v3 offset:38400
    ds_read_b128 v[180:183], v3 offset:39040
    s_mov_b64 exec, -1
    v_smfmac_f32_32x32x32_bf16 v[80:95], v[184:187], v[48:55], v192
    v_exp_f32 v72, v72
    v_exp_f32 v73, v73
    v_exp_f32 v74, v74
    v_exp_f32 v75, v75
    v_smfmac_f32_32x32x32_bf16 v[80:95], v[188:191], v[56:63], v192
    v_exp_f32 v76, v76
    v_exp_f32 v77, v77
    v_exp_f32 v78, v78
    v_exp_f32 v79, v79
    s_barrier
    v_mfma_f32_32x32x16_bf16 v[32:47], v[160:163], v[148:151], v[128:143]
    v_exp_f32 v16, v16
    v_exp_f32 v17, v17
    v_exp_f32 v18, v18
    v_exp_f32 v19, v19
    ds_read2st64_b64 v[164:167], v5 offset0:135 offset1:136
    v_mfma_f32_32x32x8bf16_1k v[32:47], v[174:175], v[156:157], v[32:47]
    v_exp_f32 v20, v20
    v_exp_f32 v21, v21
    v_exp_f32 v22, v22
    v_exp_f32 v23, v23
    v_smfmac_f32_32x32x32_bf16 v[96:111], v[184:187], v[64:71], v192
    v_exp_f32 v24, v24
    v_exp_f32 v25, v25
    v_exp_f32 v26, v26
    v_exp_f32 v27, v27
    v_smfmac_f32_32x32x32_bf16 v[96:111], v[188:191], v[72:79], v192
    v_exp_f32 v28, v28
    v_exp_f32 v29, v29
    v_exp_f32 v30, v30
    v_exp_f32 v31, v31
    s_waitcnt lgkmcnt(0)
    v_mfma_f32_32x32x16_bf16 v[48:63], v[164:167], v[144:147], v[112:127]
    v_exp_f32 v32, v32
    v_exp_f32 v33, v33
    v_exp_f32 v34, v34
    v_exp_f32 v35, v35
    v_mfma_f32_32x32x8bf16_1k v[48:63], v[174:175], v[154:155], v[48:63]
    v_exp_f32 v36, v36
    v_exp_f32 v37, v37
    v_exp_f32 v38, v38
    v_exp_f32 v39, v39
    s_mov_b64 exec, s[30:31]
    ds_read_b128 v[184:187], v3 offset:39680
    ds_read_b128 v[188:191], v3 offset:40320
    s_mov_b64 exec, -1
    v_smfmac_f32_32x32x32_bf16 v[80:95], v[176:179], v[16:23], v192
    v_exp_f32 v40, v40
    v_exp_f32 v41, v41
    v_exp_f32 v42, v42
    v_exp_f32 v43, v43
    v_smfmac_f32_32x32x32_bf16 v[80:95], v[180:183], v[24:31], v192
    v_exp_f32 v44, v44
    v_exp_f32 v45, v45
    v_exp_f32 v46, v46
    v_exp_f32 v47, v47
    v_mfma_f32_32x32x16_bf16 v[64:79], v[164:167], v[148:151], v[128:143]
    v_exp_f32 v48, v48
    v_exp_f32 v49, v49
    v_exp_f32 v50, v50
    v_exp_f32 v51, v51
    v_mfma_f32_32x32x8bf16_1k v[64:79], v[174:175], v[158:159], v[64:79]
    v_exp_f32 v52, v52
    v_exp_f32 v53, v53
    v_exp_f32 v54, v54
    v_exp_f32 v55, v55
    v_smfmac_f32_32x32x32_bf16 v[96:111], v[176:179], v[32:39], v192
    v_exp_f32 v56, v56
    v_exp_f32 v57, v57
    v_exp_f32 v58, v58
    v_exp_f32 v59, v59
    v_smfmac_f32_32x32x32_bf16 v[96:111], v[180:183], v[40:47], v192
    v_exp_f32 v60, v60
    v_exp_f32 v61, v61
    v_exp_f32 v62, v62
    v_exp_f32 v63, v63
    s_waitcnt lgkmcnt(0)
    v_exp_f32 v64, v64
    v_exp_f32 v65, v65
    v_exp_f32 v66, v66
    v_exp_f32 v67, v67
    v_exp_f32 v68, v68
    v_exp_f32 v69, v69
    v_exp_f32 v70, v70
    v_exp_f32 v71, v71
    v_smfmac_f32_32x32x32_bf16 v[80:95], v[184:187], v[48:55], v192
    v_exp_f32 v72, v72
    v_exp_f32 v73, v73
    v_exp_f32 v74, v74
    v_exp_f32 v75, v75
    v_smfmac_f32_32x32x32_bf16 v[80:95], v[188:191], v[56:63], v192
    v_exp_f32 v76, v76
    v_exp_f32 v77, v77
    v_exp_f32 v78, v78
    v_exp_f32 v79, v79
    s_nop 0
    v_smfmac_f32_32x32x32_bf16 v[96:111], v[184:187], v[64:71], v192
    v_smfmac_f32_32x32x32_bf16 v[96:111], v[188:191], v[72:79], v192
    s_nop 4
    ds_write_b128 v233, v[80:83] offset:0
    ds_write_b128 v233, v[84:87] offset:1024
    ds_write_b128 v233, v[88:91] offset:2048
    v_maximum3_f32 v12, |v80|, |v81|, |v82|
    v_maximum3_f32 v12, |v83|, |v84|, v12
    v_maximum3_f32 v12, |v85|, |v86|, v12
    v_maximum3_f32 v12, |v87|, |v88|, v12
    v_maximum3_f32 v12, |v89|, |v90|, v12
    v_maximum3_f32 v12, |v91|, v12, v12
    v_maximum3_f32 v12, |v96|, |v97|, v12
    v_maximum3_f32 v12, |v98|, |v99|, v12
    v_maximum3_f32 v12, |v100|, |v101|, v12
    v_maximum3_f32 v12, |v102|, |v103|, v12
    v_maximum3_f32 v12, |v104|, |v105|, v12
    v_maximum3_f32 v12, |v106|, |v107|, v12
    v_cmp_ngt_f32 vcc, s34, v12
    s_cmp_lg_u64 vcc, 0
    s_cselect_b32 s35, 1, 0
    v_mov_b32 v13, s35
    ds_write_b32 v235, v13
    s_waitcnt lgkmcnt(0)
    s_barrier
    ds_read_b128 v[16:19], v234 offset:0
    ds_read_b128 v[20:23], v234 offset:1024
    ds_read_b128 v[24:27], v234 offset:2048
    ds_read_b32 v14, v236
    s_waitcnt lgkmcnt(0)
    v_cmp_ne_u32 vcc, 0, v14
    v_add_f32 v96, v96, v16
    v_add_f32 v97, v97, v17
    v_add_f32 v98, v98, v18
    v_add_f32 v99, v99, v19
    v_add_f32 v100, v100, v20
    v_add_f32 v101, v101, v21
    v_add_f32 v102, v102, v22
    v_add_f32 v103, v103, v23
    v_add_f32 v104, v104, v24
    v_add_f32 v105, v105, v25
    v_add_f32 v106, v106, v26
    v_add_f32 v107, v107, v27
    v_mov_b32 v12, v104
    v_mov_b32 v13, v104
    s_cmp_lg_u64 vcc, 0
    s_cselect_b32 s35, 1, 0
    s_andn2_b32 s35, s35, s28
    s_cmp_eq_u32 s35, 0
    s_cbranch_scc1 C_go_84
    s_mov_b32 s28, 1
    v_mov_b32 v221, 0x7f000000
    v_mov_b32 v222, 0x7f000000
    s_waitcnt vmcnt(0)
    s_barrier
    s_branch C_restart_77
Cspin_75:
    s_mov_b32 s61, 0
Chp_85:
    buffer_load_dword v217, v193, s[8:11], s57 offen sc1
    s_add_u32 s61, s61, 1
    s_cmp_gt_u32 s61, 262144
    s_waitcnt vmcnt(0)
    s_cbranch_scc1 Cret_76
    v_cmp_ne_u32 vcc, 1, v217
    s_cbranch_vccnz Chp_85
    s_branch Cret_76
C_exact_78:
    s_waitcnt lgkmcnt(0)
    s_barrier
    s_add_u32 m0, s41, 20480
    s_add_u32 s62, s42, 20480
    buffer_load_dwordx4 v4, s[8:11], s62 offen sc1 lds
    s_add_u32 m0, s41, 24576
    s_add_u32 s62, s42, 24576
    buffer_load_dwordx4 v4, s[8:11], s62 offen sc1 lds
    s_add_u32 m0, s41, 28672
    s_add_u32 s62, s42, 28672
    buffer_load_dwordx4 v4, s[8:11], s62 offen sc1 lds
    s_add_u32 m0, s41, 32768
    s_add_u32 s62, s42, 32768
    buffer_load_dwordx4 v4, s[8:11], s62 offen sc1 lds
    s_add_u32 m0, s41, 36864
    s_add_u32 s62, s42, 36864
    buffer_load_dwordx4 v4, s[8:11], s62 offen sc1 lds
    s_add_u32 m0, s41, 40960
    s_add_u32 s62, s42, 40960
    buffer_load_dwordx4 v4, s[8:11], s62 offen sc1 lds
    s_add_u32 m0, s41, 45056
    s_add_u32 s62, s42, 45056
    buffer_load_dwordx4 v4, s[8:11], s62 offen sc1 lds
    s_add_u32 m0, s41, 49152
    s_add_u32 s62, s42, 49152
    buffer_load_dwordx4 v4, s[8:11], s62 offen sc1 lds
    s_add_u32 m0, s41, 53248
    s_add_u32 s62, s42, 53248
    buffer_load_dwordx4 v4, s[8:11], s62 offen sc1 lds
    s_add_u32 m0, s41, 57344
    s_add_u32 s62, s42, 57344
    buffer_load_dwordx4 v4, s[8:11], s62 offen sc1 lds
    s_add_u32 m0, s41, 61440
    s_add_u32 s62, s42, 61440
    buffer_load_dwordx4 v4, s[8:11], s62 offen sc1 lds
    s_add_u32 m0, s41, 65536
    s_add_u32 s62, s42, 65536
    buffer_load_dwordx4 v4, s[8:11], s62 offen sc1 lds
    s_add_u32 m0, s41, 69632
    s_add_u32 s62, s42, 69632
    buffer_load_dwordx4 v4, s[8:11], s62 offen sc1 lds
    s_add_u32 m0, s41, 73728
    s_add_u32 s62, s42, 73728
    buffer_load_dwordx4 v4, s[8:11], s62 offen sc1 lds
    s_add_u32 m0, s41, 77824
    s_add_u32 s62, s42, 77824
    buffer_load_dwordx4 v4, s[8:11], s62 offen sc1 lds
    s_waitcnt vmcnt(0) lgkmcnt(0)
    s_barrier
    v_mov_b32 v6, 0xff800000
    v_mov_b32 v7, 0xff800000
    v_mov_b32 v2, v199
    v_add_u32 v5, 256, v199
    v_lshlrev_b32 v15, 3, v0
    s_mov_b32 s29, 8
C_xl_86:
    ds_read2st64_b64 v[160:163], v2 offset0:0 offset1:1
    ds_read2st64_b64 v[168:171], v15 offset0:4 offset1:9
    s_waitcnt lgkmcnt(0)
    v_mfma_f32_32x32x16_bf16 v[16:31], v[160:163], v[144:147], 0
    v_mfma_f32_32x32x16_bf16 v[32:47], v[160:163], v[148:151], 0
    v_mfma_f32_32x32x8bf16_1k v[16:31], v[168:169], v[152:153], v[16:31]
    v_mfma_f32_32x32x8bf16_1k v[32:47], v[168:169], v[156:157], v[32:47]
    s_nop 11
    v_max3_f32 v6, v6, v16, v17
    v_max3_f32 v6, v6, v18, v19
    v_max3_f32 v6, v6, v20, v21
    v_max3_f32 v6, v6, v22, v23
    v_max3_f32 v6, v6, v24, v25
    v_max3_f32 v6, v6, v26, v27
    v_max3_f32 v6, v6, v28, v29
    v_max3_f32 v6, v6, v30, v31
    v_max3_f32 v7, v7, v32, v33
    v_max3_f32 v7, v7, v34, v35
    v_max3_f32 v7, v7, v36, v37
    v_max3_f32 v7, v7, v38, v39
    v_max3_f32 v7, v7, v40, v41
    v_max3_f32 v7, v7, v42, v43
    v_max3_f32 v7, v7, v44, v45
    v_max3_f32 v7, v7, v46, v47
    ds_read2st64_b64 v[164:167], v5 offset0:0 offset1:1
    s_waitcnt lgkmcnt(0)
    v_mfma_f32_32x32x16_bf16 v[16:31], v[164:167], v[144:147], 0
    v_mfma_f32_32x32x16_bf16 v[32:47], v[164:167], v[148:151], 0
    v_mfma_f32_32x32x8bf16_1k v[16:31], v[168:169], v[154:155], v[16:31]
    v_mfma_f32_32x32x8bf16_1k v[32:47], v[168:169], v[158:159], v[32:47]
    s_nop 11
    v_max3_f32 v6, v6, v16, v17
    v_max3_f32 v6, v6, v18, v19
    v_max3_f32 v6, v6, v20, v21
    v_max3_f32 v6, v6, v22, v23
    v_max3_f32 v6, v6, v24, v25
    v_max3_f32 v6, v6, v26, v27
    v_max3_f32 v6, v6, v28, v29
    v_max3_f32 v6, v6, v30, v31
    v_max3_f32 v7, v7, v32, v33
    v_max3_f32 v7, v7, v34, v35
    v_max3_f32 v7, v7, v36, v37
    v_max3_f32 v7, v7, v38, v39
    v_max3_f32 v7, v7, v40, v41
    v_max3_f32 v7, v7, v42, v43
    v_max3_f32 v7, v7, v44, v45
    v_max3_f32 v7, v7, v46, v47
    ds_read2st64_b64 v[160:163], v2 offset0:5 offset1:6
    s_waitcnt lgkmcnt(0)
    v_mfma_f32_32x32x16_bf16 v[16:31], v[160:163], v[144:147], 0
    v_mfma_f32_32x32x16_bf16 v[32:47], v[160:163], v[148:151], 0
    v_mfma_f32_32x32x8bf16_1k v[16:31], v[170:171], v[152:153], v[16:31]
    v_mfma_f32_32x32x8bf16_1k v[32:47], v[170:171], v[156:157], v[32:47]
    s_nop 11
    v_max3_f32 v6, v6, v16, v17
    v_max3_f32 v6, v6, v18, v19
    v_max3_f32 v6, v6, v20, v21
    v_max3_f32 v6, v6, v22, v23
    v_max3_f32 v6, v6, v24, v25
    v_max3_f32 v6, v6, v26, v27
    v_max3_f32 v6, v6, v28, v29
    v_max3_f32 v6, v6, v30, v31
    v_max3_f32 v7, v7, v32, v33
    v_max3_f32 v7, v7, v34, v35
    v_max3_f32 v7, v7, v36, v37
    v_max3_f32 v7, v7, v38, v39
    v_max3_f32 v7, v7, v40, v41
    v_max3_f32 v7, v7, v42, v43
    v_max3_f32 v7, v7, v44, v45
    v_max3_f32 v7, v7, v46, v47
    ds_read2st64_b64 v[164:167], v5 offset0:5 offset1:6
    s_waitcnt lgkmcnt(0)
    v_mfma_f32_32x32x16_bf16 v[16:31], v[164:167], v[144:147], 0
    v_mfma_f32_32x32x16_bf16 v[32:47], v[164:167], v[148:151], 0
    v_mfma_f32_32x32x8bf16_1k v[16:31], v[170:171], v[154:155], v[16:31]
    v_mfma_f32_32x32x8bf16_1k v[32:47], v[170:171], v[158:159], v[32:47]
    s_nop 11
    v_max3_f32 v6, v6, v16, v17
    v_max3_f32 v6, v6, v18, v19
    v_max3_f32 v6, v6, v20, v21
    v_max3_f32 v6, v6, v22, v23
    v_max3_f32 v6, v6, v24, v25
    v_max3_f32 v6, v6, v26, v27
    v_max3_f32 v6, v6, v28, v29
    v_max3_f32 v6, v6, v30, v31
    v_max3_f32 v7, v7, v32, v33
    v_max3_f32 v7, v7, v34, v35
    v_max3_f32 v7, v7, v36, v37
    v_max3_f32 v7, v7, v38, v39
    v_max3_f32 v7, v7, v40, v41
    v_max3_f32 v7, v7, v42, v43
    v_max3_f32 v7, v7, v44, v45
    v_max3_f32 v7, v7, v46, v47
    ds_read2st64_b64 v[160:163], v2 offset0:10 offset1:11
    ds_read2st64_b64 v[172:175], v15 offset0:14 offset1:19
    s_waitcnt lgkmcnt(0)
    v_mfma_f32_32x32x16_bf16 v[16:31], v[160:163], v[144:147], 0
    v_mfma_f32_32x32x16_bf16 v[32:47], v[160:163], v[148:151], 0
    v_mfma_f32_32x32x8bf16_1k v[16:31], v[172:173], v[152:153], v[16:31]
    v_mfma_f32_32x32x8bf16_1k v[32:47], v[172:173], v[156:157], v[32:47]
    s_nop 11
    v_max3_f32 v6, v6, v16, v17
    v_max3_f32 v6, v6, v18, v19
    v_max3_f32 v6, v6, v20, v21
    v_max3_f32 v6, v6, v22, v23
    v_max3_f32 v6, v6, v24, v25
    v_max3_f32 v6, v6, v26, v27
    v_max3_f32 v6, v6, v28, v29
    v_max3_f32 v6, v6, v30, v31
    v_max3_f32 v7, v7, v32, v33
    v_max3_f32 v7, v7, v34, v35
    v_max3_f32 v7, v7, v36, v37
    v_max3_f32 v7, v7, v38, v39
    v_max3_f32 v7, v7, v40, v41
    v_max3_f32 v7, v7, v42, v43
    v_max3_f32 v7, v7, v44, v45
    v_max3_f32 v7, v7, v46, v47
    ds_read2st64_b64 v[164:167], v5 offset0:10 offset1:11
    s_waitcnt lgkmcnt(0)
    v_mfma_f32_32x32x16_bf16 v[16:31], v[164:167], v[144:147], 0
    v_mfma_f32_32x32x16_bf16 v[32:47], v[164:167], v[148:151], 0
    v_mfma_f32_32x32x8bf16_1k v[16:31], v[172:173], v[154:155], v[16:31]
    v_mfma_f32_32x32x8bf16_1k v[32:47], v[172:173], v[158:159], v[32:47]
    s_nop 11
    v_max3_f32 v6, v6, v16, v17
    v_max3_f32 v6, v6, v18, v19
    v_max3_f32 v6, v6, v20, v21
    v_max3_f32 v6, v6, v22, v23
    v_max3_f32 v6, v6, v24, v25
    v_max3_f32 v6, v6, v26, v27
    v_max3_f32 v6, v6, v28, v29
    v_max3_f32 v6, v6, v30, v31
    v_max3_f32 v7, v7, v32, v33
    v_max3_f32 v7, v7, v34, v35
    v_max3_f32 v7, v7, v36, v37
    v_max3_f32 v7, v7, v38, v39
    v_max3_f32 v7, v7, v40, v41
    v_max3_f32 v7, v7, v42, v43
    v_max3_f32 v7, v7, v44, v45
    v_max3_f32 v7, v7, v46, v47
    ds_read2st64_b64 v[160:163], v2 offset0:15 offset1:16
    s_waitcnt lgkmcnt(0)
    v_mfma_f32_32x32x16_bf16 v[16:31], v[160:163], v[144:147], 0
    v_mfma_f32_32x32x16_bf16 v[32:47], v[160:163], v[148:151], 0
    v_mfma_f32_32x32x8bf16_1k v[16:31], v[174:175], v[152:153], v[16:31]
    v_mfma_f32_32x32x8bf16_1k v[32:47], v[174:175], v[156:157], v[32:47]
    s_nop 11
    v_max3_f32 v6, v6, v16, v17
    v_max3_f32 v6, v6, v18, v19
    v_max3_f32 v6, v6, v20, v21
    v_max3_f32 v6, v6, v22, v23
    v_max3_f32 v6, v6, v24, v25
    v_max3_f32 v6, v6, v26, v27
    v_max3_f32 v6, v6, v28, v29
    v_max3_f32 v6, v6, v30, v31
    v_max3_f32 v7, v7, v32, v33
    v_max3_f32 v7, v7, v34, v35
    v_max3_f32 v7, v7, v36, v37
    v_max3_f32 v7, v7, v38, v39
    v_max3_f32 v7, v7, v40, v41
    v_max3_f32 v7, v7, v42, v43
    v_max3_f32 v7, v7, v44, v45
    v_max3_f32 v7, v7, v46, v47
    ds_read2st64_b64 v[164:167], v5 offset0:15 offset1:16
    s_waitcnt lgkmcnt(0)
    v_mfma_f32_32x32x16_bf16 v[16:31], v[164:167], v[144:147], 0
    v_mfma_f32_32x32x16_bf16 v[32:47], v[164:167], v[148:151], 0
    v_mfma_f32_32x32x8bf16_1k v[16:31], v[174:175], v[154:155], v[16:31]
    v_mfma_f32_32x32x8bf16_1k v[32:47], v[174:175], v[158:159], v[32:47]
    s_nop 11
    v_max3_f32 v6, v6, v16, v17
    v_max3_f32 v6, v6, v18, v19
    v_max3_f32 v6, v6, v20, v21
    v_max3_f32 v6, v6, v22, v23
    v_max3_f32 v6, v6, v24, v25
    v_max3_f32 v6, v6, v26, v27
    v_max3_f32 v6, v6, v28, v29
    v_max3_f32 v6, v6, v30, v31
    v_max3_f32 v7, v7, v32, v33
    v_max3_f32 v7, v7, v34, v35
    v_max3_f32 v7, v7, v36, v37
    v_max3_f32 v7, v7, v38, v39
    v_max3_f32 v7, v7, v40, v41
    v_max3_f32 v7, v7, v42, v43
    v_max3_f32 v7, v7, v44, v45
    v_max3_f32 v7, v7, v46, v47
    v_add_u32 v2, 20480, v2
    v_add_u32 v5, 20480, v5
    v_add_u32 v15, 20480, v15
    s_sub_u32 s29, s29, 1
    s_cmp_lg_u32 s29, 0
    s_cbranch_scc1 C_xl_86
    s_mul_i32 s33, s27, 81920
    v_add_u32 v2, s33, v199
    v_add_u32 v5, 256, v2
    v_lshl_add_u32 v15, v0, 3, s33
    ds_read2st64_b64 v[160:163], v2 offset0:0 offset1:1
    ds_read2st64_b64 v[168:171], v15 offset0:4 offset1:9
    s_mov_b32 s33, 0
    s_branch C_havem_79
C_go_84:
    v_permlane32_swap_b32 v12, v13
    v_rcp_f32 v13, v13
    s_nop 0
    v_mul_f32 v96, v96, v13
    v_mul_f32 v97, v97, v13
    v_mul_f32 v98, v98, v13
    v_mul_f32 v99, v99, v13
    v_mul_f32 v100, v100, v13
    v_mul_f32 v101, v101, v13
    v_mul_f32 v102, v102, v13
    v_mul_f32 v103, v103, v13
    v_mul_f32 v104, v104, v13
    v_mul_f32 v105, v105, v13
    v_mul_f32 v106, v106, v13
    v_mul_f32 v107, v107, v13
    v_cvt_pk_bf16_f32 v16, v96, v97
    v_cvt_pk_bf16_f32 v17, v98, v99
    v_cvt_pk_bf16_f32 v18, v100, v101
    v_cvt_pk_bf16_f32 v19, v102, v103
    v_cvt_pk_bf16_f32 v20, v104, v105
    v_cvt_pk_bf16_f32 v21, v106, v107
    buffer_store_dwordx4 v[16:19], v231, s[8:11], s37 offen sc1
    s_mov_b32 exec_hi, 0
    buffer_store_dwordx2 v[20:21], v232, s[8:11], s38 offen sc1
    s_mov_b64 exec, -1
    s_lshl_b32 s56, s25, 5
    s_add_u32 s56, s56, s24
    s_waitcnt vmcnt(0)
    s_barrier
    s_cmp_lg_u32 s3, 0
    s_cbranch_scc1 sig_87
    s_lshl_b32 s60, s56, 7
    s_add_u32 s60, s60, 98304
    v_lshlrev_b32 v254, 2, v0
    v_mov_b32 v255, 1
    s_mov_b32 exec_hi, 0
    buffer_store_dword v255, v254, s[8:11], s60 offen sc1
    s_mov_b64 exec, -1
sig_87:
    s_add_u32 m0, s63, 40960
    s_add_u32 s62, s58, 40960
    buffer_load_dwordx4 v4, s[8:11], s62 offen sc1 lds
    s_add_u32 m0, s63, 45056
    s_add_u32 s62, s58, 45056
    buffer_load_dwordx4 v4, s[8:11], s62 offen sc1 lds
    s_add_u32 m0, s63, 49152
    s_add_u32 s62, s58, 49152
    buffer_load_dwordx4 v4, s[8:11], s62 offen sc1 lds
    v_lshrrev_b32 v11, 4, v0
    s_lshl_b32 s48, s46, 7
    v_lshl_add_u32 v10, v11, 5, s48
    v_lshlrev_b32 v11, 4, v11
    s_mul_i32 s48, s44, 320
    s_add_u32 s48, s48, 311296
    buffer_load_dwordx4 v[228:231], v10, s[8:11], s48 offen offset:0 sc1
    buffer_load_dwordx4 v[232:235], v10, s[8:11], s48 offen offset:16 sc1
    buffer_load_dwordx4 v[236:239], v11, s[8:11], s48 offen offset:256 sc1
    s_add_u32 s48, s48, 5120
    buffer_load_dwordx4 v[240:243], v10, s[8:11], s48 offen offset:0 sc1
    buffer_load_dwordx4 v[244:247], v10, s[8:11], s48 offen offset:16 sc1
    buffer_load_dwordx4 v[54:57], v11, s[8:11], s48 offen offset:256 sc1
    v_lshlrev_b32 v4, 4, v0
    s_lshl_b32 s28, s4, 2
    s_add_u32 s28, s28, s43
    s_lshl2_add_u32 s28, s28, s45
    s_mul_i32 s36, s28, 20480
    s_mul_i32 s29, s46, 10240
    s_add_u32 s36, s36, s29
    s_add_u32 s36, s36, 12582912
    s_mul_i32 s34, s28, 20480
    s_mul_i32 s29, s44, 160
    s_add_u32 s34, s34, s29
    s_mul_i32 s35, s28, 20480
    s_mul_i32 s30, s44, 2560
    s_add_u32 s35, s35, s30
    s_add_u32 s35, s35, 15728640
    v_and_b32 v1, 15, v0
    v_lshrrev_b32 v10, 4, v0
    v_mul_u32_u24 v11, 1280, v1
    s_lshl_b32 s30, s46, 6
    v_lshl_add_u32 v5, v10, 4, v11
    v_add_u32 v5, s30, v5
    v_lshl_add_u32 v6, v10, 3, v11
    v_add_u32 v6, 128, v6
    v_lshlrev_b32 v11, 4, v1
    s_lshl_b32 s30, s46, 10
    v_add_u32 v7, s30, v4
    v_lshrrev_b32 v12, 1, v10
    v_lshl_add_u32 v8, v12, 8, v11
    v_and_b32 v12, 1, v10
    v_lshl_add_u32 v8, v12, 3, v8
    v_add_u32 v8, 2048, v8
    s_lshl_b32 s30, s45, 10
    s_sub_u32 s31, s59, s30
    v_add_u32 v2, s31, v4
    s_sub_u32 s31, s63, s30
    s_add_u32 s31, s31, 24576
    v_add_u32 v3, s31, v4
    v_add_u32 v14, 40960, v3
    s_mov_b32 s20, s64
    s_mov_b32 s21, s65
    s_mov_b32 s22, 0x280000
    s_mov_b32 s23, 0x20000
    buffer_load_dwordx4 v[248:251], v5, s[20:23], s34 offen
    buffer_load_dwordx2 v[252:253], v6, s[20:23], s34 offen
    v_add_f32 v200, v200, v201
    v_add_f32 v202, v202, v203
    v_add_f32 v200, v200, v202
    v_cvt_pk_bf16_f32 v120, v200, v200
    v_and_b32 v201, 0xffff0000, v120
    v_sub_f32 v200, v200, v201
    v_cvt_pk_bf16_f32 v121, v200, v200
    v_add_f32 v204, v204, v205
    v_add_f32 v206, v206, v207
    v_add_f32 v204, v204, v206
    v_cvt_pk_bf16_f32 v122, v204, v204
    v_and_b32 v205, 0xffff0000, v122
    v_sub_f32 v204, v204, v205
    v_cvt_pk_bf16_f32 v123, v204, v204
    v_add_f32 v208, v208, v209
    v_add_f32 v210, v210, v211
    v_add_f32 v208, v208, v210
    v_cvt_pk_bf16_f32 v124, v208, v208
    v_and_b32 v209, 0xffff0000, v124
    v_sub_f32 v208, v208, v209
    v_cvt_pk_bf16_f32 v125, v208, v208
    v_add_f32 v212, v212, v213
    v_add_f32 v214, v214, v215
    v_add_f32 v212, v212, v214
    v_cvt_pk_bf16_f32 v126, v212, v212
    v_and_b32 v213, 0xffff0000, v126
    v_sub_f32 v212, v212, v213
    v_cvt_pk_bf16_f32 v127, v212, v212
    v_and_b32 v1, 15, v0
    v_lshrrev_b32 v12, 4, v0
    v_lshlrev_b32 v12, 8, v12
    v_lshl_add_u32 v12, v1, 3, v12
    v_and_b32 v10, 31, v0
    v_lshlrev_b32 v10, 7, v10
    s_lshl_b32 s57, s4, 12
    s_add_u32 s57, s57, 98304
    s_waitcnt vmcnt(0)
    v_pk_add_f32 v[228:229], v[228:229], v[240:241]
    v_pk_add_f32 v[230:231], v[230:231], v[242:243]
    v_pk_add_f32 v[232:233], v[232:233], v[244:245]
    v_pk_add_f32 v[234:235], v[234:235], v[246:247]
    v_pk_add_f32 v[236:237], v[236:237], v[54:55]
    v_pk_add_f32 v[238:239], v[238:239], v[56:57]
    v_cvt_pk_bf16_f32 v1, v228, v229
    v_lshlrev_b32 v228, 16, v1
    v_and_b32 v229, 0xffff0000, v1
    v_cvt_pk_bf16_f32 v1, v230, v231
    v_lshlrev_b32 v230, 16, v1
    v_and_b32 v231, 0xffff0000, v1
    v_cvt_pk_bf16_f32 v1, v232, v233
    v_lshlrev_b32 v232, 16, v1
    v_and_b32 v233, 0xffff0000, v1
    v_cvt_pk_bf16_f32 v1, v234, v235
    v_lshlrev_b32 v234, 16, v1
    v_and_b32 v235, 0xffff0000, v1
    v_cvt_pk_bf16_f32 v1, v236, v237
    v_lshlrev_b32 v236, 16, v1
    v_and_b32 v237, 0xffff0000, v1
    v_cvt_pk_bf16_f32 v1, v238, v239
    v_lshlrev_b32 v238, 16, v1
    v_and_b32 v239, 0xffff0000, v1
    s_mul_i32 s28, s45, 3072
    s_add_u32 s28, s28, 135168
    s_mul_i32 s29, s46, 12288
    s_sub_u32 s30, 12288, s29
    s_add_u32 s29, s29, s28
    s_add_u32 s30, s30, s28
    v_add_u32 v16, s29, v4
    v_add_u32 v17, s30, v4
    v_lshlrev_b32 v18, 16, v248
    v_and_b32 v19, 0xffff0000, v248
    v_lshlrev_b32 v20, 16, v249
    v_and_b32 v21, 0xffff0000, v249
    v_lshlrev_b32 v22, 16, v250
    v_and_b32 v23, 0xffff0000, v250
    v_lshlrev_b32 v24, 16, v251
    v_and_b32 v25, 0xffff0000, v251
    v_lshlrev_b32 v26, 16, v252
    v_and_b32 v27, 0xffff0000, v252
    v_lshlrev_b32 v28, 16, v253
    v_and_b32 v29, 0xffff0000, v253
    v_and_b32 v1, 15, v0
    v_lshlrev_b32 v1, 3, v1
    v_bfe_u32 v15, v0, 4, 1
    v_lshl_add_u32 v15, v15, 2, v1
    s_lshl2_add_u32 s31, s4, s43
    s_lshl2_add_u32 s31, s31, s45
    s_lshl_b32 s31, s31, 7
    s_lshl1_add_u32 s29, s44, s46
    s_lshl_b32 s29, s29, 14
    s_add_u32 s31, s31, s29
    s_add_u32 s31, s31, 589824
    s_cmp_lg_u32 s46, 0
    s_cselect_b32 s30, 0, -1
    s_mov_b32 s6, 0x3f803f80
    s_cmp_lg_u32 s3, 0
    s_cbranch_scc1 polle_89
    s_mov_b32 s61, 0
poll_88:
    buffer_load_dword v11, v10, s[8:11], s57 offen sc1
    s_add_u32 s61, s61, 1
    s_cmp_gt_u32 s61, 262144
    s_waitcnt vmcnt(0)
    s_cbranch_scc1 polle_89
    v_cmp_ne_u32 vcc, 1, v11
    s_cbranch_vccnz poll_88
polle_89:
    s_barrier
    buffer_load_dwordx4 v[32:35], v4, s[8:11], s36 offen offset:0 sc1
    buffer_load_dwordx4 v[36:39], v4, s[8:11], s36 offen offset:1024 sc1
    buffer_load_dwordx4 v[40:43], v4, s[8:11], s36 offen offset:2048 sc1
    buffer_load_dwordx4 v[44:47], v4, s[8:11], s36 offen offset:3072 sc1
    s_add_u32 s36, s36, 4096
    buffer_load_dwordx4 v[48:51], v4, s[8:11], s36 offen offset:0 sc1
    buffer_load_dwordx4 v[52:55], v4, s[8:11], s36 offen offset:1024 sc1
    s_cmp_lg_u32 s46, 0
    s_cbranch_scc1 D_l_90
    buffer_load_dwordx4 v[56:59], v4, s[8:11], s36 offen offset:2048 sc1
    buffer_load_dwordx4 v[60:63], v4, s[8:11], s36 offen offset:3072 sc1
    s_add_u32 s36, s36, 4096
    buffer_load_dwordx4 v[64:67], v4, s[8:11], s36 offen offset:0 sc1
    buffer_load_dwordx4 v[68:71], v4, s[8:11], s36 offen offset:1024 sc1
    s_branch D_le_91
D_l_90:
    buffer_load_dwordx2 v[56:57], v12, s[8:11], s36 offen offset:2048 sc1
    buffer_load_dwordx2 v[58:59], v12, s[8:11], s36 offen offset:2176 sc1
    buffer_load_dwordx2 v[60:61], v12, s[8:11], s36 offen offset:3072 sc1
    buffer_load_dwordx2 v[62:63], v12, s[8:11], s36 offen offset:3200 sc1
    s_add_u32 s36, s36, 4096
    buffer_load_dwordx2 v[64:65], v12, s[8:11], s36 offen offset:0 sc1
    buffer_load_dwordx2 v[66:67], v12, s[8:11], s36 offen offset:128 sc1
    buffer_load_dwordx2 v[68:69], v12, s[8:11], s36 offen offset:1024 sc1
    buffer_load_dwordx2 v[70:71], v12, s[8:11], s36 offen offset:1152 sc1
D_le_91:
    v_mov_b32 v10, 0
    v_mov_b32 v11, 0
    ds_read_b128 v[160:163], v2 offset:0
    ds_read_b128 v[164:167], v2 offset:1024
    ds_read_b128 v[168:171], v2 offset:2048
    ds_read_b128 v[172:175], v2 offset:3072
    ds_read_b128 v[176:179], v2 offset:4096
    ds_read_b128 v[180:183], v2 offset:5120
    ds_read_b128 v[184:187], v2 offset:6144
    ds_read_b128 v[188:191], v2 offset:7168
    ds_read_b128 v[192:195], v2 offset:8192
    ds_read_b128 v[196:199], v2 offset:9216
    s_waitcnt vmcnt(9) lgkmcnt(9)
    v_mfma_f32_16x16x32_bf16 v[140:143], v[160:163], v[32:35], 0
    ds_read_b128 v[200:203], v2 offset:10240
    s_waitcnt lgkmcnt(9)
    v_mfma_f32_16x16x32_bf16 v[144:147], v[164:167], v[32:35], 0
    ds_read_b128 v[204:207], v2 offset:11264
    s_waitcnt lgkmcnt(9)
    v_mfma_f32_16x16x32_bf16 v[148:151], v[168:171], v[32:35], 0
    ds_read_b128 v[208:211], v2 offset:12288
    s_waitcnt lgkmcnt(9)
    v_mfma_f32_16x16x32_bf16 v[152:155], v[172:175], v[32:35], 0
    ds_read_b128 v[212:215], v2 offset:13312
    s_waitcnt lgkmcnt(9)
    v_mfma_f32_16x16x32_bf16 v[156:159], v[176:179], v[32:35], 0
    ds_read_b128 v[216:219], v2 offset:14336
    s_waitcnt vmcnt(8) lgkmcnt(9)
    v_mfma_f32_16x16x32_bf16 v[140:143], v[180:183], v[36:39], v[140:143]
    ds_read_b128 v[160:163], v2 offset:15360
    s_waitcnt lgkmcnt(9)
    v_mfma_f32_16x16x32_bf16 v[144:147], v[184:187], v[36:39], v[144:147]
    ds_read_b128 v[164:167], v2 offset:16384
    s_waitcnt lgkmcnt(9)
    v_mfma_f32_16x16x32_bf16 v[148:151], v[188:191], v[36:39], v[148:151]
    ds_read_b128 v[168:171], v2 offset:17408
    s_waitcnt lgkmcnt(9)
    v_mfma_f32_16x16x32_bf16 v[152:155], v[192:195], v[36:39], v[152:155]
    ds_read_b128 v[172:175], v2 offset:18432
    s_waitcnt lgkmcnt(9)
    v_mfma_f32_16x16x32_bf16 v[156:159], v[196:199], v[36:39], v[156:159]
    ds_read_b128 v[176:179], v2 offset:19456
    s_waitcnt vmcnt(7) lgkmcnt(9)
    v_mfma_f32_16x16x32_bf16 v[140:143], v[200:203], v[40:43], v[140:143]
    ds_read_b128 v[180:183], v2 offset:20480
    s_waitcnt lgkmcnt(9)
    v_mfma_f32_16x16x32_bf16 v[144:147], v[204:207], v[40:43], v[144:147]
    ds_read_b128 v[184:187], v2 offset:21504
    s_waitcnt lgkmcnt(9)
    v_mfma_f32_16x16x32_bf16 v[148:151], v[208:211], v[40:43], v[148:151]
    ds_read_b128 v[188:191], v2 offset:22528
    s_waitcnt lgkmcnt(9)
    v_mfma_f32_16x16x32_bf16 v[152:155], v[212:215], v[40:43], v[152:155]
    ds_read_b128 v[192:195], v2 offset:23552
    s_waitcnt lgkmcnt(9)
    v_mfma_f32_16x16x32_bf16 v[156:159], v[216:219], v[40:43], v[156:159]
    ds_read_b128 v[196:199], v3 offset:0
    s_waitcnt vmcnt(6) lgkmcnt(9)
    v_mfma_f32_16x16x32_bf16 v[140:143], v[160:163], v[44:47], v[140:143]
    ds_read_b128 v[200:203], v3 offset:1024
    s_waitcnt lgkmcnt(9)
    v_mfma_f32_16x16x32_bf16 v[144:147], v[164:167], v[44:47], v[144:147]
    ds_read_b128 v[204:207], v3 offset:2048
    s_waitcnt lgkmcnt(9)
    v_mfma_f32_16x16x32_bf16 v[148:151], v[168:171], v[44:47], v[148:151]
    ds_read_b128 v[208:211], v3 offset:3072
    s_waitcnt lgkmcnt(9)
    v_mfma_f32_16x16x32_bf16 v[152:155], v[172:175], v[44:47], v[152:155]
    ds_read_b128 v[212:215], v3 offset:4096
    s_waitcnt lgkmcnt(9)
    v_mfma_f32_16x16x32_bf16 v[156:159], v[176:179], v[44:47], v[156:159]
    ds_read_b128 v[216:219], v3 offset:5120
    s_waitcnt vmcnt(5) lgkmcnt(9)
    v_mfma_f32_16x16x32_bf16 v[140:143], v[180:183], v[48:51], v[140:143]
    ds_read_b128 v[160:163], v3 offset:6144
    s_waitcnt lgkmcnt(9)
    v_mfma_f32_16x16x32_bf16 v[144:147], v[184:187], v[48:51], v[144:147]
    ds_read_b128 v[164:167], v3 offset:7168
    s_waitcnt lgkmcnt(9)
    v_mfma_f32_16x16x32_bf16 v[148:151], v[188:191], v[48:51], v[148:151]
    ds_read_b128 v[168:171], v3 offset:8192
    s_waitcnt lgkmcnt(9)
    v_mfma_f32_16x16x32_bf16 v[152:155], v[192:195], v[48:51], v[152:155]
    ds_read_b128 v[172:175], v3 offset:9216
    s_waitcnt lgkmcnt(9)
    v_mfma_f32_16x16x32_bf16 v[156:159], v[196:199], v[48:51], v[156:159]
    ds_read_b128 v[176:179], v3 offset:10240
    s_waitcnt vmcnt(4) lgkmcnt(9)
    v_mfma_f32_16x16x32_bf16 v[140:143], v[200:203], v[52:55], v[140:143]
    ds_read_b128 v[180:183], v3 offset:11264
    s_waitcnt lgkmcnt(9)
    v_mfma_f32_16x16x32_bf16 v[144:147], v[204:207], v[52:55], v[144:147]
    ds_read_b128 v[184:187], v3 offset:12288
    s_waitcnt lgkmcnt(9)
    v_mfma_f32_16x16x32_bf16 v[148:151], v[208:211], v[52:55], v[148:151]
    ds_read_b128 v[188:191], v3 offset:13312
    s_waitcnt lgkmcnt(9)
    v_mfma_f32_16x16x32_bf16 v[152:155], v[212:215], v[52:55], v[152:155]
    ds_read_b128 v[192:195], v3 offset:14336
    s_waitcnt lgkmcnt(9)
    v_mfma_f32_16x16x32_bf16 v[156:159], v[216:219], v[52:55], v[156:159]
    ds_read_b128 v[196:199], v3 offset:15360
    s_waitcnt vmcnt(3) lgkmcnt(9)
    v_mfma_f32_16x16x32_bf16 v[140:143], v[160:163], v[56:59], v[140:143]
    ds_read_b128 v[200:203], v3 offset:16384
    s_waitcnt lgkmcnt(9)
    v_mfma_f32_16x16x32_bf16 v[144:147], v[164:167], v[56:59], v[144:147]
    ds_read_b128 v[204:207], v3 offset:17408
    s_waitcnt lgkmcnt(9)
    v_mfma_f32_16x16x32_bf16 v[148:151], v[168:171], v[56:59], v[148:151]
    ds_read_b128 v[208:211], v3 offset:18432
    s_waitcnt lgkmcnt(9)
    v_mfma_f32_16x16x32_bf16 v[152:155], v[172:175], v[56:59], v[152:155]
    ds_read_b128 v[212:215], v3 offset:19456
    s_waitcnt lgkmcnt(9)
    v_mfma_f32_16x16x32_bf16 v[156:159], v[176:179], v[56:59], v[156:159]
    ds_read_b128 v[216:219], v3 offset:20480
    s_waitcnt vmcnt(2) lgkmcnt(9)
    v_mfma_f32_16x16x32_bf16 v[140:143], v[180:183], v[60:63], v[140:143]
    ds_read_b128 v[160:163], v3 offset:21504
    s_waitcnt lgkmcnt(9)
    v_mfma_f32_16x16x32_bf16 v[144:147], v[184:187], v[60:63], v[144:147]
    ds_read_b128 v[164:167], v3 offset:22528
    s_waitcnt lgkmcnt(9)
    v_mfma_f32_16x16x32_bf16 v[148:151], v[188:191], v[60:63], v[148:151]
    ds_read_b128 v[168:171], v3 offset:23552
    s_waitcnt lgkmcnt(9)
    v_mfma_f32_16x16x32_bf16 v[152:155], v[192:195], v[60:63], v[152:155]
    ds_read_b128 v[172:175], v3 offset:24576
    s_waitcnt lgkmcnt(9)
    v_mfma_f32_16x16x32_bf16 v[156:159], v[196:199], v[60:63], v[156:159]
    ds_read_b128 v[176:179], v3 offset:25600
    s_waitcnt vmcnt(1) lgkmcnt(9)
    v_mfma_f32_16x16x32_bf16 v[140:143], v[200:203], v[64:67], v[140:143]
    s_waitcnt lgkmcnt(8)
    v_mfma_f32_16x16x32_bf16 v[144:147], v[204:207], v[64:67], v[144:147]
    s_waitcnt lgkmcnt(7)
    v_mfma_f32_16x16x32_bf16 v[148:151], v[208:211], v[64:67], v[148:151]
    s_waitcnt lgkmcnt(6)
    v_mfma_f32_16x16x32_bf16 v[152:155], v[212:215], v[64:67], v[152:155]
    s_waitcnt lgkmcnt(5)
    v_mfma_f32_16x16x32_bf16 v[156:159], v[216:219], v[64:67], v[156:159]
    s_waitcnt vmcnt(0) lgkmcnt(2)
    v_mfma_f32_16x16x32_bf16 v[148:151], v[168:171], v[68:71], v[148:151]
    s_waitcnt lgkmcnt(1)
    v_mfma_f32_16x16x32_bf16 v[152:155], v[172:175], v[68:71], v[152:155]
    s_waitcnt lgkmcnt(0)
    v_mfma_f32_16x16x32_bf16 v[156:159], v[176:179], v[68:71], v[156:159]
    v_mfma_f32_16x16x32_bf16 v[140:143], v[160:163], v[68:71], v[140:143]
    v_mfma_f32_16x16x32_bf16 v[144:147], v[164:167], v[68:71], v[144:147]
    s_nop 3
    ds_write_b128 v16, v[148:151] offset:0
    ds_write_b128 v16, v[152:155] offset:1024
    ds_write_b128 v16, v[156:159] offset:2048
    s_waitcnt lgkmcnt(0)
    s_barrier
    ds_read_b128 v[160:163], v17 offset:0
    ds_read_b128 v[164:167], v17 offset:1024
    ds_read_b128 v[168:171], v17 offset:2048
    v_fmac_f32 v18, v140, v228
    v_fmac_f32 v19, v141, v229
    v_fmac_f32 v20, v142, v230
    v_fmac_f32 v21, v143, v231
    v_fmac_f32 v22, v144, v232
    v_fmac_f32 v23, v145, v233
    v_fmac_f32 v24, v146, v234
    v_fmac_f32 v25, v147, v235
    v_fmac_f32 v26, v156, v236
    v_fmac_f32 v27, v157, v237
    v_fmac_f32 v28, v158, v238
    v_fmac_f32 v29, v159, v239
    s_waitcnt lgkmcnt(0)
    v_fmac_f32 v18, v160, v228
    v_fmac_f32 v19, v161, v229
    v_fmac_f32 v20, v162, v230
    v_fmac_f32 v21, v163, v231
    v_fmac_f32 v22, v164, v232
    v_fmac_f32 v23, v165, v233
    v_fmac_f32 v24, v166, v234
    v_fmac_f32 v25, v167, v235
    v_fmac_f32 v26, v168, v236
    v_fmac_f32 v27, v169, v237
    v_fmac_f32 v28, v170, v238
    v_fmac_f32 v29, v171, v239
    v_cvt_pk_bf16_f32 v248, v18, v19
    v_cvt_pk_bf16_f32 v249, v20, v21
    v_cvt_pk_bf16_f32 v250, v22, v23
    v_cvt_pk_bf16_f32 v251, v24, v25
    v_cvt_pk_bf16_f32 v252, v26, v27
    v_cvt_pk_bf16_f32 v253, v28, v29
    buffer_store_dwordx4 v[248:251], v7, s[8:11], s35 offen sc1
    s_cmp_lg_u32 s46, 0
    s_cbranch_scc1 DF_n4_92
    buffer_store_dwordx2 v[252:253], v8, s[8:11], s35 offen sc1
DF_n4_92:
    v_and_b32 v12, s30, v252
    v_and_b32 v13, s30, v253
    v_dot2c_f32_bf16 v10, s6, v248
    v_dot2c_f32_bf16 v11, v248, v248
    v_dot2c_f32_bf16 v10, s6, v249
    v_dot2c_f32_bf16 v11, v249, v249
    v_dot2c_f32_bf16 v10, s6, v250
    v_dot2c_f32_bf16 v11, v250, v250
    v_dot2c_f32_bf16 v10, s6, v251
    v_dot2c_f32_bf16 v11, v251, v251
    v_dot2c_f32_bf16 v10, s6, v12
    v_dot2c_f32_bf16 v11, v12, v12
    v_dot2c_f32_bf16 v10, s6, v13
    v_dot2c_f32_bf16 v11, v13, v13
    s_nop 2
    v_permlane16_swap_b32 v10, v11
    v_add_f32 v10, v10, v11
    v_mov_b32 v11, v10
    s_nop 1
    v_permlane32_swap_b32 v10, v11
    v_add_f32 v10, v10, v11
    s_mov_b32 exec_hi, 0
    buffer_store_dword v10, v15, s[8:11], s31 offen sc1
    s_mov_b64 exec, -1
    s_lshl2_add_u32 s56, s4, s43
    s_lshl3_add_u32 s56, s56, s44
    s_lshr_b32 s28, s4, 1
    s_and_b32 s29, s5, 3
    s_lshl2_add_u32 s24, s28, s29
    s_and_b32 s28, s4, 1
    s_lshr_b32 s29, s5, 2
    s_lshl3_add_u32 s39, s28, s29
    s_mul_i32 s28, s39, 441370
    s_lshr_b32 s25, s28, 16
    s_and_b32 s26, s3, 3
    s_lshr_b32 s27, s3, 2
    s_lshr_b32 s33, s3, 1
    s_add_u32 s29, s25, s33
    s_mul_i32 s32, s29, 40960
    s_and_b32 s28, s3, 1
    s_lshl_b32 s28, s28, 10
    s_add_u32 s32, s32, s28
    s_add_u32 s32, s32, 30408704
    s_lshl_b32 s35, s3, 10
    v_lshlrev_b32 v2, 4, v0
    s_lshl3_add_u32 s28, s24, s3
    s_mul_i32 s34, s28, 20480
    s_add_u32 s34, s34, 15728640
    s_lshl2_add_u32 s28, s24, s26
    s_lshl_b32 s37, s28, 8
    s_add_u32 s37, s37, 589824
    s_mul_i32 s36, s28, 110592
    s_lshl2_add_u32 s29, s27, s25
    s_lshl_b32 s30, s29, 9
    s_add_u32 s36, s36, s30
    s_add_u32 s36, s36, 18874368
    s_lshl_b32 s29, s27, 13
    v_add_u32 v3, s29, v2
    v_add_u32 v4, 57344, v3
    s_add_u32 s29, s27, 6
    s_lshl_b32 s29, s29, 10
    v_add_u32 v48, s29, v2
    v_add_u32 v49, 57344, v48
    s_lshl1_add_u32 s29, s26, s27
    s_lshl_b32 s29, s29, 10
    s_add_u32 s29, s29, 114688
    v_add_u32 v5, s29, v2
    v_xor_b32 v50, 1024, v5
    s_add_u32 s29, s35, 131072
    v_add_u32 v51, s29, v2
    v_xor_b32 v52, 4096, v51
    v_and_b32 v1, 15, v0
    v_lshrrev_b32 v12, 5, v0
    v_lshlrev_b32 v12, 8, v12
    v_lshl_add_u32 v12, v1, 4, v12
    v_bfe_u32 v11, v0, 4, 1
    v_lshl_add_u32 v53, v11, 3, v12
    s_mul_i32 s29, s27, 53248
    s_add_u32 s29, s29, 1536
    v_add_u32 v53, s29, v53
    v_xor_b32 v11, s27, v11
    v_mul_u32_u24 v11, 55296, v11
    v_add_u32 v6, v12, v11
    v_lshrrev_b32 v12, 4, v0
    v_lshlrev_b32 v12, 16, v12
    v_lshl_add_u32 v12, v1, 3, v12
    s_lshl_b32 s29, s27, 7
    s_add_u32 s31, s37, 128
    s_sub_u32 s31, s31, s29
    s_add_u32 s37, s37, s29
    s_add_u32 m0, s35, 0
    s_add_u32 s33, s33, 4
    buffer_load_dwordx4 v2, s[8:11], s32 offen sc1 lds
    s_cmp_ge_u32 s33, 7
    s_cselect_b32 s28, 0xfffba800, 0
    s_cselect_b32 s29, 7, 0
    s_sub_u32 s33, s33, s29
    s_add_u32 s32, s32, s28
    s_add_u32 s32, s32, 163840
    s_add_u32 m0, s35, 8192
    s_add_u32 s33, s33, 4
    buffer_load_dwordx4 v2, s[8:11], s32 offen sc1 lds
    s_cmp_ge_u32 s33, 7
    s_cselect_b32 s28, 0xfffba800, 0
    s_cselect_b32 s29, 7, 0
    s_sub_u32 s33, s33, s29
    s_add_u32 s32, s32, s28
    s_add_u32 s32, s32, 163840
    s_add_u32 m0, s35, 16384
    s_add_u32 s33, s33, 4
    buffer_load_dwordx4 v2, s[8:11], s32 offen sc1 lds
    s_cmp_ge_u32 s33, 7
    s_cselect_b32 s28, 0xfffba800, 0
    s_cselect_b32 s29, 7, 0
    s_sub_u32 s33, s33, s29
    s_add_u32 s32, s32, s28
    s_add_u32 s32, s32, 163840
    s_add_u32 m0, s35, 24576
    s_add_u32 s33, s33, 4
    buffer_load_dwordx4 v2, s[8:11], s32 offen sc1 lds
    s_cmp_ge_u32 s33, 7
    s_cselect_b32 s28, 0xfffba800, 0
    s_cselect_b32 s29, 7, 0
    s_sub_u32 s33, s33, s29
    s_add_u32 s32, s32, s28
    s_add_u32 s32, s32, 163840
    s_waitcnt vmcnt(4)
    s_barrier
    s_cmp_lg_u32 s3, 0
    s_cbranch_scc1 sig_93
    s_lshl_b32 s60, s56, 7
    s_add_u32 s60, s60, 131072
    v_lshlrev_b32 v254, 2, v0
    v_mov_b32 v255, 1
    s_mov_b32 exec_hi, 0
    buffer_store_dword v255, v254, s[8:11], s60 offen sc1
    s_mov_b64 exec, -1
sig_93:
    s_add_u32 m0, s35, 32768
    s_add_u32 s33, s33, 4
    buffer_load_dwordx4 v2, s[8:11], s32 offen sc1 lds
    s_cmp_ge_u32 s33, 7
    s_cselect_b32 s28, 0xfffba800, 0
    s_cselect_b32 s29, 7, 0
    s_sub_u32 s33, s33, s29
    s_add_u32 s32, s32, s28
    s_add_u32 s32, s32, 163840
    s_add_u32 m0, s35, 40960
    s_add_u32 s33, s33, 4
    buffer_load_dwordx4 v2, s[8:11], s32 offen sc1 lds
    s_cmp_ge_u32 s33, 7
    s_cselect_b32 s28, 0xfffba800, 0
    s_cselect_b32 s29, 7, 0
    s_sub_u32 s33, s33, s29
    s_add_u32 s32, s32, s28
    s_add_u32 s32, s32, 163840
    s_add_u32 m0, s35, 49152
    s_add_u32 s33, s33, 4
    buffer_load_dwordx4 v2, s[8:11], s32 offen sc1 lds
    s_cmp_ge_u32 s33, 7
    s_cselect_b32 s28, 0xfffba800, 0
    s_cselect_b32 s29, 7, 0
    s_sub_u32 s33, s33, s29
    s_add_u32 s32, s32, s28
    s_add_u32 s32, s32, 163840
    s_add_u32 m0, s35, 57344
    s_add_u32 s33, s33, 4
    buffer_load_dwordx4 v2, s[8:11], s32 offen sc1 lds
    s_cmp_ge_u32 s33, 7
    s_cselect_b32 s28, 0xfffba800, 0
    s_cselect_b32 s29, 7, 0
    s_sub_u32 s33, s33, s29
    s_add_u32 s32, s32, s28
    s_add_u32 s32, s32, 163840
    s_add_u32 m0, s35, 65536
    s_add_u32 s33, s33, 4
    buffer_load_dwordx4 v2, s[8:11], s32 offen sc1 lds
    s_cmp_ge_u32 s33, 7
    s_cselect_b32 s28, 0xfffba800, 0
    s_cselect_b32 s29, 7, 0
    s_sub_u32 s33, s33, s29
    s_add_u32 s32, s32, s28
    s_add_u32 s32, s32, 163840
    s_add_u32 m0, s35, 73728
    s_add_u32 s33, s33, 4
    buffer_load_dwordx4 v2, s[8:11], s32 offen sc1 lds
    s_cmp_ge_u32 s33, 7
    s_cselect_b32 s28, 0xfffba800, 0
    s_cselect_b32 s29, 7, 0
    s_sub_u32 s33, s33, s29
    s_add_u32 s32, s32, s28
    s_add_u32 s32, s32, 163840
    s_add_u32 m0, s35, 81920
    s_add_u32 s33, s33, 4
    buffer_load_dwordx4 v2, s[8:11], s32 offen sc1 lds
    s_cmp_ge_u32 s33, 7
    s_cselect_b32 s28, 0xfffba800, 0
    s_cselect_b32 s29, 7, 0
    s_sub_u32 s33, s33, s29
    s_add_u32 s32, s32, s28
    s_add_u32 s32, s32, 163840
    s_add_u32 m0, s35, 90112
    s_add_u32 s33, s33, 4
    buffer_load_dwordx4 v2, s[8:11], s32 offen sc1 lds
    s_cmp_ge_u32 s33, 7
    s_cselect_b32 s28, 0xfffba800, 0
    s_cselect_b32 s29, 7, 0
    s_sub_u32 s33, s33, s29
    s_add_u32 s32, s32, s28
    s_add_u32 s32, s32, 163840
    s_add_u32 m0, s35, 98304
    s_add_u32 s33, s33, 4
    buffer_load_dwordx4 v2, s[8:11], s32 offen sc1 lds
    s_cmp_ge_u32 s33, 7
    s_cselect_b32 s28, 0xfffba800, 0
    s_cselect_b32 s29, 7, 0
    s_sub_u32 s33, s33, s29
    s_add_u32 s32, s32, s28
    s_add_u32 s32, s32, 163840
    s_add_u32 m0, s35, 106496
    s_add_u32 s33, s33, 4
    buffer_load_dwordx4 v2, s[8:11], s32 offen sc1 lds
    s_cmp_ge_u32 s33, 7
    s_cselect_b32 s28, 0xfffba800, 0
    s_cselect_b32 s29, 7, 0
    s_sub_u32 s33, s33, s29
    s_add_u32 s32, s32, s28
    s_add_u32 s32, s32, 163840
    v_and_b32 v14, 15, v0
    v_lshlrev_b32 v14, 7, v14
    s_lshl_b32 s57, s24, 11
    s_add_u32 s57, s57, 131072
    s_cmp_lg_u32 s3, 0
    s_cbranch_scc1 polle_95
    s_mov_b32 s61, 0
poll_94:
    buffer_load_dword v13, v14, s[8:11], s57 offen sc1
    s_add_u32 s61, s61, 1
    s_cmp_gt_u32 s61, 262144
    s_waitcnt vmcnt(0)
    s_cbranch_scc1 polle_95
    v_cmp_ne_u32 vcc, 1, v13
    s_cbranch_vccnz poll_94
polle_95:
    s_barrier
    s_add_u32 m0, s35, 114688
    s_add_u32 s28, s34, 0
    buffer_load_dwordx4 v2, s[8:11], s28 offen sc1 lds
    s_add_u32 m0, s35, 122880
    s_add_u32 s28, s34, 1024
    buffer_load_dwordx4 v2, s[8:11], s28 offen sc1 lds
    s_barrier
    s_add_u32 m0, s35, 131072
    s_add_u32 s28, s34, 2048
    buffer_load_dwordx4 v2, s[8:11], s28 offen sc1 lds
    s_add_u32 m0, s35, 139264
    s_add_u32 s28, s34, 3072
    buffer_load_dwordx4 v2, s[8:11], s28 offen sc1 lds
    s_lshl4_add_u32 s56, s24, s39
    s_and_b32 s43, s5, 3
    s_lshr_b32 s44, s5, 2
    s_and_b32 s45, s3, 3
    s_lshr_b32 s46, s3, 2
    s_lshl1_add_u32 s47, s44, s46
    s_mul_i32 s58, s47, 138240
    s_lshl_b32 s47, s45, 10
    s_add_u32 s58, s58, s47
    s_add_u32 s58, s58, 27262976
    s_mul_i32 s63, s46, 106496
    s_sub_u32 s63, s63, 24576
    s_add_u32 s63, s63, s47
    s_mul_i32 s59, s46, 24576
    s_add_u32 s59, s59, 57344
    s_add_u32 s59, s59, s47
    v_lshrrev_b32 v59, 4, v0
    s_lshl_b32 s48, s46, 7
    v_lshl_add_u32 v58, v59, 5, s48
    v_lshlrev_b32 v59, 4, v59
    s_mul_i32 s48, s44, 320
    s_add_u32 s48, s48, 313856
    s_waitcnt vmcnt(2)
    s_barrier
    ds_read_b128 v[128:131], v5 offset:0
    ds_read_b128 v[132:135], v50 offset:0
    ds_read_b128 v[144:147], v3 offset:0
    ds_read_b128 v[148:151], v3 offset:1024
    ds_read_b128 v[152:155], v3 offset:2048
    ds_read_b128 v[156:159], v3 offset:3072
    ds_read_b128 v[160:163], v3 offset:4096
    ds_read_b128 v[164:167], v3 offset:5120
    ds_read_b128 v[168:171], v48 offset:0
    s_waitcnt lgkmcnt(6)
    v_mfma_f32_16x16x32_bf16 v[64:67], v[144:147], v[128:131], 0
    ds_read_b128 v[136:139], v5 offset:8192
    v_mfma_f32_16x16x32_bf16 v[68:71], v[144:147], v[132:135], 0
    ds_read_b128 v[140:143], v50 offset:8192
    s_waitcnt lgkmcnt(7)
    v_mfma_f32_16x16x32_bf16 v[72:75], v[148:151], v[128:131], 0
    ds_read_b128 v[176:179], v3 offset:14336
    v_mfma_f32_16x16x32_bf16 v[76:79], v[148:151], v[132:135], 0
    ds_read_b128 v[180:183], v3 offset:15360
    s_add_u32 m0, s35, 147456
    s_add_u32 s28, s34, 4096
    buffer_load_dwordx4 v2, s[8:11], s28 offen sc1 lds
    s_waitcnt lgkmcnt(8)
    v_mfma_f32_16x16x32_bf16 v[80:83], v[152:155], v[128:131], 0
    ds_read_b128 v[184:187], v3 offset:16384
    v_mfma_f32_16x16x32_bf16 v[84:87], v[152:155], v[132:135], 0
    ds_read_b128 v[188:191], v3 offset:17408
    s_waitcnt lgkmcnt(9)
    v_mfma_f32_16x16x32_bf16 v[88:91], v[156:159], v[128:131], 0
    ds_read_b128 v[192:195], v3 offset:18432
    v_mfma_f32_16x16x32_bf16 v[92:95], v[156:159], v[132:135], 0
    ds_read_b128 v[196:199], v3 offset:19456
    s_add_u32 m0, s35, 155648
    s_add_u32 s28, s34, 5120
    buffer_load_dwordx4 v2, s[8:11], s28 offen sc1 lds
    s_waitcnt lgkmcnt(10)
    v_mfma_f32_16x16x32_bf16 v[96:99], v[160:163], v[128:131], 0
    ds_read_b128 v[200:203], v48 offset:14336
    v_mfma_f32_16x16x32_bf16 v[100:103], v[160:163], v[132:135], 0
    s_add_u32 s28, s37, 0
    buffer_load_dwordx2 v[32:33], v12, s[8:11], s28 offen sc1
    s_waitcnt lgkmcnt(10)
    v_mfma_f32_16x16x32_bf16 v[104:107], v[164:167], v[128:131], 0
    v_mfma_f32_16x16x32_bf16 v[108:111], v[164:167], v[132:135], 0
    s_add_u32 s28, s37, 16384
    buffer_load_dwordx2 v[34:35], v12, s[8:11], s28 offen sc1
    s_waitcnt lgkmcnt(9)
    v_mfma_f32_16x16x32_bf16 v[112:115], v[168:171], v[128:131], 0
    v_mfma_f32_16x16x32_bf16 v[116:119], v[168:171], v[132:135], 0
    s_waitcnt lgkmcnt(0)
    v_mfma_f32_16x16x32_bf16 v[64:67], v[176:179], v[136:139], v[64:67]
    s_waitcnt vmcnt(4)
    s_barrier
    ds_read_b128 v[128:131], v5 offset:16384
    v_mfma_f32_16x16x32_bf16 v[68:71], v[176:179], v[140:143], v[68:71]
    ds_read_b128 v[132:135], v50 offset:16384
    v_mfma_f32_16x16x32_bf16 v[72:75], v[180:183], v[136:139], v[72:75]
    ds_read_b128 v[144:147], v3 offset:28672
    v_mfma_f32_16x16x32_bf16 v[76:79], v[180:183], v[140:143], v[76:79]
    ds_read_b128 v[148:151], v3 offset:29696
    s_add_u32 m0, s35, 114688
    s_add_u32 s28, s34, 6144
    buffer_load_dwordx4 v2, s[8:11], s28 offen sc1 lds
    v_mfma_f32_16x16x32_bf16 v[80:83], v[184:187], v[136:139], v[80:83]
    ds_read_b128 v[152:155], v3 offset:30720
    v_mfma_f32_16x16x32_bf16 v[84:87], v[184:187], v[140:143], v[84:87]
    ds_read_b128 v[156:159], v3 offset:31744
    v_mfma_f32_16x16x32_bf16 v[88:91], v[188:191], v[136:139], v[88:91]
    ds_read_b128 v[160:163], v3 offset:32768
    v_mfma_f32_16x16x32_bf16 v[92:95], v[188:191], v[140:143], v[92:95]
    ds_read_b128 v[164:167], v3 offset:33792
    s_add_u32 m0, s35, 122880
    s_add_u32 s28, s34, 7168
    buffer_load_dwordx4 v2, s[8:11], s28 offen sc1 lds
    v_mfma_f32_16x16x32_bf16 v[96:99], v[192:195], v[136:139], v[96:99]
    ds_read_b128 v[168:171], v48 offset:28672
    v_mfma_f32_16x16x32_bf16 v[100:103], v[192:195], v[140:143], v[100:103]
    s_add_u32 m0, s35, 0
    s_add_u32 s33, s33, 4
    buffer_load_dwordx4 v2, s[8:11], s32 offen sc1 lds
    s_cmp_ge_u32 s33, 7
    s_cselect_b32 s28, 0xfffba800, 0
    s_cselect_b32 s29, 7, 0
    s_sub_u32 s33, s33, s29
    s_add_u32 s32, s32, s28
    s_add_u32 s32, s32, 163840
    v_mfma_f32_16x16x32_bf16 v[104:107], v[196:199], v[136:139], v[104:107]
    v_mfma_f32_16x16x32_bf16 v[108:111], v[196:199], v[140:143], v[108:111]
    v_mfma_f32_16x16x32_bf16 v[112:115], v[200:203], v[136:139], v[112:115]
    v_mfma_f32_16x16x32_bf16 v[116:119], v[200:203], v[140:143], v[116:119]
    s_waitcnt lgkmcnt(6)
    v_mfma_f32_16x16x32_bf16 v[64:67], v[144:147], v[128:131], v[64:67]
    ds_read_b128 v[136:139], v5 offset:24576
    v_mfma_f32_16x16x32_bf16 v[68:71], v[144:147], v[132:135], v[68:71]
    ds_read_b128 v[140:143], v50 offset:24576
    s_waitcnt lgkmcnt(7)
    v_mfma_f32_16x16x32_bf16 v[72:75], v[148:151], v[128:131], v[72:75]
    ds_read_b128 v[176:179], v3 offset:43008
    v_mfma_f32_16x16x32_bf16 v[76:79], v[148:151], v[132:135], v[76:79]
    ds_read_b128 v[180:183], v3 offset:44032
    s_add_u32 m0, s35, 8192
    s_add_u32 s33, s33, 4
    buffer_load_dwordx4 v2, s[8:11], s32 offen sc1 lds
    s_cmp_ge_u32 s33, 7
    s_cselect_b32 s28, 0xfffba800, 0
    s_cselect_b32 s29, 7, 0
    s_sub_u32 s33, s33, s29
    s_add_u32 s32, s32, s28
    s_add_u32 s32, s32, 163840
    s_waitcnt lgkmcnt(8)
    v_mfma_f32_16x16x32_bf16 v[80:83], v[152:155], v[128:131], v[80:83]
    ds_read_b128 v[184:187], v3 offset:45056
    v_mfma_f32_16x16x32_bf16 v[84:87], v[152:155], v[132:135], v[84:87]
    ds_read_b128 v[188:191], v3 offset:46080
    s_waitcnt lgkmcnt(9)
    v_mfma_f32_16x16x32_bf16 v[88:91], v[156:159], v[128:131], v[88:91]
    ds_read_b128 v[192:195], v3 offset:47104
    v_mfma_f32_16x16x32_bf16 v[92:95], v[156:159], v[132:135], v[92:95]
    ds_read_b128 v[196:199], v3 offset:48128
    s_add_u32 m0, s35, 16384
    s_add_u32 s33, s33, 4
    buffer_load_dwordx4 v2, s[8:11], s32 offen sc1 lds
    s_cmp_ge_u32 s33, 7
    s_cselect_b32 s28, 0xfffba800, 0
    s_cselect_b32 s29, 7, 0
    s_sub_u32 s33, s33, s29
    s_add_u32 s32, s32, s28
    s_add_u32 s32, s32, 163840
    s_waitcnt lgkmcnt(10)
    v_mfma_f32_16x16x32_bf16 v[96:99], v[160:163], v[128:131], v[96:99]
    ds_read_b128 v[200:203], v48 offset:43008
    v_mfma_f32_16x16x32_bf16 v[100:103], v[160:163], v[132:135], v[100:103]
    s_add_u32 s28, s37, 32768
    buffer_load_dwordx2 v[36:37], v12, s[8:11], s28 offen sc1
    s_waitcnt lgkmcnt(10)
    v_mfma_f32_16x16x32_bf16 v[104:107], v[164:167], v[128:131], v[104:107]
    v_mfma_f32_16x16x32_bf16 v[108:111], v[164:167], v[132:135], v[108:111]
    s_add_u32 s28, s37, 49152
    buffer_load_dwordx2 v[38:39], v12, s[8:11], s28 offen sc1
    s_waitcnt lgkmcnt(9)
    v_mfma_f32_16x16x32_bf16 v[112:115], v[168:171], v[128:131], v[112:115]
    v_mfma_f32_16x16x32_bf16 v[116:119], v[168:171], v[132:135], v[116:119]
    s_waitcnt lgkmcnt(0)
    v_mfma_f32_16x16x32_bf16 v[64:67], v[176:179], v[136:139], v[64:67]
    s_waitcnt vmcnt(9)
    s_barrier
    ds_read_b128 v[128:131], v5 offset:32768
    v_mfma_f32_16x16x32_bf16 v[68:71], v[176:179], v[140:143], v[68:71]
    ds_read_b128 v[132:135], v50 offset:32768
    v_mfma_f32_16x16x32_bf16 v[72:75], v[180:183], v[136:139], v[72:75]
    ds_read_b128 v[144:147], v4 offset:0
    v_mfma_f32_16x16x32_bf16 v[76:79], v[180:183], v[140:143], v[76:79]
    ds_read_b128 v[148:151], v4 offset:1024
    s_add_u32 m0, s35, 131072
    s_add_u32 s28, s34, 8192
    buffer_load_dwordx4 v2, s[8:11], s28 offen sc1 lds
    v_mfma_f32_16x16x32_bf16 v[80:83], v[184:187], v[136:139], v[80:83]
    ds_read_b128 v[152:155], v4 offset:2048
    v_mfma_f32_16x16x32_bf16 v[84:87], v[184:187], v[140:143], v[84:87]
    ds_read_b128 v[156:159], v4 offset:3072
    v_mfma_f32_16x16x32_bf16 v[88:91], v[188:191], v[136:139], v[88:91]
    ds_read_b128 v[160:163], v4 offset:4096
    v_mfma_f32_16x16x32_bf16 v[92:95], v[188:191], v[140:143], v[92:95]
    ds_read_b128 v[164:167], v4 offset:5120
    s_add_u32 m0, s35, 139264
    s_add_u32 s28, s34, 9216
    buffer_load_dwordx4 v2, s[8:11], s28 offen sc1 lds
    v_mfma_f32_16x16x32_bf16 v[96:99], v[192:195], v[136:139], v[96:99]
    ds_read_b128 v[168:171], v49 offset:0
    v_mfma_f32_16x16x32_bf16 v[100:103], v[192:195], v[140:143], v[100:103]
    s_add_u32 m0, s35, 24576
    s_add_u32 s33, s33, 4
    buffer_load_dwordx4 v2, s[8:11], s32 offen sc1 lds
    s_cmp_ge_u32 s33, 7
    s_cselect_b32 s28, 0xfffba800, 0
    s_cselect_b32 s29, 7, 0
    s_sub_u32 s33, s33, s29
    s_add_u32 s32, s32, s28
    s_add_u32 s32, s32, 163840
    v_mfma_f32_16x16x32_bf16 v[104:107], v[196:199], v[136:139], v[104:107]
    v_mfma_f32_16x16x32_bf16 v[108:111], v[196:199], v[140:143], v[108:111]
    v_mfma_f32_16x16x32_bf16 v[112:115], v[200:203], v[136:139], v[112:115]
    v_mfma_f32_16x16x32_bf16 v[116:119], v[200:203], v[140:143], v[116:119]
    s_waitcnt lgkmcnt(6)
    v_mfma_f32_16x16x32_bf16 v[64:67], v[144:147], v[128:131], v[64:67]
    ds_read_b128 v[136:139], v5 offset:40960
    v_mfma_f32_16x16x32_bf16 v[68:71], v[144:147], v[132:135], v[68:71]
    ds_read_b128 v[140:143], v50 offset:40960
    s_waitcnt lgkmcnt(7)
    v_mfma_f32_16x16x32_bf16 v[72:75], v[148:151], v[128:131], v[72:75]
    ds_read_b128 v[176:179], v4 offset:14336
    v_mfma_f32_16x16x32_bf16 v[76:79], v[148:151], v[132:135], v[76:79]
    ds_read_b128 v[180:183], v4 offset:15360
    s_add_u32 s28, s31, 0
    buffer_load_dwordx2 v[40:41], v12, s[8:11], s28 offen sc1
    s_waitcnt lgkmcnt(8)
    v_mfma_f32_16x16x32_bf16 v[80:83], v[152:155], v[128:131], v[80:83]
    ds_read_b128 v[184:187], v4 offset:16384
    v_mfma_f32_16x16x32_bf16 v[84:87], v[152:155], v[132:135], v[84:87]
    ds_read_b128 v[188:191], v4 offset:17408
    s_add_u32 s28, s31, 16384
    buffer_load_dwordx2 v[42:43], v12, s[8:11], s28 offen sc1
    s_waitcnt lgkmcnt(9)
    v_mfma_f32_16x16x32_bf16 v[88:91], v[156:159], v[128:131], v[88:91]
    ds_read_b128 v[192:195], v4 offset:18432
    v_mfma_f32_16x16x32_bf16 v[92:95], v[156:159], v[132:135], v[92:95]
    ds_read_b128 v[196:199], v4 offset:19456
    s_add_u32 s28, s31, 32768
    buffer_load_dwordx2 v[44:45], v12, s[8:11], s28 offen sc1
    s_waitcnt lgkmcnt(10)
    v_mfma_f32_16x16x32_bf16 v[96:99], v[160:163], v[128:131], v[96:99]
    ds_read_b128 v[200:203], v49 offset:14336
    v_mfma_f32_16x16x32_bf16 v[100:103], v[160:163], v[132:135], v[100:103]
    s_add_u32 s28, s31, 49152
    buffer_load_dwordx2 v[46:47], v12, s[8:11], s28 offen sc1
    s_waitcnt lgkmcnt(10)
    v_mfma_f32_16x16x32_bf16 v[104:107], v[164:167], v[128:131], v[104:107]
    v_mfma_f32_16x16x32_bf16 v[108:111], v[164:167], v[132:135], v[108:111]
    s_add_u32 m0, s35, 32768
    s_add_u32 s33, s33, 4
    buffer_load_dwordx4 v2, s[8:11], s32 offen sc1 lds
    s_cmp_ge_u32 s33, 7
    s_cselect_b32 s28, 0xfffba800, 0
    s_cselect_b32 s29, 7, 0
    s_sub_u32 s33, s33, s29
    s_add_u32 s32, s32, s28
    s_add_u32 s32, s32, 163840
    s_waitcnt lgkmcnt(9)
    v_mfma_f32_16x16x32_bf16 v[112:115], v[168:171], v[128:131], v[112:115]
    v_mfma_f32_16x16x32_bf16 v[116:119], v[168:171], v[132:135], v[116:119]
    s_waitcnt lgkmcnt(0)
    v_mfma_f32_16x16x32_bf16 v[64:67], v[176:179], v[136:139], v[64:67]
    s_waitcnt vmcnt(13)
    s_barrier
    ds_read_b128 v[128:131], v5 offset:0
    v_mfma_f32_16x16x32_bf16 v[68:71], v[176:179], v[140:143], v[68:71]
    ds_read_b128 v[132:135], v50 offset:0
    v_mfma_f32_16x16x32_bf16 v[72:75], v[180:183], v[136:139], v[72:75]
    ds_read_b128 v[144:147], v4 offset:28672
    v_mfma_f32_16x16x32_bf16 v[76:79], v[180:183], v[140:143], v[76:79]
    ds_read_b128 v[148:151], v4 offset:29696
    s_add_u32 m0, s35, 147456
    s_add_u32 s28, s34, 10240
    buffer_load_dwordx4 v2, s[8:11], s28 offen sc1 lds
    v_mfma_f32_16x16x32_bf16 v[80:83], v[184:187], v[136:139], v[80:83]
    ds_read_b128 v[152:155], v4 offset:30720
    v_mfma_f32_16x16x32_bf16 v[84:87], v[184:187], v[140:143], v[84:87]
    ds_read_b128 v[156:159], v4 offset:31744
    v_mfma_f32_16x16x32_bf16 v[88:91], v[188:191], v[136:139], v[88:91]
    ds_read_b128 v[160:163], v4 offset:32768
    v_mfma_f32_16x16x32_bf16 v[92:95], v[188:191], v[140:143], v[92:95]
    ds_read_b128 v[164:167], v4 offset:33792
    s_add_u32 m0, s35, 155648
    s_add_u32 s28, s34, 11264
    buffer_load_dwordx4 v2, s[8:11], s28 offen sc1 lds
    v_mfma_f32_16x16x32_bf16 v[96:99], v[192:195], v[136:139], v[96:99]
    ds_read_b128 v[168:171], v49 offset:28672
    v_mfma_f32_16x16x32_bf16 v[100:103], v[192:195], v[140:143], v[100:103]
    s_add_u32 m0, s35, 40960
    s_add_u32 s33, s33, 4
    buffer_load_dwordx4 v2, s[8:11], s32 offen sc1 lds
    s_cmp_ge_u32 s33, 7
    s_cselect_b32 s28, 0xfffba800, 0
    s_cselect_b32 s29, 7, 0
    s_sub_u32 s33, s33, s29
    s_add_u32 s32, s32, s28
    s_add_u32 s32, s32, 163840
    v_mfma_f32_16x16x32_bf16 v[104:107], v[196:199], v[136:139], v[104:107]
    v_mfma_f32_16x16x32_bf16 v[108:111], v[196:199], v[140:143], v[108:111]
    v_mfma_f32_16x16x32_bf16 v[112:115], v[200:203], v[136:139], v[112:115]
    v_mfma_f32_16x16x32_bf16 v[116:119], v[200:203], v[140:143], v[116:119]
    s_waitcnt lgkmcnt(6)
    v_mfma_f32_16x16x32_bf16 v[64:67], v[144:147], v[128:131], v[64:67]
    ds_read_b128 v[136:139], v5 offset:8192
    v_mfma_f32_16x16x32_bf16 v[68:71], v[144:147], v[132:135], v[68:71]
    ds_read_b128 v[140:143], v50 offset:8192
    s_waitcnt lgkmcnt(7)
    v_mfma_f32_16x16x32_bf16 v[72:75], v[148:151], v[128:131], v[72:75]
    ds_read_b128 v[176:179], v4 offset:43008
    v_mfma_f32_16x16x32_bf16 v[76:79], v[148:151], v[132:135], v[76:79]
    ds_read_b128 v[180:183], v4 offset:44032
    s_add_u32 m0, s35, 49152
    s_add_u32 s33, s33, 4
    buffer_load_dwordx4 v2, s[8:11], s32 offen sc1 lds
    s_cmp_ge_u32 s33, 7
    s_cselect_b32 s28, 0xfffba800, 0
    s_cselect_b32 s29, 7, 0
    s_sub_u32 s33, s33, s29
    s_add_u32 s32, s32, s28
    s_add_u32 s32, s32, 163840
    s_waitcnt lgkmcnt(8)
    v_mfma_f32_16x16x32_bf16 v[80:83], v[152:155], v[128:131], v[80:83]
    ds_read_b128 v[184:187], v4 offset:45056
    v_mfma_f32_16x16x32_bf16 v[84:87], v[152:155], v[132:135], v[84:87]
    ds_read_b128 v[188:191], v4 offset:46080
    s_waitcnt lgkmcnt(9)
    v_mfma_f32_16x16x32_bf16 v[88:91], v[156:159], v[128:131], v[88:91]
    ds_read_b128 v[192:195], v4 offset:47104
    v_mfma_f32_16x16x32_bf16 v[92:95], v[156:159], v[132:135], v[92:95]
    ds_read_b128 v[196:199], v4 offset:48128
    s_add_u32 m0, s35, 57344
    s_add_u32 s33, s33, 4
    buffer_load_dwordx4 v2, s[8:11], s32 offen sc1 lds
    s_cmp_ge_u32 s33, 7
    s_cselect_b32 s28, 0xfffba800, 0
    s_cselect_b32 s29, 7, 0
    s_sub_u32 s33, s33, s29
    s_add_u32 s32, s32, s28
    s_add_u32 s32, s32, 163840
    s_waitcnt lgkmcnt(10)
    v_mfma_f32_16x16x32_bf16 v[96:99], v[160:163], v[128:131], v[96:99]
    ds_read_b128 v[200:203], v49 offset:43008
    v_mfma_f32_16x16x32_bf16 v[100:103], v[160:163], v[132:135], v[100:103]
    s_add_u32 m0, s35, 65536
    s_add_u32 s33, s33, 4
    buffer_load_dwordx4 v2, s[8:11], s32 offen sc1 lds
    s_cmp_ge_u32 s33, 7
    s_cselect_b32 s28, 0xfffba800, 0
    s_cselect_b32 s29, 7, 0
    s_sub_u32 s33, s33, s29
    s_add_u32 s32, s32, s28
    s_add_u32 s32, s32, 163840
    s_waitcnt lgkmcnt(10)
    v_mfma_f32_16x16x32_bf16 v[104:107], v[164:167], v[128:131], v[104:107]
    v_mfma_f32_16x16x32_bf16 v[108:111], v[164:167], v[132:135], v[108:111]
    s_waitcnt lgkmcnt(9)
    v_mfma_f32_16x16x32_bf16 v[112:115], v[168:171], v[128:131], v[112:115]
    v_mfma_f32_16x16x32_bf16 v[116:119], v[168:171], v[132:135], v[116:119]
    s_waitcnt lgkmcnt(0)
    v_mfma_f32_16x16x32_bf16 v[64:67], v[176:179], v[136:139], v[64:67]
    s_waitcnt vmcnt(11)
    s_barrier
    ds_read_b128 v[128:131], v5 offset:16384
    v_mfma_f32_16x16x32_bf16 v[68:71], v[176:179], v[140:143], v[68:71]
    ds_read_b128 v[132:135], v50 offset:16384
    v_mfma_f32_16x16x32_bf16 v[72:75], v[180:183], v[136:139], v[72:75]
    ds_read_b128 v[144:147], v3 offset:0
    v_mfma_f32_16x16x32_bf16 v[76:79], v[180:183], v[140:143], v[76:79]
    ds_read_b128 v[148:151], v3 offset:1024
    s_add_u32 m0, s35, 114688
    s_add_u32 s28, s34, 12288
    buffer_load_dwordx4 v2, s[8:11], s28 offen sc1 lds
    v_mfma_f32_16x16x32_bf16 v[80:83], v[184:187], v[136:139], v[80:83]
    ds_read_b128 v[152:155], v3 offset:2048
    v_mfma_f32_16x16x32_bf16 v[84:87], v[184:187], v[140:143], v[84:87]
    ds_read_b128 v[156:159], v3 offset:3072
    v_mfma_f32_16x16x32_bf16 v[88:91], v[188:191], v[136:139], v[88:91]
    ds_read_b128 v[160:163], v3 offset:4096
    v_mfma_f32_16x16x32_bf16 v[92:95], v[188:191], v[140:143], v[92:95]
    ds_read_b128 v[164:167], v3 offset:5120
    s_add_u32 m0, s35, 122880
    s_add_u32 s28, s34, 13312
    buffer_load_dwordx4 v2, s[8:11], s28 offen sc1 lds
    v_mfma_f32_16x16x32_bf16 v[96:99], v[192:195], v[136:139], v[96:99]
    ds_read_b128 v[168:171], v48 offset:0
    v_mfma_f32_16x16x32_bf16 v[100:103], v[192:195], v[140:143], v[100:103]
    s_add_u32 m0, s35, 73728
    s_add_u32 s33, s33, 4
    buffer_load_dwordx4 v2, s[8:11], s32 offen sc1 lds
    s_cmp_ge_u32 s33, 7
    s_cselect_b32 s28, 0xfffba800, 0
    s_cselect_b32 s29, 7, 0
    s_sub_u32 s33, s33, s29
    s_add_u32 s32, s32, s28
    s_add_u32 s32, s32, 163840
    v_mfma_f32_16x16x32_bf16 v[104:107], v[196:199], v[136:139], v[104:107]
    v_mfma_f32_16x16x32_bf16 v[108:111], v[196:199], v[140:143], v[108:111]
    v_mfma_f32_16x16x32_bf16 v[112:115], v[200:203], v[136:139], v[112:115]
    v_mfma_f32_16x16x32_bf16 v[116:119], v[200:203], v[140:143], v[116:119]
    s_waitcnt lgkmcnt(6)
    v_mfma_f32_16x16x32_bf16 v[64:67], v[144:147], v[128:131], v[64:67]
    ds_read_b128 v[136:139], v5 offset:24576
    v_mfma_f32_16x16x32_bf16 v[68:71], v[144:147], v[132:135], v[68:71]
    ds_read_b128 v[140:143], v50 offset:24576
    s_waitcnt lgkmcnt(7)
    v_mfma_f32_16x16x32_bf16 v[72:75], v[148:151], v[128:131], v[72:75]
    ds_read_b128 v[176:179], v3 offset:14336
    v_mfma_f32_16x16x32_bf16 v[76:79], v[148:151], v[132:135], v[76:79]
    ds_read_b128 v[180:183], v3 offset:15360
    s_add_u32 m0, s35, 81920
    s_add_u32 s33, s33, 4
    buffer_load_dwordx4 v2, s[8:11], s32 offen sc1 lds
    s_cmp_ge_u32 s33, 7
    s_cselect_b32 s28, 0xfffba800, 0
    s_cselect_b32 s29, 7, 0
    s_sub_u32 s33, s33, s29
    s_add_u32 s32, s32, s28
    s_add_u32 s32, s32, 163840
    s_waitcnt lgkmcnt(8)
    v_mfma_f32_16x16x32_bf16 v[80:83], v[152:155], v[128:131], v[80:83]
    ds_read_b128 v[184:187], v3 offset:16384
    v_mfma_f32_16x16x32_bf16 v[84:87], v[152:155], v[132:135], v[84:87]
    ds_read_b128 v[188:191], v3 offset:17408
    s_waitcnt lgkmcnt(9)
    v_mfma_f32_16x16x32_bf16 v[88:91], v[156:159], v[128:131], v[88:91]
    ds_read_b128 v[192:195], v3 offset:18432
    v_mfma_f32_16x16x32_bf16 v[92:95], v[156:159], v[132:135], v[92:95]
    ds_read_b128 v[196:199], v3 offset:19456
    s_add_u32 m0, s35, 90112
    s_add_u32 s33, s33, 4
    buffer_load_dwordx4 v2, s[8:11], s32 offen sc1 lds
    s_cmp_ge_u32 s33, 7
    s_cselect_b32 s28, 0xfffba800, 0
    s_cselect_b32 s29, 7, 0
    s_sub_u32 s33, s33, s29
    s_add_u32 s32, s32, s28
    s_add_u32 s32, s32, 163840
    s_waitcnt lgkmcnt(10)
    v_mfma_f32_16x16x32_bf16 v[96:99], v[160:163], v[128:131], v[96:99]
    ds_read_b128 v[200:203], v48 offset:14336
    v_mfma_f32_16x16x32_bf16 v[100:103], v[160:163], v[132:135], v[100:103]
    s_add_u32 m0, s35, 98304
    s_add_u32 s33, s33, 4
    buffer_load_dwordx4 v2, s[8:11], s32 offen sc1 lds
    s_cmp_ge_u32 s33, 7
    s_cselect_b32 s28, 0xfffba800, 0
    s_cselect_b32 s29, 7, 0
    s_sub_u32 s33, s33, s29
    s_add_u32 s32, s32, s28
    s_add_u32 s32, s32, 163840
    s_waitcnt lgkmcnt(10)
    v_mfma_f32_16x16x32_bf16 v[104:107], v[164:167], v[128:131], v[104:107]
    v_mfma_f32_16x16x32_bf16 v[108:111], v[164:167], v[132:135], v[108:111]
    s_waitcnt lgkmcnt(9)
    v_mfma_f32_16x16x32_bf16 v[112:115], v[168:171], v[128:131], v[112:115]
    v_mfma_f32_16x16x32_bf16 v[116:119], v[168:171], v[132:135], v[116:119]
    s_waitcnt lgkmcnt(0)
    v_mfma_f32_16x16x32_bf16 v[64:67], v[176:179], v[136:139], v[64:67]
    s_waitcnt vmcnt(8)
    s_barrier
    ds_read_b128 v[128:131], v5 offset:32768
    v_mfma_f32_16x16x32_bf16 v[68:71], v[176:179], v[140:143], v[68:71]
    ds_read_b128 v[132:135], v50 offset:32768
    v_mfma_f32_16x16x32_bf16 v[72:75], v[180:183], v[136:139], v[72:75]
    ds_read_b128 v[144:147], v3 offset:28672
    v_mfma_f32_16x16x32_bf16 v[76:79], v[180:183], v[140:143], v[76:79]
    ds_read_b128 v[148:151], v3 offset:29696
    s_add_u32 m0, s35, 131072
    s_add_u32 s28, s34, 14336
    buffer_load_dwordx4 v2, s[8:11], s28 offen sc1 lds
    v_mfma_f32_16x16x32_bf16 v[80:83], v[184:187], v[136:139], v[80:83]
    ds_read_b128 v[152:155], v3 offset:30720
    v_mfma_f32_16x16x32_bf16 v[84:87], v[184:187], v[140:143], v[84:87]
    ds_read_b128 v[156:159], v3 offset:31744
    v_mfma_f32_16x16x32_bf16 v[88:91], v[188:191], v[136:139], v[88:91]
    ds_read_b128 v[160:163], v3 offset:32768
    v_mfma_f32_16x16x32_bf16 v[92:95], v[188:191], v[140:143], v[92:95]
    ds_read_b128 v[164:167], v3 offset:33792
    s_add_u32 m0, s35, 139264
    s_add_u32 s28, s34, 15360
    buffer_load_dwordx4 v2, s[8:11], s28 offen sc1 lds
    v_mfma_f32_16x16x32_bf16 v[96:99], v[192:195], v[136:139], v[96:99]
    ds_read_b128 v[168:171], v48 offset:28672
    v_mfma_f32_16x16x32_bf16 v[100:103], v[192:195], v[140:143], v[100:103]
    s_add_u32 m0, s35, 106496
    s_add_u32 s33, s33, 4
    buffer_load_dwordx4 v2, s[8:11], s32 offen sc1 lds
    s_cmp_ge_u32 s33, 7
    s_cselect_b32 s28, 0xfffba800, 0
    s_cselect_b32 s29, 7, 0
    s_sub_u32 s33, s33, s29
    s_add_u32 s32, s32, s28
    s_add_u32 s32, s32, 163840
    v_mfma_f32_16x16x32_bf16 v[104:107], v[196:199], v[136:139], v[104:107]
    v_mfma_f32_16x16x32_bf16 v[108:111], v[196:199], v[140:143], v[108:111]
    v_mfma_f32_16x16x32_bf16 v[112:115], v[200:203], v[136:139], v[112:115]
    v_mfma_f32_16x16x32_bf16 v[116:119], v[200:203], v[140:143], v[116:119]
    s_waitcnt lgkmcnt(6)
    v_mfma_f32_16x16x32_bf16 v[64:67], v[144:147], v[128:131], v[64:67]
    ds_read_b128 v[136:139], v5 offset:40960
    v_mfma_f32_16x16x32_bf16 v[68:71], v[144:147], v[132:135], v[68:71]
    ds_read_b128 v[140:143], v50 offset:40960
    s_waitcnt lgkmcnt(7)
    v_mfma_f32_16x16x32_bf16 v[72:75], v[148:151], v[128:131], v[72:75]
    ds_read_b128 v[176:179], v3 offset:43008
    v_mfma_f32_16x16x32_bf16 v[76:79], v[148:151], v[132:135], v[76:79]
    ds_read_b128 v[180:183], v3 offset:44032
    s_add_u32 m0, s35, 0
    s_add_u32 s33, s33, 4
    buffer_load_dwordx4 v2, s[8:11], s32 offen sc1 lds
    s_cmp_ge_u32 s33, 7
    s_cselect_b32 s28, 0xfffba800, 0
    s_cselect_b32 s29, 7, 0
    s_sub_u32 s33, s33, s29
    s_add_u32 s32, s32, s28
    s_add_u32 s32, s32, 163840
    s_waitcnt lgkmcnt(8)
    v_mfma_f32_16x16x32_bf16 v[80:83], v[152:155], v[128:131], v[80:83]
    ds_read_b128 v[184:187], v3 offset:45056
    v_mfma_f32_16x16x32_bf16 v[84:87], v[152:155], v[132:135], v[84:87]
    ds_read_b128 v[188:191], v3 offset:46080
    s_waitcnt lgkmcnt(9)
    v_mfma_f32_16x16x32_bf16 v[88:91], v[156:159], v[128:131], v[88:91]
    ds_read_b128 v[192:195], v3 offset:47104
    v_mfma_f32_16x16x32_bf16 v[92:95], v[156:159], v[132:135], v[92:95]
    ds_read_b128 v[196:199], v3 offset:48128
    s_add_u32 m0, s35, 8192
    s_add_u32 s33, s33, 4
    buffer_load_dwordx4 v2, s[8:11], s32 offen sc1 lds
    s_cmp_ge_u32 s33, 7
    s_cselect_b32 s28, 0xfffba800, 0
    s_cselect_b32 s29, 7, 0
    s_sub_u32 s33, s33, s29
    s_add_u32 s32, s32, s28
    s_add_u32 s32, s32, 163840
    s_waitcnt lgkmcnt(10)
    v_mfma_f32_16x16x32_bf16 v[96:99], v[160:163], v[128:131], v[96:99]
    ds_read_b128 v[200:203], v48 offset:43008
    v_mfma_f32_16x16x32_bf16 v[100:103], v[160:163], v[132:135], v[100:103]
    s_add_u32 m0, s35, 16384
    s_add_u32 s33, s33, 4
    buffer_load_dwordx4 v2, s[8:11], s32 offen sc1 lds
    s_cmp_ge_u32 s33, 7
    s_cselect_b32 s28, 0xfffba800, 0
    s_cselect_b32 s29, 7, 0
    s_sub_u32 s33, s33, s29
    s_add_u32 s32, s32, s28
    s_add_u32 s32, s32, 163840
    s_mov_b32 s40, 0xffff0000
    s_mov_b32 s41, 0xffff0000
    s_mov_b32 s30, -1
    s_waitcnt lgkmcnt(10)
    v_mfma_f32_16x16x32_bf16 v[104:107], v[164:167], v[128:131], v[104:107]
    s_mov_b32 s31, 0
    s_cmp_eq_u32 s27, 1
    s_cselect_b64 s[50:51], -1, 0
    v_mfma_f32_16x16x32_bf16 v[108:111], v[164:167], v[132:135], v[108:111]
    v_add_f32 v32, v32, v34
    v_add_f32 v40, v40, v42
    v_add_f32 v33, v33, v35
    s_waitcnt lgkmcnt(9)
    v_mfma_f32_16x16x32_bf16 v[112:115], v[168:171], v[128:131], v[112:115]
    v_add_f32 v41, v41, v43
    v_add_f32 v36, v36, v38
    v_add_f32 v44, v44, v46
    v_mfma_f32_16x16x32_bf16 v[116:119], v[168:171], v[132:135], v[116:119]
    v_add_f32 v37, v37, v39
    v_add_f32 v45, v45, v47
    v_add_f32 v32, v32, v36
    s_waitcnt lgkmcnt(0)
    v_mfma_f32_16x16x32_bf16 v[64:67], v[176:179], v[136:139], v[64:67]
    s_waitcnt vmcnt(8)
    s_barrier
    ds_read_b128 v[128:131], v5 offset:0
    v_mfma_f32_16x16x32_bf16 v[68:71], v[176:179], v[140:143], v[68:71]
    ds_read_b128 v[132:135], v50 offset:0
    v_mfma_f32_16x16x32_bf16 v[72:75], v[180:183], v[136:139], v[72:75]
    ds_read_b128 v[144:147], v4 offset:0
    v_mfma_f32_16x16x32_bf16 v[76:79], v[180:183], v[140:143], v[76:79]
    ds_read_b128 v[148:151], v4 offset:1024
    s_add_u32 m0, s35, 147456
    s_add_u32 s28, s34, 16384
    buffer_load_dwordx4 v2, s[8:11], s28 offen sc1 lds
    v_mfma_f32_16x16x32_bf16 v[80:83], v[184:187], v[136:139], v[80:83]
    ds_read_b128 v[152:155], v4 offset:2048
    v_mfma_f32_16x16x32_bf16 v[84:87], v[184:187], v[140:143], v[84:87]
    ds_read_b128 v[156:159], v4 offset:3072
    buffer_load_dwordx4 v[228:231], v58, s[8:11], s48 offen offset:0 sc1
    v_mfma_f32_16x16x32_bf16 v[88:91], v[188:191], v[136:139], v[88:91]
    ds_read_b128 v[160:163], v4 offset:4096
    v_mfma_f32_16x16x32_bf16 v[92:95], v[188:191], v[140:143], v[92:95]
    ds_read_b128 v[164:167], v4 offset:5120
    s_add_u32 m0, s35, 155648
    s_add_u32 s28, s34, 17408
    buffer_load_dwordx4 v2, s[8:11], s28 offen sc1 lds
    v_mfma_f32_16x16x32_bf16 v[96:99], v[192:195], v[136:139], v[96:99]
    ds_read_b128 v[168:171], v49 offset:0
    v_mfma_f32_16x16x32_bf16 v[100:103], v[192:195], v[140:143], v[100:103]
    s_add_u32 m0, s35, 24576
    s_add_u32 s33, s33, 4
    buffer_load_dwordx4 v2, s[8:11], s32 offen sc1 lds
    s_cmp_ge_u32 s33, 7
    s_cselect_b32 s28, 0xfffba800, 0
    s_cselect_b32 s29, 7, 0
    s_sub_u32 s33, s33, s29
    s_add_u32 s32, s32, s28
    s_add_u32 s32, s32, 163840
    v_add_f32 v40, v40, v44
    v_add_f32 v33, v33, v37
    v_add_f32 v41, v41, v45
    v_mfma_f32_16x16x32_bf16 v[104:107], v[196:199], v[136:139], v[104:107]
    s_nop 0
    s_nop 0
    v_permlane16_swap_b32 v32, v33
    v_mfma_f32_16x16x32_bf16 v[108:111], v[196:199], v[140:143], v[108:111]
    buffer_load_dwordx4 v[232:235], v58, s[8:11], s48 offen offset:16 sc1
    v_permlane16_swap_b32 v40, v41
    v_add_f32 v32, v32, v33
    v_add_f32 v40, v40, v41
    v_mfma_f32_16x16x32_bf16 v[112:115], v[200:203], v[136:139], v[112:115]
    v_mov_b32 v33, v32
    v_mov_b32 v41, v40
    s_nop 0
    v_mfma_f32_16x16x32_bf16 v[116:119], v[200:203], v[140:143], v[116:119]
    s_nop 0
    v_permlane32_swap_b32 v32, v33
    v_permlane32_swap_b32 v40, v41
    s_waitcnt lgkmcnt(6)
    v_mfma_f32_16x16x32_bf16 v[64:67], v[144:147], v[128:131], v[64:67]
    ds_read_b128 v[136:139], v5 offset:8192
    v_mfma_f32_16x16x32_bf16 v[68:71], v[144:147], v[132:135], v[68:71]
    ds_read_b128 v[140:143], v50 offset:8192
    s_waitcnt lgkmcnt(7)
    v_mfma_f32_16x16x32_bf16 v[72:75], v[148:151], v[128:131], v[72:75]
    ds_read_b128 v[176:179], v4 offset:14336
    v_mfma_f32_16x16x32_bf16 v[76:79], v[148:151], v[132:135], v[76:79]
    ds_read_b128 v[180:183], v4 offset:15360
    s_add_u32 m0, s35, 32768
    s_add_u32 s33, s33, 4
    buffer_load_dwordx4 v2, s[8:11], s32 offen sc1 lds
    s_cmp_ge_u32 s33, 7
    s_cselect_b32 s28, 0xfffba800, 0
    s_cselect_b32 s29, 7, 0
    s_sub_u32 s33, s33, s29
    s_add_u32 s32, s32, s28
    s_add_u32 s32, s32, 163840
    s_waitcnt lgkmcnt(8)
    v_mfma_f32_16x16x32_bf16 v[80:83], v[152:155], v[128:131], v[80:83]
    ds_read_b128 v[184:187], v4 offset:16384
    v_mfma_f32_16x16x32_bf16 v[84:87], v[152:155], v[132:135], v[84:87]
    ds_read_b128 v[188:191], v4 offset:17408
    buffer_load_dwordx4 v[236:239], v59, s[8:11], s48 offen offset:256 sc1
    s_waitcnt lgkmcnt(9)
    v_mfma_f32_16x16x32_bf16 v[88:91], v[156:159], v[128:131], v[88:91]
    ds_read_b128 v[192:195], v4 offset:18432
    v_mfma_f32_16x16x32_bf16 v[92:95], v[156:159], v[132:135], v[92:95]
    ds_read_b128 v[196:199], v4 offset:19456
    s_add_u32 m0, s35, 40960
    s_add_u32 s33, s33, 4
    buffer_load_dwordx4 v2, s[8:11], s32 offen sc1 lds
    s_cmp_ge_u32 s33, 7
    s_cselect_b32 s28, 0xfffba800, 0
    s_cselect_b32 s29, 7, 0
    s_sub_u32 s33, s33, s29
    s_add_u32 s32, s32, s28
    s_add_u32 s32, s32, 163840
    s_waitcnt lgkmcnt(10)
    v_mfma_f32_16x16x32_bf16 v[96:99], v[160:163], v[128:131], v[96:99]
    ds_read_b128 v[200:203], v49 offset:14336
    v_mfma_f32_16x16x32_bf16 v[100:103], v[160:163], v[132:135], v[100:103]
    s_add_u32 m0, s35, 49152
    s_add_u32 s33, s33, 4
    buffer_load_dwordx4 v2, s[8:11], s32 offen sc1 lds
    s_cmp_ge_u32 s33, 7
    s_cselect_b32 s28, 0xfffba800, 0
    s_cselect_b32 s29, 7, 0
    s_sub_u32 s33, s33, s29
    s_add_u32 s32, s32, s28
    s_add_u32 s32, s32, 163840
    v_add_f32 v32, v32, v33
    v_add_f32 v40, v40, v41
    v_mov_b32 v33, v32
    s_waitcnt lgkmcnt(10)
    v_mfma_f32_16x16x32_bf16 v[104:107], v[164:167], v[128:131], v[104:107]
    v_mov_b32 v41, v40
    s_nop 0
    s_nop 0
    v_mfma_f32_16x16x32_bf16 v[108:111], v[164:167], v[132:135], v[108:111]
    s_add_u32 s48, s48, 5120
    buffer_load_dwordx4 v[240:243], v58, s[8:11], s48 offen offset:0 sc1
    v_permlane16_swap_b32 v32, v33
    v_permlane16_swap_b32 v40, v41
    v_mul_f32 v32, 0xbacccccd, v32
    s_waitcnt lgkmcnt(9)
    v_mfma_f32_16x16x32_bf16 v[112:115], v[168:171], v[128:131], v[112:115]
    v_mul_f32 v40, 0xbacccccd, v40
    v_mul_f32 v33, 0x3acccccd, v33
    v_mul_f32 v41, 0x3acccccd, v41
    v_mfma_f32_16x16x32_bf16 v[116:119], v[168:171], v[132:135], v[116:119]
    v_fma_f32 v33, -v32, v32, v33
    v_fma_f32 v41, -v40, v40, v41
    v_max_f32 v33, 0, v33
    s_waitcnt lgkmcnt(0)
    v_mfma_f32_16x16x32_bf16 v[64:67], v[176:179], v[136:139], v[64:67]
    s_waitcnt vmcnt(13)
    s_barrier
    ds_read_b128 v[128:131], v5 offset:16384
    v_mfma_f32_16x16x32_bf16 v[68:71], v[176:179], v[140:143], v[68:71]
    ds_read_b128 v[132:135], v50 offset:16384
    v_mfma_f32_16x16x32_bf16 v[72:75], v[180:183], v[136:139], v[72:75]
    ds_read_b128 v[144:147], v4 offset:28672
    v_mfma_f32_16x16x32_bf16 v[76:79], v[180:183], v[140:143], v[76:79]
    ds_read_b128 v[148:151], v4 offset:29696
    s_add_u32 m0, s35, 114688
    s_add_u32 s28, s34, 18432
    buffer_load_dwordx4 v2, s[8:11], s28 offen sc1 lds
    v_mfma_f32_16x16x32_bf16 v[80:83], v[184:187], v[136:139], v[80:83]
    ds_read_b128 v[152:155], v4 offset:30720
    v_mfma_f32_16x16x32_bf16 v[84:87], v[184:187], v[140:143], v[84:87]
    ds_read_b128 v[156:159], v4 offset:31744
    buffer_load_dwordx4 v[244:247], v58, s[8:11], s48 offen offset:16 sc1
    v_mfma_f32_16x16x32_bf16 v[88:91], v[188:191], v[136:139], v[88:91]
    ds_read_b128 v[160:163], v4 offset:32768
    v_mfma_f32_16x16x32_bf16 v[92:95], v[188:191], v[140:143], v[92:95]
    ds_read_b128 v[164:167], v4 offset:33792
    s_add_u32 m0, s35, 122880
    s_add_u32 s28, s34, 19456
    buffer_load_dwordx4 v2, s[8:11], s28 offen sc1 lds
    v_mfma_f32_16x16x32_bf16 v[96:99], v[192:195], v[136:139], v[96:99]
    ds_read_b128 v[168:171], v49 offset:28672
    v_mfma_f32_16x16x32_bf16 v[100:103], v[192:195], v[140:143], v[100:103]
    buffer_load_dwordx4 v[54:57], v59, s[8:11], s48 offen offset:256 sc1
    v_max_f32 v41, 0, v41
    v_add_f32 v33, 0x3727c5ac, v33
    v_add_f32 v41, 0x3727c5ac, v41
    v_mfma_f32_16x16x32_bf16 v[104:107], v[196:199], v[136:139], v[104:107]
    v_rsq_f32 v7, v33
    v_rsq_f32 v8, v41
    s_nop 0
    v_mfma_f32_16x16x32_bf16 v[108:111], v[196:199], v[140:143], v[108:111]
    s_nop 0
    v_mul_f32 v9, v33, v7
    v_mul_f32 v10, v41, v8
    v_mfma_f32_16x16x32_bf16 v[112:115], v[200:203], v[136:139], v[112:115]
    v_mul_f32 v7, 0xbfb8aa3b, v7
    v_mul_f32 v8, 0xbfb8aa3b, v8
    v_cndmask_b32 v32, v32, v9, s[40:41]
    v_mfma_f32_16x16x32_bf16 v[116:119], v[200:203], v[140:143], v[116:119]
    v_cndmask_b32 v40, v40, v10, s[40:41]
    v_cvt_pk_bf16_f32 v33, v32, v32
    v_cvt_pk_bf16_f32 v41, v40, v40
    s_waitcnt lgkmcnt(6)
    v_mfma_f32_16x16x32_bf16 v[64:67], v[144:147], v[128:131], v[64:67]
    ds_read_b128 v[136:139], v5 offset:24576
    v_mfma_f32_16x16x32_bf16 v[68:71], v[144:147], v[132:135], v[68:71]
    ds_read_b128 v[140:143], v50 offset:24576
    s_waitcnt lgkmcnt(7)
    v_mfma_f32_16x16x32_bf16 v[72:75], v[148:151], v[128:131], v[72:75]
    ds_read_b128 v[176:179], v4 offset:43008
    v_mfma_f32_16x16x32_bf16 v[76:79], v[148:151], v[132:135], v[76:79]
    ds_read_b128 v[180:183], v4 offset:44032
    s_waitcnt lgkmcnt(8)
    v_mfma_f32_16x16x32_bf16 v[80:83], v[152:155], v[128:131], v[80:83]
    ds_read_b128 v[184:187], v4 offset:45056
    v_mfma_f32_16x16x32_bf16 v[84:87], v[152:155], v[132:135], v[84:87]
    ds_read_b128 v[188:191], v4 offset:46080
    s_waitcnt lgkmcnt(9)
    v_mfma_f32_16x16x32_bf16 v[88:91], v[156:159], v[128:131], v[88:91]
    ds_read_b128 v[192:195], v4 offset:47104
    v_mfma_f32_16x16x32_bf16 v[92:95], v[156:159], v[132:135], v[92:95]
    ds_read_b128 v[196:199], v4 offset:48128
    s_waitcnt lgkmcnt(10)
    v_mfma_f32_16x16x32_bf16 v[96:99], v[160:163], v[128:131], v[96:99]
    ds_read_b128 v[200:203], v49 offset:43008
    v_mfma_f32_16x16x32_bf16 v[100:103], v[160:163], v[132:135], v[100:103]
    v_and_b32 v33, 0xffff0000, v33
    v_and_b32 v41, 0xffff0000, v41
    v_sub_f32 v33, v32, v33
    s_waitcnt lgkmcnt(10)
    v_mfma_f32_16x16x32_bf16 v[104:107], v[164:167], v[128:131], v[104:107]
    v_sub_f32 v41, v40, v41
    v_cvt_pk_bf16_f32 v32, v32, v33
    v_cvt_pk_bf16_f32 v40, v40, v41
    v_mfma_f32_16x16x32_bf16 v[108:111], v[164:167], v[132:135], v[108:111]
    v_cndmask_b32 v216, 0, v32, s[30:31]
    v_cndmask_b32 v220, 0, v40, s[30:31]
    v_cndmask_b32 v218, v32, 0, s[30:31]
    s_waitcnt lgkmcnt(9)
    v_mfma_f32_16x16x32_bf16 v[112:115], v[168:171], v[128:131], v[112:115]
    v_cndmask_b32 v222, v40, 0, s[30:31]
    v_mov_b32 v217, v216
    v_mov_b32 v221, v220
    v_mfma_f32_16x16x32_bf16 v[116:119], v[168:171], v[132:135], v[116:119]
    v_mov_b32 v219, v218
    v_mov_b32 v223, v222
    v_cndmask_b32 v224, v216, v218, s[50:51]
    s_waitcnt lgkmcnt(0)
    v_mfma_f32_16x16x32_bf16 v[64:67], v[176:179], v[136:139], v[64:67]
    s_waitcnt vmcnt(1)
    s_barrier
    ds_read_b128 v[128:131], v5 offset:32768
    v_mfma_f32_16x16x32_bf16 v[68:71], v[176:179], v[140:143], v[68:71]
    ds_read_b128 v[132:135], v50 offset:32768
    v_mfma_f32_16x16x32_bf16 v[72:75], v[180:183], v[136:139], v[72:75]
    ds_read_b128 v[144:147], v3 offset:0
    v_mfma_f32_16x16x32_bf16 v[76:79], v[180:183], v[140:143], v[76:79]
    ds_read_b128 v[148:151], v3 offset:1024
    s_add_u32 m0, s59, 0
    s_add_u32 s62, s58, 0
    buffer_load_dwordx4 v2, s[8:11], s62 offen sc1 lds
    v_mfma_f32_16x16x32_bf16 v[80:83], v[184:187], v[136:139], v[80:83]
    ds_read_b128 v[152:155], v3 offset:2048
    v_mfma_f32_16x16x32_bf16 v[84:87], v[184:187], v[140:143], v[84:87]
    ds_read_b128 v[156:159], v3 offset:3072
    v_mfma_f32_16x16x32_bf16 v[88:91], v[188:191], v[136:139], v[88:91]
    ds_read_b128 v[160:163], v3 offset:4096
    v_mfma_f32_16x16x32_bf16 v[92:95], v[188:191], v[140:143], v[92:95]
    ds_read_b128 v[164:167], v3 offset:5120
    s_add_u32 m0, s59, 4096
    s_add_u32 s62, s58, 4096
    buffer_load_dwordx4 v2, s[8:11], s62 offen sc1 lds
    v_mfma_f32_16x16x32_bf16 v[96:99], v[192:195], v[136:139], v[96:99]
    ds_read_b128 v[168:171], v48 offset:0
    v_mfma_f32_16x16x32_bf16 v[100:103], v[192:195], v[140:143], v[100:103]
    v_cndmask_b32 v226, v220, v222, s[50:51]
    v_mov_b32 v225, v224
    v_mov_b32 v227, v226
    v_mfma_f32_16x16x32_bf16 v[104:107], v[196:199], v[136:139], v[104:107]
    v_mfma_f32_16x16x32_bf16 v[108:111], v[196:199], v[140:143], v[108:111]
    v_mfma_f32_16x16x32_bf16 v[112:115], v[200:203], v[136:139], v[112:115]
    v_mfma_f32_16x16x32_bf16 v[116:119], v[200:203], v[140:143], v[116:119]
    ds_read_b128 v[136:139], v5 offset:40960
    ds_read_b128 v[140:143], v50 offset:40960
    ds_read_b128 v[176:179], v48 offset:14336
    ds_read_b128 v[16:19], v5 offset:0
    ds_read_b128 v[20:23], v50 offset:0
    ds_read_b128 v[180:183], v48 offset:28672
    ds_read_b128 v[24:27], v5 offset:8192
    ds_read_b128 v[28:31], v50 offset:8192
    ds_read_b128 v[184:187], v48 offset:43008
    ds_read_b128 v[188:191], v3 offset:14336
    s_waitcnt lgkmcnt(10)
    v_mfma_f32_16x16x32_bf16 v[112:115], v[168:171], v[128:131], v[112:115]
    ds_read_b128 v[192:195], v3 offset:15360
    v_mfma_f32_16x16x32_bf16 v[116:119], v[168:171], v[132:135], v[116:119]
    s_add_u32 m0, s59, 8192
    s_add_u32 s62, s58, 8192
    buffer_load_dwordx4 v2, s[8:11], s62 offen sc1 lds
    s_waitcnt lgkmcnt(8)
    v_mfma_f32_16x16x32_bf16 v[112:115], v[176:179], v[136:139], v[112:115]
    ds_read_b128 v[196:199], v3 offset:28672
    v_mfma_f32_16x16x32_bf16 v[116:119], v[176:179], v[140:143], v[116:119]
    s_add_u32 m0, s59, 12288
    s_add_u32 s62, s58, 12288
    buffer_load_dwordx4 v2, s[8:11], s62 offen sc1 lds
    s_waitcnt lgkmcnt(6)
    v_mfma_f32_16x16x32_bf16 v[112:115], v[180:183], v[16:19], v[112:115]
    ds_read_b128 v[200:203], v3 offset:29696
    v_mfma_f32_16x16x32_bf16 v[116:119], v[180:183], v[20:23], v[116:119]
    s_add_u32 m0, s59, 16384
    s_add_u32 s62, s58, 16384
    buffer_load_dwordx4 v2, s[8:11], s62 offen sc1 lds
    s_waitcnt lgkmcnt(4)
    v_mfma_f32_16x16x32_bf16 v[112:115], v[184:187], v[24:27], v[112:115]
    ds_read_b128 v[204:207], v3 offset:43008
    v_mfma_f32_16x16x32_bf16 v[116:119], v[184:187], v[28:31], v[116:119]
    s_add_u32 m0, s59, 20480
    s_add_u32 s62, s58, 20480
    buffer_load_dwordx4 v2, s[8:11], s62 offen sc1 lds
    v_mfma_f32_16x16x16bf16_1k v[112:115], v[126:127], v[224:225], v[112:115]
    v_mfma_f32_16x16x16bf16_1k v[116:119], v[126:127], v[226:227], v[116:119]
    v_mfma_f32_16x16x32_bf16 v[64:67], v[144:147], v[128:131], v[64:67]
    ds_read_b128 v[172:175], v3 offset:44032
    v_mfma_f32_16x16x32_bf16 v[68:71], v[144:147], v[132:135], v[68:71]
    v_mfma_f32_16x16x32_bf16 v[72:75], v[148:151], v[128:131], v[72:75]
    ds_read_b128 v[168:171], v3 offset:16384
    v_mfma_f32_16x16x32_bf16 v[76:79], v[148:151], v[132:135], v[76:79]
    s_nop 1
    ds_write_b128 v51, v[116:119]
    s_waitcnt lgkmcnt(7)
    v_mfma_f32_16x16x32_bf16 v[64:67], v[188:191], v[136:139], v[64:67]
    ds_read_b128 v[176:179], v3 offset:17408
    v_mfma_f32_16x16x32_bf16 v[68:71], v[188:191], v[140:143], v[68:71]
    s_waitcnt lgkmcnt(7)
    v_mfma_f32_16x16x32_bf16 v[72:75], v[192:195], v[136:139], v[72:75]
    ds_read_b128 v[180:183], v3 offset:30720
    s_waitcnt lgkmcnt(2)
    s_barrier
    ds_read_b128 v[116:119], v52
    v_mfma_f32_16x16x32_bf16 v[76:79], v[192:195], v[140:143], v[76:79]
    v_mfma_f32_16x16x32_bf16 v[64:67], v[196:199], v[16:19], v[64:67]
    ds_read_b128 v[184:187], v3 offset:31744
    v_mfma_f32_16x16x32_bf16 v[68:71], v[196:199], v[20:23], v[68:71]
    v_mfma_f32_16x16x32_bf16 v[72:75], v[200:203], v[16:19], v[72:75]
    ds_read_b128 v[144:147], v3 offset:45056
    s_cmp_eq_u32 s27, 0
    s_waitcnt lgkmcnt(2)
    s_cbranch_scc1 E_g_96
    v_swap_b32 v112, v116
    v_swap_b32 v113, v117
    v_swap_b32 v114, v118
    v_swap_b32 v115, v119
E_g_96:
    v_mul_f32 v112, v112, v7
    v_mul_f32 v113, v113, v7
    v_mfma_f32_16x16x32_bf16 v[76:79], v[200:203], v[20:23], v[76:79]
    v_mul_f32 v114, v114, v7
    v_mul_f32 v115, v115, v7
    v_exp_f32 v112, v112
    v_mfma_f32_16x16x32_bf16 v[64:67], v[204:207], v[24:27], v[64:67]
    ds_read_b128 v[148:151], v3 offset:46080
    v_exp_f32 v113, v113
    v_exp_f32 v114, v114
    v_exp_f32 v115, v115
    v_mfma_f32_16x16x32_bf16 v[68:71], v[204:207], v[28:31], v[68:71]
    v_fma_f32 v112, v112, v9, v9
    v_fma_f32 v113, v113, v9, v9
    v_fma_f32 v114, v114, v9, v9
    v_mfma_f32_16x16x32_bf16 v[72:75], v[172:175], v[24:27], v[72:75]
    ds_read_b128 v[188:191], v3 offset:18432
    v_fma_f32 v115, v115, v9, v9
    v_rcp_f32 v112, v112
    v_rcp_f32 v113, v113
    v_mfma_f32_16x16x32_bf16 v[76:79], v[172:175], v[28:31], v[76:79]
    v_rcp_f32 v114, v114
    v_rcp_f32 v115, v115
    v_mul_f32 v112, v112, v116
    v_mfma_f32_16x16x16bf16_1k v[64:67], v[120:121], v[216:217], v[64:67]
    v_mul_f32 v113, v113, v117
    v_mul_f32 v114, v114, v118
    v_mul_f32 v115, v115, v119
    v_mfma_f32_16x16x16bf16_1k v[68:71], v[120:121], v[220:221], v[68:71]
    v_cvt_pk_bf16_f32 v44, v112, v113
    v_cvt_pk_bf16_f32 v45, v114, v115
    buffer_store_dwordx2 v[44:45], v53, s[8:11], s36 offen sc1
    v_mfma_f32_16x16x16bf16_1k v[72:75], v[120:121], v[218:219], v[72:75]
    v_mfma_f32_16x16x16bf16_1k v[76:79], v[120:121], v[222:223], v[76:79]
    v_mfma_f32_16x16x32_bf16 v[80:83], v[152:155], v[128:131], v[80:83]
    ds_read_b128 v[192:195], v3 offset:19456
    v_mfma_f32_16x16x32_bf16 v[84:87], v[152:155], v[132:135], v[84:87]
    v_mfma_f32_16x16x32_bf16 v[88:91], v[156:159], v[128:131], v[88:91]
    ds_read_b128 v[196:199], v3 offset:32768
    v_mfma_f32_16x16x32_bf16 v[92:95], v[156:159], v[132:135], v[92:95]
    v_mul_f32 v64, v64, v7
    v_mul_f32 v65, v65, v7
    v_mul_f32 v66, v66, v7
    v_mfma_f32_16x16x32_bf16 v[80:83], v[168:171], v[136:139], v[80:83]
    ds_read_b128 v[200:203], v3 offset:33792
    v_mul_f32 v67, v67, v7
    v_mul_f32 v68, v68, v8
    v_mul_f32 v69, v69, v8
    v_mfma_f32_16x16x32_bf16 v[84:87], v[168:171], v[140:143], v[84:87]
    v_mul_f32 v70, v70, v8
    v_mul_f32 v71, v71, v8
    v_exp_f32 v64, v64
    v_mfma_f32_16x16x32_bf16 v[88:91], v[176:179], v[136:139], v[88:91]
    ds_read_b128 v[204:207], v3 offset:47104
    v_exp_f32 v65, v65
    v_exp_f32 v66, v66
    v_exp_f32 v67, v67
    v_mfma_f32_16x16x32_bf16 v[92:95], v[176:179], v[140:143], v[92:95]
    v_exp_f32 v68, v68
    v_exp_f32 v69, v69
    v_exp_f32 v70, v70
    v_mfma_f32_16x16x32_bf16 v[80:83], v[180:183], v[16:19], v[80:83]
    ds_read_b128 v[172:175], v3 offset:48128
    v_exp_f32 v71, v71
    v_fma_f32 v64, v64, v9, v9
    v_fma_f32 v65, v65, v9, v9
    v_mfma_f32_16x16x32_bf16 v[84:87], v[180:183], v[20:23], v[84:87]
    v_fma_f32 v66, v66, v9, v9
    v_fma_f32 v67, v67, v9, v9
    v_fma_f32 v68, v68, v10, v10
    s_waitcnt lgkmcnt(8)
    v_mfma_f32_16x16x32_bf16 v[88:91], v[184:187], v[16:19], v[88:91]
    v_fma_f32 v69, v69, v10, v10
    v_fma_f32 v70, v70, v10, v10
    v_fma_f32 v71, v71, v10, v10
    v_mfma_f32_16x16x32_bf16 v[92:95], v[184:187], v[20:23], v[92:95]
    v_rcp_f32 v64, v64
    v_rcp_f32 v65, v65
    v_rcp_f32 v66, v66
    s_waitcnt lgkmcnt(7)
    v_mfma_f32_16x16x32_bf16 v[80:83], v[144:147], v[24:27], v[80:83]
    v_rcp_f32 v67, v67
    v_rcp_f32 v68, v68
    v_rcp_f32 v69, v69
    v_mfma_f32_16x16x32_bf16 v[84:87], v[144:147], v[28:31], v[84:87]
    v_rcp_f32 v70, v70
    v_rcp_f32 v71, v71
    v_mul_f32 v64, v64, v72
    s_waitcnt lgkmcnt(6)
    v_mfma_f32_16x16x32_bf16 v[88:91], v[148:151], v[24:27], v[88:91]
    v_mul_f32 v65, v65, v73
    v_mul_f32 v66, v66, v74
    v_mul_f32 v67, v67, v75
    v_mfma_f32_16x16x32_bf16 v[92:95], v[148:151], v[28:31], v[92:95]
    v_mul_f32 v68, v68, v76
    v_mul_f32 v69, v69, v77
    v_mul_f32 v70, v70, v78
    v_mfma_f32_16x16x16bf16_1k v[80:83], v[122:123], v[216:217], v[80:83]
    v_mul_f32 v71, v71, v79
    v_cvt_pk_bf16_f32 v32, v64, v65
    v_cvt_pk_bf16_f32 v33, v66, v67
    v_mfma_f32_16x16x16bf16_1k v[84:87], v[122:123], v[220:221], v[84:87]
    v_cvt_pk_bf16_f32 v34, v68, v69
    v_cvt_pk_bf16_f32 v35, v70, v71
    s_nop 1
    v_mfma_f32_16x16x16bf16_1k v[88:91], v[122:123], v[218:219], v[88:91]
    v_permlane16_swap_b32 v32, v34
    v_permlane16_swap_b32 v33, v35
    buffer_store_dwordx4 v[32:35], v6, s[8:11], s36 offen offset:0 sc1
    v_mfma_f32_16x16x16bf16_1k v[92:95], v[122:123], v[222:223], v[92:95]
    v_mfma_f32_16x16x32_bf16 v[96:99], v[160:163], v[128:131], v[96:99]
    v_mfma_f32_16x16x32_bf16 v[100:103], v[160:163], v[132:135], v[100:103]
    v_mfma_f32_16x16x32_bf16 v[104:107], v[164:167], v[128:131], v[104:107]
    v_mfma_f32_16x16x32_bf16 v[108:111], v[164:167], v[132:135], v[108:111]
    v_mul_f32 v80, v80, v7
    v_mul_f32 v81, v81, v7
    v_mul_f32 v82, v82, v7
    s_waitcnt lgkmcnt(5)
    v_mfma_f32_16x16x32_bf16 v[96:99], v[188:191], v[136:139], v[96:99]
    v_mul_f32 v83, v83, v7
    v_mul_f32 v84, v84, v8
    v_mul_f32 v85, v85, v8
    v_mfma_f32_16x16x32_bf16 v[100:103], v[188:191], v[140:143], v[100:103]
    v_mul_f32 v86, v86, v8
    v_mul_f32 v87, v87, v8
    v_exp_f32 v80, v80
    s_waitcnt lgkmcnt(4)
    v_mfma_f32_16x16x32_bf16 v[104:107], v[192:195], v[136:139], v[104:107]
    v_exp_f32 v81, v81
    v_exp_f32 v82, v82
    v_exp_f32 v83, v83
    v_mfma_f32_16x16x32_bf16 v[108:111], v[192:195], v[140:143], v[108:111]
    v_exp_f32 v84, v84
    v_exp_f32 v85, v85
    v_exp_f32 v86, v86
    s_waitcnt lgkmcnt(3)
    v_mfma_f32_16x16x32_bf16 v[96:99], v[196:199], v[16:19], v[96:99]
    v_exp_f32 v87, v87
    v_fma_f32 v80, v80, v9, v9
    v_fma_f32 v81, v81, v9, v9
    v_mfma_f32_16x16x32_bf16 v[100:103], v[196:199], v[20:23], v[100:103]
    v_fma_f32 v82, v82, v9, v9
    v_fma_f32 v83, v83, v9, v9
    v_fma_f32 v84, v84, v10, v10
    s_waitcnt lgkmcnt(2)
    v_mfma_f32_16x16x32_bf16 v[104:107], v[200:203], v[16:19], v[104:107]
    v_fma_f32 v85, v85, v10, v10
    v_fma_f32 v86, v86, v10, v10
    v_fma_f32 v87, v87, v10, v10
    v_mfma_f32_16x16x32_bf16 v[108:111], v[200:203], v[20:23], v[108:111]
    v_rcp_f32 v80, v80
    v_rcp_f32 v81, v81
    v_rcp_f32 v82, v82
    s_waitcnt lgkmcnt(1)
    v_mfma_f32_16x16x32_bf16 v[96:99], v[204:207], v[24:27], v[96:99]
    v_rcp_f32 v83, v83
    v_rcp_f32 v84, v84
    v_rcp_f32 v85, v85
    v_mfma_f32_16x16x32_bf16 v[100:103], v[204:207], v[28:31], v[100:103]
    v_rcp_f32 v86, v86
    v_rcp_f32 v87, v87
    v_mul_f32 v80, v80, v88
    s_waitcnt lgkmcnt(0)
    v_mfma_f32_16x16x32_bf16 v[104:107], v[172:175], v[24:27], v[104:107]
    v_mul_f32 v81, v81, v89
    v_mul_f32 v82, v82, v90
    v_mul_f32 v83, v83, v91
    v_mfma_f32_16x16x32_bf16 v[108:111], v[172:175], v[28:31], v[108:111]
    v_mul_f32 v84, v84, v92
    v_mul_f32 v85, v85, v93
    v_mul_f32 v86, v86, v94
    v_mfma_f32_16x16x16bf16_1k v[96:99], v[124:125], v[216:217], v[96:99]
    v_mul_f32 v87, v87, v95
    v_cvt_pk_bf16_f32 v36, v80, v81
    v_cvt_pk_bf16_f32 v37, v82, v83
    v_mfma_f32_16x16x16bf16_1k v[100:103], v[124:125], v[220:221], v[100:103]
    v_cvt_pk_bf16_f32 v38, v84, v85
    v_cvt_pk_bf16_f32 v39, v86, v87
    s_nop 1
    v_mfma_f32_16x16x16bf16_1k v[104:107], v[124:125], v[218:219], v[104:107]
    v_permlane16_swap_b32 v36, v38
    v_permlane16_swap_b32 v37, v39
    buffer_store_dwordx4 v[36:39], v6, s[8:11], s36 offen offset:512 sc1
    v_mfma_f32_16x16x16bf16_1k v[108:111], v[124:125], v[222:223], v[108:111]
    s_nop 5
    v_mul_f32 v96, v96, v7
    v_mul_f32 v97, v97, v7
    v_mul_f32 v98, v98, v7
    v_mul_f32 v99, v99, v7
    v_mul_f32 v100, v100, v8
    v_mul_f32 v101, v101, v8
    v_mul_f32 v102, v102, v8
    v_mul_f32 v103, v103, v8
    v_exp_f32 v96, v96
    v_exp_f32 v97, v97
    v_exp_f32 v98, v98
    v_exp_f32 v99, v99
    v_exp_f32 v100, v100
    v_exp_f32 v101, v101
    v_exp_f32 v102, v102
    v_exp_f32 v103, v103
    v_fma_f32 v96, v96, v9, v9
    v_fma_f32 v97, v97, v9, v9
    v_fma_f32 v98, v98, v9, v9
    v_fma_f32 v99, v99, v9, v9
    v_fma_f32 v100, v100, v10, v10
    v_fma_f32 v101, v101, v10, v10
    v_fma_f32 v102, v102, v10, v10
    v_fma_f32 v103, v103, v10, v10
    v_rcp_f32 v96, v96
    v_rcp_f32 v97, v97
    v_rcp_f32 v98, v98
    v_rcp_f32 v99, v99
    v_rcp_f32 v100, v100
    v_rcp_f32 v101, v101
    v_rcp_f32 v102, v102
    v_rcp_f32 v103, v103
    v_mul_f32 v96, v96, v104
    v_mul_f32 v97, v97, v105
    v_mul_f32 v98, v98, v106
    v_mul_f32 v99, v99, v107
    v_mul_f32 v100, v100, v108
    v_mul_f32 v101, v101, v109
    v_mul_f32 v102, v102, v110
    v_mul_f32 v103, v103, v111
    v_cvt_pk_bf16_f32 v40, v96, v97
    v_cvt_pk_bf16_f32 v41, v98, v99
    v_cvt_pk_bf16_f32 v42, v100, v101
    v_cvt_pk_bf16_f32 v43, v102, v103
    s_nop 1
    v_permlane16_swap_b32 v40, v42
    v_permlane16_swap_b32 v41, v43
    buffer_store_dwordx4 v[40:43], v6, s[8:11], s36 offen offset:1024 sc1
    s_waitcnt vmcnt(0)
    s_barrier
    s_cmp_lg_u32 s3, 0
    s_cbranch_scc1 sig_97
    s_lshl_b32 s60, s56, 7
    s_add_u32 s60, s60, 163840
    v_lshlrev_b32 v254, 2, v0
    v_mov_b32 v255, 1
    s_mov_b32 exec_hi, 0
    buffer_store_dword v255, v254, s[8:11], s60 offen sc1
    s_mov_b64 exec, -1
sig_97:
    v_lshlrev_b32 v4, 4, v0
    s_add_u32 m0, s63, 24576
    s_add_u32 s62, s58, 24576
    buffer_load_dwordx4 v4, s[8:11], s62 offen sc1 lds
    s_add_u32 m0, s63, 28672
    s_add_u32 s62, s58, 28672
    buffer_load_dwordx4 v4, s[8:11], s62 offen sc1 lds
    s_add_u32 m0, s63, 32768
    s_add_u32 s62, s58, 32768
    buffer_load_dwordx4 v4, s[8:11], s62 offen sc1 lds
    s_add_u32 m0, s63, 36864
    s_add_u32 s62, s58, 36864
    buffer_load_dwordx4 v4, s[8:11], s62 offen sc1 lds
    s_add_u32 m0, s63, 40960
    s_add_u32 s62, s58, 40960
    buffer_load_dwordx4 v4, s[8:11], s62 offen sc1 lds
    s_add_u32 m0, s63, 45056
    s_add_u32 s62, s58, 45056
    buffer_load_dwordx4 v4, s[8:11], s62 offen sc1 lds
    s_add_u32 m0, s63, 49152
    s_add_u32 s62, s58, 49152
    buffer_load_dwordx4 v4, s[8:11], s62 offen sc1 lds
    s_add_u32 m0, s63, 53248
    s_add_u32 s62, s58, 53248
    buffer_load_dwordx4 v4, s[8:11], s62 offen sc1 lds
    s_add_u32 m0, s63, 57344
    s_add_u32 s62, s58, 57344
    buffer_load_dwordx4 v4, s[8:11], s62 offen sc1 lds
    s_add_u32 m0, s63, 61440
    s_add_u32 s62, s58, 61440
    buffer_load_dwordx4 v4, s[8:11], s62 offen sc1 lds
    s_add_u32 m0, s63, 65536
    s_add_u32 s62, s58, 65536
    buffer_load_dwordx4 v4, s[8:11], s62 offen sc1 lds
    s_add_u32 m0, s63, 69632
    s_add_u32 s62, s58, 69632
    buffer_load_dwordx4 v4, s[8:11], s62 offen sc1 lds
    v_lshlrev_b32 v4, 4, v0
    s_lshl_b32 s28, s4, 2
    s_add_u32 s28, s28, s43
    s_lshl2_add_u32 s28, s28, s45
    s_mul_i32 s36, s28, 55296
    s_mul_i32 s29, s46, 27648
    s_add_u32 s36, s36, s29
    s_add_u32 s36, s36, 18874368
    s_mul_i32 s34, s28, 20480
    s_mul_i32 s29, s44, 160
    s_add_u32 s34, s34, s29
    s_mul_i32 s35, s28, 20480
    s_mul_i32 s30, s44, 2560
    s_add_u32 s35, s35, s30
    s_add_u32 s35, s35, 15728640
    v_and_b32 v1, 15, v0
    v_lshrrev_b32 v10, 4, v0
    v_mul_u32_u24 v11, 1280, v1
    s_lshl_b32 s30, s46, 6
    v_lshl_add_u32 v5, v10, 4, v11
    v_add_u32 v5, s30, v5
    v_lshl_add_u32 v6, v10, 3, v11
    v_add_u32 v6, 128, v6
    v_lshlrev_b32 v11, 4, v1
    s_lshl_b32 s30, s46, 10
    v_add_u32 v7, s30, v4
    v_lshrrev_b32 v12, 1, v10
    v_lshl_add_u32 v8, v12, 8, v11
    v_and_b32 v12, 1, v10
    v_lshl_add_u32 v8, v12, 3, v8
    v_add_u32 v8, 2048, v8
    s_lshl_b32 s30, s45, 10
    s_sub_u32 s31, s59, s30
    v_add_u32 v2, s31, v4
    s_sub_u32 s31, s63, s30
    s_add_u32 s31, s31, 24576
    v_add_u32 v3, s31, v4
    v_add_u32 v14, 40960, v3
    s_mov_b32 s20, s82
    s_mov_b32 s21, s83
    s_mov_b32 s22, 0x280000
    s_mov_b32 s23, 0x20000
    v_and_b32 v10, 15, v0
    v_lshlrev_b32 v10, 7, v10
    s_lshr_b32 s57, s43, 1
    s_lshl1_add_u32 s57, s4, s57
    s_lshl_b32 s57, s57, 11
    s_add_u32 s57, s57, 163840
    v_pk_add_f32 v[228:229], v[228:229], v[240:241]
    v_pk_add_f32 v[230:231], v[230:231], v[242:243]
    v_pk_add_f32 v[232:233], v[232:233], v[244:245]
    v_pk_add_f32 v[234:235], v[234:235], v[246:247]
    v_pk_add_f32 v[236:237], v[236:237], v[54:55]
    v_pk_add_f32 v[238:239], v[238:239], v[56:57]
    v_cvt_pk_bf16_f32 v1, v228, v229
    v_lshlrev_b32 v228, 16, v1
    v_and_b32 v229, 0xffff0000, v1
    v_cvt_pk_bf16_f32 v1, v230, v231
    v_lshlrev_b32 v230, 16, v1
    v_and_b32 v231, 0xffff0000, v1
    v_cvt_pk_bf16_f32 v1, v232, v233
    v_lshlrev_b32 v232, 16, v1
    v_and_b32 v233, 0xffff0000, v1
    v_cvt_pk_bf16_f32 v1, v234, v235
    v_lshlrev_b32 v234, 16, v1
    v_and_b32 v235, 0xffff0000, v1
    v_cvt_pk_bf16_f32 v1, v236, v237
    v_lshlrev_b32 v236, 16, v1
    v_and_b32 v237, 0xffff0000, v1
    v_cvt_pk_bf16_f32 v1, v238, v239
    v_lshlrev_b32 v238, 16, v1
    v_and_b32 v239, 0xffff0000, v1
    s_mul_i32 s28, s45, 3072
    s_add_u32 s28, s28, 36864
    s_mul_i32 s29, s46, 106496
    s_sub_u32 s30, 106496, s29
    s_add_u32 s29, s29, s28
    s_add_u32 s30, s30, s28
    v_add_u32 v16, s29, v4
    v_add_u32 v17, s30, v4
    v_lshlrev_b32 v18, 16, v248
    v_and_b32 v19, 0xffff0000, v248
    v_lshlrev_b32 v20, 16, v249
    v_and_b32 v21, 0xffff0000, v249
    v_lshlrev_b32 v22, 16, v250
    v_and_b32 v23, 0xffff0000, v250
    v_lshlrev_b32 v24, 16, v251
    v_and_b32 v25, 0xffff0000, v251
    v_lshlrev_b32 v26, 16, v252
    v_and_b32 v27, 0xffff0000, v252
    v_lshlrev_b32 v28, 16, v253
    v_and_b32 v29, 0xffff0000, v253
    s_cmp_lg_u32 s3, 0
    s_cbranch_scc1 polle_99
    s_mov_b32 s61, 0
poll_98:
    buffer_load_dword v11, v10, s[8:11], s57 offen sc1
    s_add_u32 s61, s61, 1
    s_cmp_gt_u32 s61, 262144
    s_waitcnt vmcnt(0)
    s_cbranch_scc1 polle_99
    v_cmp_ne_u32 vcc, 1, v11
    s_cbranch_vccnz poll_98
polle_99:
    s_barrier
    buffer_load_dwordx4 v[32:35], v4, s[8:11], s36 offen offset:0 sc1
    buffer_load_dwordx4 v[36:39], v4, s[8:11], s36 offen offset:1024 sc1
    s_barrier
    buffer_load_dwordx4 v[40:43], v4, s[8:11], s36 offen offset:2048 sc1
    buffer_load_dwordx4 v[44:47], v4, s[8:11], s36 offen offset:3072 sc1
    ds_read_b128 v[160:163], v2 offset:0
    ds_read_b128 v[164:167], v2 offset:1024
    ds_read_b128 v[168:171], v2 offset:2048
    ds_read_b128 v[172:175], v2 offset:3072
    ds_read_b128 v[176:179], v2 offset:4096
    ds_read_b128 v[180:183], v2 offset:5120
    ds_read_b128 v[184:187], v2 offset:6144
    ds_read_b128 v[188:191], v2 offset:7168
    ds_read_b128 v[192:195], v2 offset:8192
    ds_read_b128 v[196:199], v2 offset:9216
    s_waitcnt vmcnt(3) lgkmcnt(9)
    v_mfma_f32_16x16x32_bf16 v[140:143], v[160:163], v[32:35], 0
    ds_read_b128 v[200:203], v2 offset:10240
    s_waitcnt lgkmcnt(9)
    v_mfma_f32_16x16x32_bf16 v[144:147], v[164:167], v[32:35], 0
    ds_read_b128 v[204:207], v2 offset:11264
    s_add_u32 s36, s36, 4096
    buffer_load_dwordx4 v[48:51], v4, s[8:11], s36 offen offset:0 sc1
    s_waitcnt lgkmcnt(9)
    v_mfma_f32_16x16x32_bf16 v[148:151], v[168:171], v[32:35], 0
    ds_read_b128 v[208:211], v2 offset:12288
    s_waitcnt lgkmcnt(9)
    v_mfma_f32_16x16x32_bf16 v[152:155], v[172:175], v[32:35], 0
    ds_read_b128 v[212:215], v2 offset:13312
    s_add_u32 m0, s63, 73728
    s_add_u32 s62, s58, 73728
    buffer_load_dwordx4 v4, s[8:11], s62 offen sc1 lds
    s_waitcnt lgkmcnt(9)
    v_mfma_f32_16x16x32_bf16 v[156:159], v[176:179], v[32:35], 0
    ds_read_b128 v[216:219], v2 offset:14336
    s_waitcnt vmcnt(4) lgkmcnt(9)
    v_mfma_f32_16x16x32_bf16 v[140:143], v[180:183], v[36:39], v[140:143]
    ds_read_b128 v[160:163], v2 offset:15360
    s_waitcnt lgkmcnt(9)
    v_mfma_f32_16x16x32_bf16 v[144:147], v[184:187], v[36:39], v[144:147]
    ds_read_b128 v[164:167], v2 offset:16384
    buffer_load_dwordx4 v[52:55], v4, s[8:11], s36 offen offset:1024 sc1
    s_waitcnt lgkmcnt(9)
    v_mfma_f32_16x16x32_bf16 v[148:151], v[188:191], v[36:39], v[148:151]
    ds_read_b128 v[168:171], v2 offset:17408
    s_waitcnt lgkmcnt(9)
    v_mfma_f32_16x16x32_bf16 v[152:155], v[192:195], v[36:39], v[152:155]
    ds_read_b128 v[172:175], v2 offset:18432
    s_add_u32 m0, s63, 77824
    s_add_u32 s62, s58, 77824
    buffer_load_dwordx4 v4, s[8:11], s62 offen sc1 lds
    s_waitcnt lgkmcnt(9)
    v_mfma_f32_16x16x32_bf16 v[156:159], v[196:199], v[36:39], v[156:159]
    ds_read_b128 v[176:179], v2 offset:19456
    s_waitcnt vmcnt(5) lgkmcnt(9)
    v_mfma_f32_16x16x32_bf16 v[140:143], v[200:203], v[40:43], v[140:143]
    s_waitcnt lgkmcnt(5)
    s_barrier
    ds_read_b128 v[180:183], v2 offset:20480
    v_mfma_f32_16x16x32_bf16 v[144:147], v[204:207], v[40:43], v[144:147]
    ds_read_b128 v[184:187], v2 offset:21504
    buffer_load_dwordx4 v[56:59], v4, s[8:11], s36 offen offset:2048 sc1
    v_mfma_f32_16x16x32_bf16 v[148:151], v[208:211], v[40:43], v[148:151]
    ds_read_b128 v[188:191], v2 offset:22528
    v_mfma_f32_16x16x32_bf16 v[152:155], v[212:215], v[40:43], v[152:155]
    ds_read_b128 v[192:195], v2 offset:23552
    s_add_u32 m0, s59, 0
    s_add_u32 s62, s58, 81920
    buffer_load_dwordx4 v4, s[8:11], s62 offen sc1 lds
    v_mfma_f32_16x16x32_bf16 v[156:159], v[216:219], v[40:43], v[156:159]
    ds_read_b128 v[196:199], v3 offset:0
    s_waitcnt vmcnt(6) lgkmcnt(9)
    v_mfma_f32_16x16x32_bf16 v[140:143], v[160:163], v[44:47], v[140:143]
    ds_read_b128 v[200:203], v3 offset:1024
    s_waitcnt lgkmcnt(9)
    v_mfma_f32_16x16x32_bf16 v[144:147], v[164:167], v[44:47], v[144:147]
    ds_read_b128 v[204:207], v3 offset:2048
    buffer_load_dwordx4 v[60:63], v4, s[8:11], s36 offen offset:3072 sc1
    s_waitcnt lgkmcnt(9)
    v_mfma_f32_16x16x32_bf16 v[148:151], v[168:171], v[44:47], v[148:151]
    ds_read_b128 v[208:211], v3 offset:3072
    s_waitcnt lgkmcnt(9)
    v_mfma_f32_16x16x32_bf16 v[152:155], v[172:175], v[44:47], v[152:155]
    ds_read_b128 v[212:215], v3 offset:4096
    s_add_u32 m0, s59, 4096
    s_add_u32 s62, s58, 86016
    buffer_load_dwordx4 v4, s[8:11], s62 offen sc1 lds
    s_waitcnt lgkmcnt(9)
    v_mfma_f32_16x16x32_bf16 v[156:159], v[176:179], v[44:47], v[156:159]
    ds_read_b128 v[216:219], v3 offset:5120
    s_waitcnt vmcnt(7) lgkmcnt(9)
    v_mfma_f32_16x16x32_bf16 v[140:143], v[180:183], v[48:51], v[140:143]
    ds_read_b128 v[160:163], v3 offset:6144
    s_waitcnt lgkmcnt(9)
    v_mfma_f32_16x16x32_bf16 v[144:147], v[184:187], v[48:51], v[144:147]
    ds_read_b128 v[164:167], v3 offset:7168
    s_add_u32 s36, s36, 4096
    buffer_load_dwordx4 v[64:67], v4, s[8:11], s36 offen offset:0 sc1
    s_waitcnt lgkmcnt(9)
    v_mfma_f32_16x16x32_bf16 v[148:151], v[188:191], v[48:51], v[148:151]
    ds_read_b128 v[168:171], v3 offset:8192
    s_waitcnt lgkmcnt(9)
    v_mfma_f32_16x16x32_bf16 v[152:155], v[192:195], v[48:51], v[152:155]
    ds_read_b128 v[172:175], v3 offset:9216
    s_add_u32 m0, s59, 8192
    s_add_u32 s62, s58, 90112
    buffer_load_dwordx4 v4, s[8:11], s62 offen sc1 lds
    s_waitcnt lgkmcnt(9)
    v_mfma_f32_16x16x32_bf16 v[156:159], v[196:199], v[48:51], v[156:159]
    ds_read_b128 v[176:179], v3 offset:10240
    s_waitcnt vmcnt(7) lgkmcnt(9)
    v_mfma_f32_16x16x32_bf16 v[140:143], v[200:203], v[52:55], v[140:143]
    ds_read_b128 v[180:183], v3 offset:11264
    s_waitcnt lgkmcnt(9)
    v_mfma_f32_16x16x32_bf16 v[144:147], v[204:207], v[52:55], v[144:147]
    ds_read_b128 v[184:187], v3 offset:12288
    buffer_load_dwordx4 v[68:71], v4, s[8:11], s36 offen offset:1024 sc1
    s_waitcnt lgkmcnt(9)
    v_mfma_f32_16x16x32_bf16 v[148:151], v[208:211], v[52:55], v[148:151]
    ds_read_b128 v[188:191], v3 offset:13312
    s_waitcnt lgkmcnt(9)
    v_mfma_f32_16x16x32_bf16 v[152:155], v[212:215], v[52:55], v[152:155]
    ds_read_b128 v[192:195], v3 offset:14336
    buffer_load_dwordx4 v[72:75], v4, s[8:11], s36 offen offset:2048 sc1
    s_waitcnt lgkmcnt(9)
    v_mfma_f32_16x16x32_bf16 v[156:159], v[216:219], v[52:55], v[156:159]
    ds_read_b128 v[196:199], v3 offset:15360
    s_waitcnt vmcnt(7) lgkmcnt(9)
    v_mfma_f32_16x16x32_bf16 v[140:143], v[160:163], v[56:59], v[140:143]
    s_waitcnt lgkmcnt(5)
    s_barrier
    ds_read_b128 v[200:203], v3 offset:16384
    v_mfma_f32_16x16x32_bf16 v[144:147], v[164:167], v[56:59], v[144:147]
    ds_read_b128 v[204:207], v3 offset:17408
    buffer_load_dwordx4 v[76:79], v4, s[8:11], s36 offen offset:3072 sc1
    v_mfma_f32_16x16x32_bf16 v[148:151], v[168:171], v[56:59], v[148:151]
    ds_read_b128 v[208:211], v3 offset:18432
    v_mfma_f32_16x16x32_bf16 v[152:155], v[172:175], v[56:59], v[152:155]
    ds_read_b128 v[212:215], v3 offset:19456
    s_add_u32 m0, s59, 12288
    s_add_u32 s62, s58, 94208
    buffer_load_dwordx4 v4, s[8:11], s62 offen sc1 lds
    v_mfma_f32_16x16x32_bf16 v[156:159], v[176:179], v[56:59], v[156:159]
    ds_read_b128 v[216:219], v3 offset:20480
    s_waitcnt vmcnt(7) lgkmcnt(9)
    v_mfma_f32_16x16x32_bf16 v[140:143], v[180:183], v[60:63], v[140:143]
    ds_read_b128 v[160:163], v3 offset:21504
    s_waitcnt lgkmcnt(9)
    v_mfma_f32_16x16x32_bf16 v[144:147], v[184:187], v[60:63], v[144:147]
    ds_read_b128 v[164:167], v3 offset:22528
    s_add_u32 s36, s36, 4096
    buffer_load_dwordx4 v[80:83], v4, s[8:11], s36 offen offset:0 sc1
    s_waitcnt lgkmcnt(9)
    v_mfma_f32_16x16x32_bf16 v[148:151], v[188:191], v[60:63], v[148:151]
    ds_read_b128 v[168:171], v3 offset:23552
    s_waitcnt lgkmcnt(9)
    v_mfma_f32_16x16x32_bf16 v[152:155], v[192:195], v[60:63], v[152:155]
    ds_read_b128 v[172:175], v3 offset:24576
    s_add_u32 m0, s59, 16384
    s_add_u32 s62, s58, 98304
    buffer_load_dwordx4 v4, s[8:11], s62 offen sc1 lds
    s_waitcnt lgkmcnt(9)
    v_mfma_f32_16x16x32_bf16 v[156:159], v[196:199], v[60:63], v[156:159]
    ds_read_b128 v[176:179], v3 offset:25600
    s_waitcnt vmcnt(7) lgkmcnt(9)
    v_mfma_f32_16x16x32_bf16 v[140:143], v[200:203], v[64:67], v[140:143]
    ds_read_b128 v[180:183], v3 offset:26624
    s_waitcnt lgkmcnt(9)
    v_mfma_f32_16x16x32_bf16 v[144:147], v[204:207], v[64:67], v[144:147]
    ds_read_b128 v[184:187], v3 offset:27648
    buffer_load_dwordx4 v[84:87], v4, s[8:11], s36 offen offset:1024 sc1
    s_waitcnt lgkmcnt(9)
    v_mfma_f32_16x16x32_bf16 v[148:151], v[208:211], v[64:67], v[148:151]
    ds_read_b128 v[188:191], v3 offset:28672
    s_waitcnt lgkmcnt(9)
    v_mfma_f32_16x16x32_bf16 v[152:155], v[212:215], v[64:67], v[152:155]
    ds_read_b128 v[192:195], v3 offset:29696
    s_add_u32 m0, s59, 20480
    s_add_u32 s62, s58, 102400
    buffer_load_dwordx4 v4, s[8:11], s62 offen sc1 lds
    s_waitcnt lgkmcnt(9)
    v_mfma_f32_16x16x32_bf16 v[156:159], v[216:219], v[64:67], v[156:159]
    ds_read_b128 v[196:199], v3 offset:30720
    s_waitcnt vmcnt(7) lgkmcnt(9)
    v_mfma_f32_16x16x32_bf16 v[140:143], v[160:163], v[68:71], v[140:143]
    ds_read_b128 v[200:203], v3 offset:31744
    s_waitcnt lgkmcnt(9)
    v_mfma_f32_16x16x32_bf16 v[144:147], v[164:167], v[68:71], v[144:147]
    ds_read_b128 v[204:207], v3 offset:32768
    buffer_load_dwordx4 v[88:91], v4, s[8:11], s36 offen offset:2048 sc1
    s_waitcnt lgkmcnt(9)
    v_mfma_f32_16x16x32_bf16 v[148:151], v[168:171], v[68:71], v[148:151]
    ds_read_b128 v[208:211], v3 offset:33792
    s_waitcnt lgkmcnt(9)
    v_mfma_f32_16x16x32_bf16 v[152:155], v[172:175], v[68:71], v[152:155]
    ds_read_b128 v[212:215], v3 offset:34816
    s_add_u32 m0, s63, 24576
    s_add_u32 s62, s58, 106496
    buffer_load_dwordx4 v4, s[8:11], s62 offen sc1 lds
    s_waitcnt lgkmcnt(9)
    v_mfma_f32_16x16x32_bf16 v[156:159], v[176:179], v[68:71], v[156:159]
    ds_read_b128 v[216:219], v3 offset:35840
    s_waitcnt vmcnt(8) lgkmcnt(9)
    v_mfma_f32_16x16x32_bf16 v[140:143], v[180:183], v[72:75], v[140:143]
    s_waitcnt lgkmcnt(5)
    s_barrier
    ds_read_b128 v[160:163], v3 offset:36864
    v_mfma_f32_16x16x32_bf16 v[144:147], v[184:187], v[72:75], v[144:147]
    ds_read_b128 v[164:167], v3 offset:37888
    buffer_load_dwordx4 v[92:95], v4, s[8:11], s36 offen offset:3072 sc1
    v_mfma_f32_16x16x32_bf16 v[148:151], v[188:191], v[72:75], v[148:151]
    ds_read_b128 v[168:171], v3 offset:38912
    v_mfma_f32_16x16x32_bf16 v[152:155], v[192:195], v[72:75], v[152:155]
    ds_read_b128 v[172:175], v3 offset:39936
    s_add_u32 m0, s63, 28672
    s_add_u32 s62, s58, 110592
    buffer_load_dwordx4 v4, s[8:11], s62 offen sc1 lds
    v_mfma_f32_16x16x32_bf16 v[156:159], v[196:199], v[72:75], v[156:159]
    ds_read_b128 v[176:179], v14 offset:0
    s_waitcnt vmcnt(9) lgkmcnt(9)
    v_mfma_f32_16x16x32_bf16 v[140:143], v[200:203], v[76:79], v[140:143]
    ds_read_b128 v[180:183], v14 offset:1024
    s_waitcnt lgkmcnt(9)
    v_mfma_f32_16x16x32_bf16 v[144:147], v[204:207], v[76:79], v[144:147]
    ds_read_b128 v[184:187], v14 offset:2048
    s_add_u32 s36, s36, 4096
    buffer_load_dwordx4 v[96:99], v4, s[8:11], s36 offen offset:0 sc1
    s_waitcnt lgkmcnt(9)
    v_mfma_f32_16x16x32_bf16 v[148:151], v[208:211], v[76:79], v[148:151]
    ds_read_b128 v[188:191], v14 offset:3072
    s_waitcnt lgkmcnt(9)
    v_mfma_f32_16x16x32_bf16 v[152:155], v[212:215], v[76:79], v[152:155]
    ds_read_b128 v[192:195], v14 offset:4096
    s_add_u32 m0, s63, 32768
    s_add_u32 s62, s58, 114688
    buffer_load_dwordx4 v4, s[8:11], s62 offen sc1 lds
    s_waitcnt lgkmcnt(9)
    v_mfma_f32_16x16x32_bf16 v[156:159], v[216:219], v[76:79], v[156:159]
    ds_read_b128 v[196:199], v14 offset:5120
    s_waitcnt vmcnt(9) lgkmcnt(9)
    v_mfma_f32_16x16x32_bf16 v[140:143], v[160:163], v[80:83], v[140:143]
    ds_read_b128 v[200:203], v14 offset:6144
    s_waitcnt lgkmcnt(9)
    v_mfma_f32_16x16x32_bf16 v[144:147], v[164:167], v[80:83], v[144:147]
    ds_read_b128 v[204:207], v14 offset:7168
    buffer_load_dwordx4 v[100:103], v4, s[8:11], s36 offen offset:1024 sc1
    s_waitcnt lgkmcnt(9)
    v_mfma_f32_16x16x32_bf16 v[148:151], v[168:171], v[80:83], v[148:151]
    ds_read_b128 v[208:211], v14 offset:8192
    s_waitcnt lgkmcnt(9)
    v_mfma_f32_16x16x32_bf16 v[152:155], v[172:175], v[80:83], v[152:155]
    ds_read_b128 v[212:215], v14 offset:9216
    s_add_u32 m0, s63, 36864
    s_add_u32 s62, s58, 118784
    buffer_load_dwordx4 v4, s[8:11], s62 offen sc1 lds
    s_waitcnt lgkmcnt(9)
    v_mfma_f32_16x16x32_bf16 v[156:159], v[176:179], v[80:83], v[156:159]
    ds_read_b128 v[216:219], v14 offset:10240
    s_waitcnt vmcnt(9) lgkmcnt(9)
    v_mfma_f32_16x16x32_bf16 v[140:143], v[180:183], v[84:87], v[140:143]
    ds_read_b128 v[160:163], v14 offset:11264
    s_waitcnt lgkmcnt(9)
    v_mfma_f32_16x16x32_bf16 v[144:147], v[184:187], v[84:87], v[144:147]
    ds_read_b128 v[164:167], v14 offset:12288
    buffer_load_dwordx4 v[104:107], v4, s[8:11], s36 offen offset:2048 sc1
    s_waitcnt lgkmcnt(9)
    v_mfma_f32_16x16x32_bf16 v[148:151], v[188:191], v[84:87], v[148:151]
    ds_read_b128 v[168:171], v14 offset:13312
    s_waitcnt lgkmcnt(9)
    v_mfma_f32_16x16x32_bf16 v[152:155], v[192:195], v[84:87], v[152:155]
    ds_read_b128 v[172:175], v14 offset:14336
    s_add_u32 m0, s63, 40960
    s_add_u32 s62, s58, 122880
    buffer_load_dwordx4 v4, s[8:11], s62 offen sc1 lds
    s_waitcnt lgkmcnt(9)
    v_mfma_f32_16x16x32_bf16 v[156:159], v[196:199], v[84:87], v[156:159]
    ds_read_b128 v[176:179], v14 offset:15360
    s_waitcnt vmcnt(9) lgkmcnt(9)
    v_mfma_f32_16x16x32_bf16 v[140:143], v[200:203], v[88:91], v[140:143]
    s_waitcnt lgkmcnt(5)
    s_barrier
    ds_read_b128 v[180:183], v2 offset:0
    v_mfma_f32_16x16x32_bf16 v[144:147], v[204:207], v[88:91], v[144:147]
    ds_read_b128 v[184:187], v2 offset:1024
    buffer_load_dwordx4 v[108:111], v4, s[8:11], s36 offen offset:3072 sc1
    v_mfma_f32_16x16x32_bf16 v[148:151], v[208:211], v[88:91], v[148:151]
    ds_read_b128 v[188:191], v2 offset:2048
    v_mfma_f32_16x16x32_bf16 v[152:155], v[212:215], v[88:91], v[152:155]
    ds_read_b128 v[192:195], v2 offset:3072
    s_add_u32 m0, s63, 45056
    s_add_u32 s62, s58, 126976
    buffer_load_dwordx4 v4, s[8:11], s62 offen sc1 lds
    v_mfma_f32_16x16x32_bf16 v[156:159], v[216:219], v[88:91], v[156:159]
    ds_read_b128 v[196:199], v2 offset:4096
    s_waitcnt vmcnt(9) lgkmcnt(9)
    v_mfma_f32_16x16x32_bf16 v[140:143], v[160:163], v[92:95], v[140:143]
    ds_read_b128 v[200:203], v2 offset:5120
    s_waitcnt lgkmcnt(9)
    v_mfma_f32_16x16x32_bf16 v[144:147], v[164:167], v[92:95], v[144:147]
    ds_read_b128 v[204:207], v2 offset:6144
    s_add_u32 s36, s36, 4096
    buffer_load_dwordx4 v[112:115], v4, s[8:11], s36 offen offset:0 sc1
    s_waitcnt lgkmcnt(9)
    v_mfma_f32_16x16x32_bf16 v[148:151], v[168:171], v[92:95], v[148:151]
    ds_read_b128 v[208:211], v2 offset:7168
    s_waitcnt lgkmcnt(9)
    v_mfma_f32_16x16x32_bf16 v[152:155], v[172:175], v[92:95], v[152:155]
    ds_read_b128 v[212:215], v2 offset:8192
    s_add_u32 m0, s63, 49152
    s_add_u32 s62, s58, 131072
    buffer_load_dwordx4 v4, s[8:11], s62 offen sc1 lds
    s_waitcnt lgkmcnt(9)
    v_mfma_f32_16x16x32_bf16 v[156:159], v[176:179], v[92:95], v[156:159]
    ds_read_b128 v[216:219], v2 offset:9216
    s_waitcnt vmcnt(9) lgkmcnt(9)
    v_mfma_f32_16x16x32_bf16 v[140:143], v[180:183], v[96:99], v[140:143]
    ds_read_b128 v[160:163], v2 offset:10240
    s_waitcnt lgkmcnt(9)
    v_mfma_f32_16x16x32_bf16 v[144:147], v[184:187], v[96:99], v[144:147]
    ds_read_b128 v[164:167], v2 offset:11264
    buffer_load_dwordx4 v[116:119], v4, s[8:11], s36 offen offset:1024 sc1
    s_waitcnt lgkmcnt(9)
    v_mfma_f32_16x16x32_bf16 v[148:151], v[188:191], v[96:99], v[148:151]
    ds_read_b128 v[168:171], v2 offset:12288
    s_waitcnt lgkmcnt(9)
    v_mfma_f32_16x16x32_bf16 v[152:155], v[192:195], v[96:99], v[152:155]
    ds_read_b128 v[172:175], v2 offset:13312
    s_add_u32 m0, s63, 53248
    s_add_u32 s62, s58, 135168
    buffer_load_dwordx4 v4, s[8:11], s62 offen sc1 lds
    s_waitcnt lgkmcnt(9)
    v_mfma_f32_16x16x32_bf16 v[156:159], v[196:199], v[96:99], v[156:159]
    ds_read_b128 v[176:179], v2 offset:14336
    s_waitcnt vmcnt(9) lgkmcnt(9)
    v_mfma_f32_16x16x32_bf16 v[140:143], v[200:203], v[100:103], v[140:143]
    ds_read_b128 v[180:183], v2 offset:15360
    s_waitcnt lgkmcnt(9)
    v_mfma_f32_16x16x32_bf16 v[144:147], v[204:207], v[100:103], v[144:147]
    ds_read_b128 v[184:187], v2 offset:16384
    buffer_load_dwordx4 v[120:123], v4, s[8:11], s36 offen offset:2048 sc1
    s_waitcnt lgkmcnt(9)
    v_mfma_f32_16x16x32_bf16 v[148:151], v[208:211], v[100:103], v[148:151]
    ds_read_b128 v[188:191], v2 offset:17408
    s_waitcnt lgkmcnt(9)
    v_mfma_f32_16x16x32_bf16 v[152:155], v[212:215], v[100:103], v[152:155]
    ds_read_b128 v[192:195], v2 offset:18432
    buffer_load_dwordx4 v[124:127], v4, s[8:11], s36 offen offset:3072 sc1
    s_waitcnt lgkmcnt(9)
    v_mfma_f32_16x16x32_bf16 v[156:159], v[216:219], v[100:103], v[156:159]
    ds_read_b128 v[196:199], v2 offset:19456
    s_waitcnt vmcnt(9) lgkmcnt(9)
    v_mfma_f32_16x16x32_bf16 v[140:143], v[160:163], v[104:107], v[140:143]
    s_waitcnt lgkmcnt(5)
    s_barrier
    ds_read_b128 v[200:203], v2 offset:20480
    v_mfma_f32_16x16x32_bf16 v[144:147], v[164:167], v[104:107], v[144:147]
    ds_read_b128 v[204:207], v2 offset:21504
    s_add_u32 s36, s36, 4096
    buffer_load_dwordx4 v[128:131], v4, s[8:11], s36 offen offset:0 sc1
    v_mfma_f32_16x16x32_bf16 v[148:151], v[168:171], v[104:107], v[148:151]
    ds_read_b128 v[208:211], v2 offset:22528
    v_mfma_f32_16x16x32_bf16 v[152:155], v[172:175], v[104:107], v[152:155]
    ds_read_b128 v[212:215], v2 offset:23552
    buffer_load_dwordx4 v[132:135], v4, s[8:11], s36 offen offset:1024 sc1
    v_mfma_f32_16x16x32_bf16 v[156:159], v[176:179], v[104:107], v[156:159]
    ds_read_b128 v[216:219], v3 offset:0
    s_waitcnt vmcnt(9) lgkmcnt(9)
    v_mfma_f32_16x16x32_bf16 v[140:143], v[180:183], v[108:111], v[140:143]
    ds_read_b128 v[160:163], v3 offset:1024
    s_waitcnt lgkmcnt(9)
    v_mfma_f32_16x16x32_bf16 v[144:147], v[184:187], v[108:111], v[144:147]
    ds_read_b128 v[164:167], v3 offset:2048
    buffer_load_dwordx4 v[136:139], v4, s[8:11], s36 offen offset:2048 sc1
    s_waitcnt lgkmcnt(9)
    v_mfma_f32_16x16x32_bf16 v[148:151], v[188:191], v[108:111], v[148:151]
    ds_read_b128 v[168:171], v3 offset:3072
    s_waitcnt lgkmcnt(9)
    v_mfma_f32_16x16x32_bf16 v[152:155], v[192:195], v[108:111], v[152:155]
    ds_read_b128 v[172:175], v3 offset:4096
    s_waitcnt lgkmcnt(9)
    v_mfma_f32_16x16x32_bf16 v[156:159], v[196:199], v[108:111], v[156:159]
    ds_read_b128 v[176:179], v3 offset:5120
    s_waitcnt vmcnt(8) lgkmcnt(9)
    v_mfma_f32_16x16x32_bf16 v[140:143], v[200:203], v[112:115], v[140:143]
    ds_read_b128 v[180:183], v3 offset:6144
    s_waitcnt lgkmcnt(9)
    v_mfma_f32_16x16x32_bf16 v[144:147], v[204:207], v[112:115], v[144:147]
    ds_read_b128 v[184:187], v3 offset:7168
    s_waitcnt lgkmcnt(9)
    v_mfma_f32_16x16x32_bf16 v[148:151], v[208:211], v[112:115], v[148:151]
    ds_read_b128 v[188:191], v3 offset:8192
    s_waitcnt lgkmcnt(9)
    v_mfma_f32_16x16x32_bf16 v[152:155], v[212:215], v[112:115], v[152:155]
    ds_read_b128 v[192:195], v3 offset:9216
    s_waitcnt lgkmcnt(9)
    v_mfma_f32_16x16x32_bf16 v[156:159], v[216:219], v[112:115], v[156:159]
    ds_read_b128 v[196:199], v3 offset:10240
    s_waitcnt vmcnt(6) lgkmcnt(9)
    v_mfma_f32_16x16x32_bf16 v[140:143], v[160:163], v[116:119], v[140:143]
    ds_read_b128 v[200:203], v3 offset:11264
    s_waitcnt lgkmcnt(9)
    v_mfma_f32_16x16x32_bf16 v[144:147], v[164:167], v[116:119], v[144:147]
    ds_read_b128 v[204:207], v3 offset:12288
    s_waitcnt lgkmcnt(9)
    v_mfma_f32_16x16x32_bf16 v[148:151], v[168:171], v[116:119], v[148:151]
    ds_read_b128 v[208:211], v3 offset:13312
    s_waitcnt lgkmcnt(9)
    v_mfma_f32_16x16x32_bf16 v[152:155], v[172:175], v[116:119], v[152:155]
    ds_read_b128 v[212:215], v3 offset:14336
    s_waitcnt lgkmcnt(9)
    v_mfma_f32_16x16x32_bf16 v[156:159], v[176:179], v[116:119], v[156:159]
    ds_read_b128 v[216:219], v3 offset:15360
    s_waitcnt vmcnt(4) lgkmcnt(9)
    v_mfma_f32_16x16x32_bf16 v[140:143], v[180:183], v[120:123], v[140:143]
    s_waitcnt lgkmcnt(5)
    s_barrier
    ds_read_b128 v[160:163], v3 offset:16384
    v_mfma_f32_16x16x32_bf16 v[144:147], v[184:187], v[120:123], v[144:147]
    ds_read_b128 v[164:167], v3 offset:17408
    v_mfma_f32_16x16x32_bf16 v[148:151], v[188:191], v[120:123], v[148:151]
    ds_read_b128 v[168:171], v3 offset:18432
    v_mfma_f32_16x16x32_bf16 v[152:155], v[192:195], v[120:123], v[152:155]
    ds_read_b128 v[172:175], v3 offset:19456
    v_mfma_f32_16x16x32_bf16 v[156:159], v[196:199], v[120:123], v[156:159]
    ds_read_b128 v[176:179], v3 offset:20480
    s_waitcnt vmcnt(3) lgkmcnt(9)
    v_mfma_f32_16x16x32_bf16 v[140:143], v[200:203], v[124:127], v[140:143]
    ds_read_b128 v[180:183], v3 offset:21504
    s_waitcnt lgkmcnt(9)
    v_mfma_f32_16x16x32_bf16 v[144:147], v[204:207], v[124:127], v[144:147]
    ds_read_b128 v[184:187], v3 offset:22528
    s_waitcnt lgkmcnt(9)
    v_mfma_f32_16x16x32_bf16 v[148:151], v[208:211], v[124:127], v[148:151]
    ds_read_b128 v[188:191], v3 offset:23552
    s_waitcnt lgkmcnt(9)
    v_mfma_f32_16x16x32_bf16 v[152:155], v[212:215], v[124:127], v[152:155]
    ds_read_b128 v[192:195], v3 offset:24576
    s_waitcnt lgkmcnt(9)
    v_mfma_f32_16x16x32_bf16 v[156:159], v[216:219], v[124:127], v[156:159]
    ds_read_b128 v[196:199], v3 offset:25600
    s_waitcnt vmcnt(2) lgkmcnt(9)
    v_mfma_f32_16x16x32_bf16 v[140:143], v[160:163], v[128:131], v[140:143]
    ds_read_b128 v[200:203], v3 offset:26624
    s_waitcnt lgkmcnt(9)
    v_mfma_f32_16x16x32_bf16 v[144:147], v[164:167], v[128:131], v[144:147]
    ds_read_b128 v[204:207], v3 offset:27648
    s_waitcnt lgkmcnt(9)
    v_mfma_f32_16x16x32_bf16 v[148:151], v[168:171], v[128:131], v[148:151]
    ds_read_b128 v[208:211], v3 offset:28672
    s_waitcnt lgkmcnt(9)
    v_mfma_f32_16x16x32_bf16 v[152:155], v[172:175], v[128:131], v[152:155]
    ds_read_b128 v[212:215], v3 offset:29696
    s_waitcnt lgkmcnt(9)
    v_mfma_f32_16x16x32_bf16 v[156:159], v[176:179], v[128:131], v[156:159]
    ds_read_b128 v[216:219], v3 offset:30720
    s_waitcnt vmcnt(1) lgkmcnt(9)
    v_mfma_f32_16x16x32_bf16 v[140:143], v[180:183], v[132:135], v[140:143]
    s_waitcnt lgkmcnt(8)
    v_mfma_f32_16x16x32_bf16 v[144:147], v[184:187], v[132:135], v[144:147]
    s_waitcnt lgkmcnt(7)
    v_mfma_f32_16x16x32_bf16 v[148:151], v[188:191], v[132:135], v[148:151]
    s_waitcnt lgkmcnt(6)
    v_mfma_f32_16x16x32_bf16 v[152:155], v[192:195], v[132:135], v[152:155]
    s_waitcnt lgkmcnt(5)
    v_mfma_f32_16x16x32_bf16 v[156:159], v[196:199], v[132:135], v[156:159]
    s_waitcnt vmcnt(0) lgkmcnt(2)
    v_mfma_f32_16x16x32_bf16 v[148:151], v[208:211], v[136:139], v[148:151]
    s_waitcnt lgkmcnt(1)
    v_mfma_f32_16x16x32_bf16 v[152:155], v[212:215], v[136:139], v[152:155]
    s_waitcnt lgkmcnt(0)
    v_mfma_f32_16x16x32_bf16 v[156:159], v[216:219], v[136:139], v[156:159]
    v_mfma_f32_16x16x32_bf16 v[140:143], v[200:203], v[136:139], v[140:143]
    v_mfma_f32_16x16x32_bf16 v[144:147], v[204:207], v[136:139], v[144:147]
    s_nop 3
    ds_write_b128 v16, v[148:151] offset:0
    ds_write_b128 v16, v[152:155] offset:1024
    ds_write_b128 v16, v[156:159] offset:2048
    s_waitcnt lgkmcnt(0)
    s_barrier
    ds_read_b128 v[160:163], v17 offset:0
    ds_read_b128 v[164:167], v17 offset:1024
    ds_read_b128 v[168:171], v17 offset:2048
    v_fmac_f32 v18, v140, v228
    v_fmac_f32 v19, v141, v229
    v_fmac_f32 v20, v142, v230
    v_fmac_f32 v21, v143, v231
    v_fmac_f32 v22, v144, v232
    v_fmac_f32 v23, v145, v233
    v_fmac_f32 v24, v146, v234
    v_fmac_f32 v25, v147, v235
    v_fmac_f32 v26, v156, v236
    v_fmac_f32 v27, v157, v237
    v_fmac_f32 v28, v158, v238
    v_fmac_f32 v29, v159, v239
    s_waitcnt lgkmcnt(0)
    v_fmac_f32 v18, v160, v228
    v_fmac_f32 v19, v161, v229
    v_fmac_f32 v20, v162, v230
    v_fmac_f32 v21, v163, v231
    v_fmac_f32 v22, v164, v232
    v_fmac_f32 v23, v165, v233
    v_fmac_f32 v24, v166, v234
    v_fmac_f32 v25, v167, v235
    v_fmac_f32 v26, v168, v236
    v_fmac_f32 v27, v169, v237
    v_fmac_f32 v28, v170, v238
    v_fmac_f32 v29, v171, v239
    v_cvt_pk_bf16_f32 v248, v18, v19
    v_cvt_pk_bf16_f32 v249, v20, v21
    v_cvt_pk_bf16_f32 v250, v22, v23
    v_cvt_pk_bf16_f32 v251, v24, v25
    v_cvt_pk_bf16_f32 v252, v26, v27
    v_cvt_pk_bf16_f32 v253, v28, v29
    buffer_store_dwordx4 v[248:251], v5, s[20:23], s34 offen
    s_cmp_lg_u32 s46, 0
    s_cbranch_scc1 DF_n4_100
    buffer_store_dwordx2 v[252:253], v6, s[20:23], s34 offen
DF_n4_100:
adaLN_cond__mha_block__glu_gated_glu__prompt_kernel_end2:
    s_endpgm
.section .rodata,"a"
.p2align 6
.amdhsa_kernel adaLN_cond__mha_block__glu_gated_glu__prompt_kernel
  .amdhsa_next_free_vgpr 256
  .amdhsa_next_free_sgpr 102
  .amdhsa_accum_offset 256
  .amdhsa_group_segment_fixed_size 0
  .amdhsa_kernarg_size 96
  .amdhsa_user_sgpr_count 2
  .amdhsa_user_sgpr_kernarg_segment_ptr 1
  .amdhsa_system_sgpr_workgroup_id_x 1
.end_amdhsa_kernel
.text
```
